```python
import torch

def _softmax(x, axis=-1):
    return torch.softmax(x, dim=axis)
def _gelu(x):
    return torch.nn.functional.gelu(x, approximate="tanh")
def _silu(x):
    return torch.nn.functional.silu(x)
def _sigmoid(x):
    return torch.sigmoid(x)
def _layernorm(x, axis=-1, eps=1e-5):
    m = x.mean(dim=axis, keepdim=True)
    v = x.var(dim=axis, keepdim=True, unbiased=False)
    return (x - m) / torch.sqrt(v + eps)
def _scatter_add(tgt, idx, src, axis=0):
    return tgt.clone().index_add_(axis, idx, src)
def _segment_sum(src, seg, n):
    out = torch.zeros((n,) + src.shape[1:], dtype=src.dtype)
    return out.index_add_(0, seg, src)
def _pad(x, pw):
    flat = tuple(v for pair in reversed(pw) for v in pair)
    return torch.nn.functional.pad(x, flat)

kernel_name = 'concat_heads__mha_block_cached__gqa_block_cached__near_ridge'

def setup_inputs():

    _w = (lambda a: (lambda t: t.to(torch.bfloat16) if t.is_floating_point() else t)(torch.as_tensor(a)))
    def _A_setup():
        B, Sq, D = 16, 112, 448
        H, Sk, Dh = 16, 512, 256
        return {
            "x": _w((lambda *s: torch.randn(*s, dtype=torch.bfloat16) * 0.8)(B, Sq, D)),
            "k_cache": _w((lambda *s: torch.randn(*s, dtype=torch.bfloat16) * 0.8)(B, H, Sk, Dh)),
            "v_cache": _w((lambda *s: torch.randn(*s, dtype=torch.bfloat16) * 0.05)(B, H, Sk, Dh)),
            "wq": _w((lambda *s: torch.randn(*s, dtype=torch.bfloat16) * 0.8)(D, H * Dh) * (D ** -0.5)),
            "wo": _w((lambda *s: torch.randn(*s, dtype=torch.bfloat16) * 0.05)(H * Dh, D) * ((H * Dh) ** -0.5)),
        }
    _A_in = _A_setup()

    def _B_setup():
        B, Sq, D = 16, 112, 448
        Hq, Hkv, Sk, Dh = 16, 16, 512, 256
        assert Hq % Hkv == 0, (Hq, Hkv)
        return {
            "x": _w((lambda *s: torch.randn(*s, dtype=torch.bfloat16) * 0.8)(B, Sq, D)),
            "k_cache": _w((lambda *s: torch.randn(*s, dtype=torch.bfloat16) * 0.8)(B, Hkv, Sk, Dh)),
            "v_cache": _w((lambda *s: torch.randn(*s, dtype=torch.bfloat16) * 0.05)(B, Hkv, Sk, Dh)),
            "wq": _w((lambda *s: torch.randn(*s, dtype=torch.bfloat16) * 0.8)(D, Hq * Dh) * (D ** -0.5)),
            "wo": _w((lambda *s: torch.randn(*s, dtype=torch.bfloat16) * 0.05)(Hq * Dh, D) * ((Hq * Dh) ** -0.5)),
        }
    _B_in = _B_setup()

    return {
        "A_x": _A_in["x"],
        "A_k_cache": _A_in["k_cache"],
        "A_v_cache": _A_in["v_cache"],
        "A_wq": _A_in["wq"],
        "A_wo": _A_in["wo"],
        "B_x": _B_in["x"],
        "B_k_cache": _B_in["k_cache"],
        "B_v_cache": _B_in["v_cache"],
        "B_wq": _B_in["wq"],
        "B_wo": _B_in["wo"],
    }

def reference(A_x, A_k_cache, A_v_cache, A_wq, A_wo, B_x, B_k_cache, B_v_cache, B_wq, B_wo):
    def _A_ref(x, k_cache, v_cache, wq, wo):
        B, Sq, D = x.shape
        H, Dh = 16, 256
        q = (lambda x, *d: x.permute(*d))((x @ wq).reshape(B, Sq, H, Dh), 0, 2, 1, 3)
        scores = torch.einsum("bhqd,bhkd->bhqk", q, k_cache) * (Dh ** -0.5)
        p = _softmax(scores, axis=-1)
        o = torch.einsum("bhqk,bhkd->bhqd", p, v_cache)
        return (lambda x, *d: x.permute(*d))(o, 0, 2, 1, 3).reshape(B, Sq, H * Dh) @ wo

    def _B_ref(x, k_cache, v_cache, wq, wo):
        B, Sq, D = x.shape
        Hq, Dh = 16, 256
        Hkv = k_cache.shape[1]
        rep = Hq // Hkv
        q = (lambda x, *d: x.permute(*d))((x @ wq).reshape(B, Sq, Hq, Dh), 0, 2, 1, 3)
        k = (lambda x, n, axis: torch.repeat_interleave(x, n, dim=axis))(k_cache, rep, axis=1)
        v = (lambda x, n, axis: torch.repeat_interleave(x, n, dim=axis))(v_cache, rep, axis=1)
        scores = torch.einsum("bhqd,bhkd->bhqk", q, k) * (Dh ** -0.5)
        p = _softmax(scores, axis=-1)
        o = torch.einsum("bhqk,bhkd->bhqd", p, v)
        return (lambda x, *d: x.permute(*d))(o, 0, 2, 1, 3).reshape(B, Sq, Hq * Dh) @ wo

    a = _A_ref(A_x, A_k_cache, A_v_cache, A_wq, A_wo)
    b = _B_ref(B_x, B_k_cache, B_v_cache, B_wq, B_wo)
    return torch.concatenate([a, b], axis=-1)
```

```asm
; @launch grid=(256,1,1) block=(512,1,1) lds=163840
.amdgcn_target "amdgcn-amd-amdhsa--gfx950"
.text
.globl concat_heads__mha_block_cached__gqa_block_cached__near_ridge_kernel
.p2align 8
.type concat_heads__mha_block_cached__gqa_block_cached__near_ridge_kernel,@function
concat_heads__mha_block_cached__gqa_block_cached__near_ridge_kernel:
  s_cmp_ge_u32 s2, 256
  s_cbranch_scc1 L_end
  s_load_dwordx8 s[44:51], s[0:1], 0
  s_load_dwordx2 s[52:53], s[0:1], 32
  s_load_dwordx8 s[56:63], s[0:1], 40
  s_load_dwordx2 s[64:65], s[0:1], 72
  v_lshrrev_b32 v1, 6, v0
  v_and_b32 v11, 255, v0
  v_readfirstlane_b32 s3, v1
  v_and_b32 v0, 63, v0
  s_bfe_u32 s5, s2, 0x10002
  s_and_b32 s6, s2, 3
  s_lshl_b32 s6, s6, 1
  s_bfe_u32 s11, s2, 0x10003
  s_or_b32 s6, s6, s11
  s_lshr_b32 s7, s2, 4
  s_and_b32 s4, s3, 3
  s_mov_b32 s30, 100352
  s_mov_b32 s31, 0x20000
  s_mov_b32 s35, 0x20000
  s_mov_b32 s38, 458752
  s_mov_b32 s39, 0x20000
  s_mul_i32 s12, s7, 100352
  s_lshl_b32 s13, s6, 10
  s_sub_u32 s34, 3670016, s13
  s_mul_i32 s17, s6, 458752
  s_cmp_ge_u32 s3, 4
  s_cbranch_scc1 L_proj
  v_lshrrev_b32 v9, 3, v0
  v_and_b32 v66, 3, v9
  v_lshrrev_b32 v10, 2, v9
  v_lshl_add_u32 v66, v10, 3, v66
  v_lshlrev_b32 v66, 13, v66
  v_and_b32 v10, 7, v0
  v_and_b32 v9, 6, v9
  v_xor_b32 v10, v10, v9
  v_lshl_add_u32 v66, v10, 4, v66
  v_lshrrev_b32 v67, 3, v0
  s_lshl_b32 s10, s4, 5
  v_add_u32 v67, s10, v67
  v_mul_u32_u24 v67, 896, v67
  v_lshrrev_b32 v9, 4, v0
  v_and_b32 v10, 7, v0
  v_xor_b32 v9, v9, v10
  v_lshl_add_u32 v67, v9, 4, v67
  v_xor_b32 v68, 64, v67
  v_add_u32 v68, 6144, v68
  v_add_u32 v69, 12288, v67
  v_add_u32 v70, 12288, v68
  s_waitcnt lgkmcnt(0)
  s_cmp_eq_u32 s5, 0
  s_cselect_b64 s[28:29], s[44:45], s[56:57]
  s_cselect_b64 s[32:33], s[50:51], s[62:63]
  s_cselect_b64 s[20:21], s[46:47], s[58:59]
  s_cselect_b64 s[24:25], s[48:49], s[60:61]
  s_cselect_b64 s[36:37], s[52:53], s[64:65]
  s_add_u32 s28, s28, s12
  s_addc_u32 s29, s29, 0
  s_add_u32 s32, s32, s13
  s_addc_u32 s33, s33, 0
  s_add_u32 s36, s36, s17
  s_addc_u32 s37, s37, 0
  s_mul_i32 s48, s4, 12288
  s_add_u32 s48, s48, 81920
  s_lshl_b32 s49, s4, 12
  s_add_u32 s49, s49, 131072
  s_and_b32 s10, s6, 1
  s_mul_i32 s10, s10, 3
  s_add_u32 s10, s10, s7
  s_mul_i32 s11, s10, 37
  s_lshr_b32 s11, s11, 8
  s_mul_i32 s11, s11, 7
  s_sub_u32 s10, s10, s11
  s_mul_i32 s10, s10, 1
  s_lshl_b32 s64, s10, 7
  s_lshl_b32 s50, s10, 19
  s_lshl_b32 s10, s4, 7
  s_add_u32 s50, s50, s10
  s_cmp_ge_u32 s7, 7
  s_cselect_b32 s44, 1, 0
  s_lshl_b32 s10, s44, 18
  s_add_u32 s63, s50, 262144
  s_sub_u32 s63, s63, s10
  s_add_u32 s50, s50, s10
  s_add_u32 m0, s48, 0
  s_add_u32 s10, s50, 0
  buffer_load_dwordx4 v66, s[32:35], s10 offen offset:0 lds
  s_add_u32 s10, s50, 31744
  buffer_load_dwordx4 v66, s[32:35], s10 offen offset:1024 lds
  s_add_u32 s10, s50, 129024
  buffer_load_dwordx4 v66, s[32:35], s10 offen offset:2048 lds
  s_add_u32 s10, s50, 160768
  buffer_load_dwordx4 v66, s[32:35], s10 offen offset:3072 lds
  s_add_u32 m0, s49, 0
  s_nop 0
  buffer_load_dwordx4 v67, s[28:31], s64 offen offset:0 lds
  buffer_load_dwordx4 v68, s[28:31], s64 offen offset:1024 lds
  buffer_load_dwordx4 v69, s[28:31], s64 offen offset:2048 lds
  buffer_load_dwordx4 v70, s[28:31], s64 offen offset:3072 lds
  s_add_u32 s64, s64, 128
  s_cmp_eq_u32 s64, 896
  s_cselect_b32 s64, 0, s64
  s_add_u32 m0, s48, 4096
  s_add_u32 s10, s63, 0
  buffer_load_dwordx4 v66, s[32:35], s10 offen offset:0 lds
  s_add_u32 s10, s63, 31744
  buffer_load_dwordx4 v66, s[32:35], s10 offen offset:1024 lds
  s_add_u32 s10, s63, 129024
  buffer_load_dwordx4 v66, s[32:35], s10 offen offset:2048 lds
  s_add_u32 s10, s63, 160768
  buffer_load_dwordx4 v66, s[32:35], s10 offen offset:3072 lds
  s_add_u32 s50, s50, 524288
  s_cmp_ge_u32 s50, 3670016
  s_cselect_b32 s10, 3670016, 0
  s_sub_u32 s50, s50, s10
  s_add_u32 s63, s63, 524288
  s_sub_u32 s63, s63, s10
  s_add_u32 m0, s49, 16384
  s_nop 0
  buffer_load_dwordx4 v67, s[28:31], s64 offen offset:0 lds
  buffer_load_dwordx4 v68, s[28:31], s64 offen offset:1024 lds
  buffer_load_dwordx4 v69, s[28:31], s64 offen offset:2048 lds
  buffer_load_dwordx4 v70, s[28:31], s64 offen offset:3072 lds
  s_add_u32 s64, s64, 128
  s_cmp_eq_u32 s64, 896
  s_cselect_b32 s64, 0, s64
  s_lshl_b32 s10, s7, 3
  s_add_u32 s10, s10, s6
  s_lshl_b32 s11, s10, 19
  s_add_u32 s24, s24, s11
  s_addc_u32 s25, s25, 0
  s_add_u32 s20, s20, s11
  s_addc_u32 s21, s21, 0
  s_sub_u32 s20, s20, 4096
  s_subb_u32 s21, s21, 0
  s_mov_b32 s22, 528384
  s_mov_b32 s23, 0x20000
  s_mov_b32 s26, 524288
  s_mov_b32 s27, 0x20000
  s_lshl_b32 s14, s4, 12
  v_lshrrev_b32 v9, 3, v0
  v_and_b32 v8, 7, v0
  v_lshrrev_b32 v10, 4, v0
  v_xor_b32 v7, v8, v10
  s_and_b32 s10, s4, 1
  s_lshl_b32 s10, s10, 2
  v_xor_b32 v7, s10, v7
  v_lshlrev_b32 v7, 4, v7
  v_lshl_add_u32 v7, v9, 9, v7
  v_lshlrev_b32 v10, 1, v10
  v_xor_b32 v8, v8, v10
  v_lshlrev_b32 v8, 4, v8
  v_lshl_add_u32 v8, v9, 9, v8
  s_mov_b32 s12, 1035512379
  s_mov_b32 s13, 1101004800
  v_and_b32 v9, 15, v0
  v_lshrrev_b32 v1, 3, v9
  v_lshlrev_b32 v1, 12, v1
  v_and_b32 v10, 7, v9
  v_lshl_add_u32 v1, v10, 7, v1
  v_lshrrev_b32 v10, 1, v9
  v_lshrrev_b32 v9, 4, v0
  v_xor_b32 v10, v10, v9
  v_lshl_add_u32 v1, v10, 4, v1
  v_xor_b32 v2, 64, v1
  v_lshrrev_b32 v3, 2, v0
  v_lshlrev_b32 v3, 7, v3
  v_bfe_u32 v10, v0, 3, 2
  v_lshl_add_u32 v3, v10, 5, v3
  v_and_b32 v10, 3, v0
  v_lshl_add_u32 v3, v10, 3, v3
  s_mul_i32 s10, s7, 1
  s_bfe_u32 s10, s10, 0x10002
  s_lshl_b32 s10, s10, 6
  v_xor_b32 v3, s10, v3
  v_xor_b32 v4, 32, v3
  v_xor_b32 v5, 64, v3
  v_xor_b32 v6, 96, v3
  s_mov_b32 s45, 0
  s_mov_b32 s46, 0
  s_mov_b32 s47, 0
  s_mov_b32 s61, -65536
  s_movk_i32 s62, 16384
  s_cmp_eq_u32 s4, 3
  s_cselect_b64 s[52:53], -1, 0
  s_waitcnt vmcnt(8)
  s_barrier
  s_add_u32 m0, s48, 8192
  s_add_u32 s10, s50, 0
  buffer_load_dwordx4 v66, s[32:35], s10 offen offset:0 lds
  s_add_u32 s10, s50, 31744
  buffer_load_dwordx4 v66, s[32:35], s10 offen offset:1024 lds
  s_add_u32 s10, s50, 129024
  buffer_load_dwordx4 v66, s[32:35], s10 offen offset:2048 lds
  s_add_u32 s10, s50, 160768
  buffer_load_dwordx4 v66, s[32:35], s10 offen offset:3072 lds
  s_waitcnt vmcnt(8)
  s_barrier
  s_add_u32 m0, s48, 0
  s_add_u32 s10, s63, 0
  buffer_load_dwordx4 v66, s[32:35], s10 offen offset:0 lds
  s_add_u32 s10, s63, 31744
  buffer_load_dwordx4 v66, s[32:35], s10 offen offset:1024 lds
  s_add_u32 s10, s63, 129024
  buffer_load_dwordx4 v66, s[32:35], s10 offen offset:2048 lds
  s_add_u32 s10, s63, 160768
  buffer_load_dwordx4 v66, s[32:35], s10 offen offset:3072 lds
  s_add_u32 s50, s50, 524288
  s_cmp_ge_u32 s50, 3670016
  s_cselect_b32 s10, 3670016, 0
  s_sub_u32 s50, s50, s10
  s_add_u32 s63, s63, 524288
  s_sub_u32 s63, s63, s10
  s_waitcnt vmcnt(4)
  s_barrier
  s_add_u32 m0, s48, 4096
  s_add_u32 s10, s50, 0
  buffer_load_dwordx4 v66, s[32:35], s10 offen offset:0 lds
  s_add_u32 s10, s50, 31744
  buffer_load_dwordx4 v66, s[32:35], s10 offen offset:1024 lds
  s_add_u32 s10, s50, 129024
  buffer_load_dwordx4 v66, s[32:35], s10 offen offset:2048 lds
  s_add_u32 s10, s50, 160768
  buffer_load_dwordx4 v66, s[32:35], s10 offen offset:3072 lds
  s_add_u32 m0, s49, 0
  s_nop 0
  buffer_load_dwordx4 v67, s[28:31], s64 offen offset:0 lds
  buffer_load_dwordx4 v68, s[28:31], s64 offen offset:1024 lds
  buffer_load_dwordx4 v69, s[28:31], s64 offen offset:2048 lds
  buffer_load_dwordx4 v70, s[28:31], s64 offen offset:3072 lds
  s_add_u32 s64, s64, 128
  s_cmp_eq_u32 s64, 896
  s_cselect_b32 s64, 0, s64
  s_waitcnt vmcnt(8)
  s_barrier
  s_add_u32 m0, s48, 8192
  s_add_u32 s10, s63, 0
  buffer_load_dwordx4 v66, s[32:35], s10 offen offset:0 lds
  s_add_u32 s10, s63, 31744
  buffer_load_dwordx4 v66, s[32:35], s10 offen offset:1024 lds
  s_add_u32 s10, s63, 129024
  buffer_load_dwordx4 v66, s[32:35], s10 offen offset:2048 lds
  s_add_u32 s10, s63, 160768
  buffer_load_dwordx4 v66, s[32:35], s10 offen offset:3072 lds
  s_add_u32 s50, s50, 524288
  s_cmp_ge_u32 s50, 3670016
  s_cselect_b32 s10, 3670016, 0
  s_sub_u32 s50, s50, s10
  s_add_u32 s63, s63, 524288
  s_sub_u32 s63, s63, s10
  s_waitcnt vmcnt(4)
  s_barrier
  s_add_u32 m0, s48, 0
  s_add_u32 s10, s50, 0
  buffer_load_dwordx4 v66, s[32:35], s10 offen offset:0 lds
  s_add_u32 s10, s50, 31744
  buffer_load_dwordx4 v66, s[32:35], s10 offen offset:1024 lds
  s_add_u32 s10, s50, 129024
  buffer_load_dwordx4 v66, s[32:35], s10 offen offset:2048 lds
  s_add_u32 s10, s50, 160768
  buffer_load_dwordx4 v66, s[32:35], s10 offen offset:3072 lds
  s_add_u32 m0, s49, 16384
  s_nop 0
  buffer_load_dwordx4 v67, s[28:31], s64 offen offset:0 lds
  buffer_load_dwordx4 v68, s[28:31], s64 offen offset:1024 lds
  buffer_load_dwordx4 v69, s[28:31], s64 offen offset:2048 lds
  buffer_load_dwordx4 v70, s[28:31], s64 offen offset:3072 lds
  s_add_u32 s64, s64, 128
  s_cmp_eq_u32 s64, 896
  s_cselect_b32 s64, 0, s64
  s_waitcnt vmcnt(8)
  s_barrier
  s_add_u32 m0, s48, 4096
  s_add_u32 s10, s63, 0
  buffer_load_dwordx4 v66, s[32:35], s10 offen offset:0 lds
  s_add_u32 s10, s63, 31744
  buffer_load_dwordx4 v66, s[32:35], s10 offen offset:1024 lds
  s_add_u32 s10, s63, 129024
  buffer_load_dwordx4 v66, s[32:35], s10 offen offset:2048 lds
  s_add_u32 s10, s63, 160768
  buffer_load_dwordx4 v66, s[32:35], s10 offen offset:3072 lds
  s_add_u32 s50, s50, 524288
  s_cmp_ge_u32 s50, 3670016
  s_cselect_b32 s10, 3670016, 0
  s_sub_u32 s50, s50, s10
  s_add_u32 s63, s63, 524288
  s_sub_u32 s63, s63, s10
  s_waitcnt vmcnt(4)
  s_barrier
  s_add_u32 m0, s48, 8192
  s_add_u32 s10, s50, 0
  buffer_load_dwordx4 v66, s[32:35], s10 offen offset:0 lds
  s_add_u32 s10, s50, 31744
  buffer_load_dwordx4 v66, s[32:35], s10 offen offset:1024 lds
  s_add_u32 s10, s50, 129024
  buffer_load_dwordx4 v66, s[32:35], s10 offen offset:2048 lds
  s_add_u32 s10, s50, 160768
  buffer_load_dwordx4 v66, s[32:35], s10 offen offset:3072 lds
  s_add_u32 m0, s49, 0
  s_nop 0
  buffer_load_dwordx4 v67, s[28:31], s64 offen offset:0 lds
  buffer_load_dwordx4 v68, s[28:31], s64 offen offset:1024 lds
  buffer_load_dwordx4 v69, s[28:31], s64 offen offset:2048 lds
  buffer_load_dwordx4 v70, s[28:31], s64 offen offset:3072 lds
  s_add_u32 s64, s64, 128
  s_cmp_eq_u32 s64, 896
  s_cselect_b32 s64, 0, s64
  s_waitcnt vmcnt(8)
  s_barrier
  s_add_u32 m0, s48, 0
  s_add_u32 s10, s63, 0
  buffer_load_dwordx4 v66, s[32:35], s10 offen offset:0 lds
  s_add_u32 s10, s63, 31744
  buffer_load_dwordx4 v66, s[32:35], s10 offen offset:1024 lds
  s_add_u32 s10, s63, 129024
  buffer_load_dwordx4 v66, s[32:35], s10 offen offset:2048 lds
  s_add_u32 s10, s63, 160768
  buffer_load_dwordx4 v66, s[32:35], s10 offen offset:3072 lds
  s_add_u32 s50, s50, 524288
  s_cmp_ge_u32 s50, 3670016
  s_cselect_b32 s10, 3670016, 0
  s_sub_u32 s50, s50, s10
  s_add_u32 s63, s63, 524288
  s_sub_u32 s63, s63, s10
  s_add_u32 m0, s14, 0
  s_add_u32 s10, s14, 4096
  buffer_load_dwordx4 v7, s[20:23], s10 offen nt lds
  s_sub_u32 s10, s10, 896
  buffer_load_dwordx4 v7, s[20:23], s10 offen offset:1024 nt lds
  s_sub_u32 s10, s10, 896
  buffer_load_dwordx4 v7, s[20:23], s10 offen offset:2048 nt lds
  s_sub_u32 s10, s10, 896
  buffer_load_dwordx4 v7, s[20:23], s10 offen offset:3072 nt lds
  s_waitcnt vmcnt(8)
  s_barrier
  s_add_u32 m0, s48, 4096
  s_add_u32 s10, s50, 0
  buffer_load_dwordx4 v66, s[32:35], s10 offen offset:0 lds
  s_add_u32 s10, s50, 31744
  buffer_load_dwordx4 v66, s[32:35], s10 offen offset:1024 lds
  s_add_u32 s10, s50, 129024
  buffer_load_dwordx4 v66, s[32:35], s10 offen offset:2048 lds
  s_add_u32 s10, s50, 160768
  buffer_load_dwordx4 v66, s[32:35], s10 offen offset:3072 lds
  s_add_u32 m0, s49, 16384
  s_nop 0
  buffer_load_dwordx4 v67, s[28:31], s64 offen offset:0 lds
  buffer_load_dwordx4 v68, s[28:31], s64 offen offset:1024 lds
  buffer_load_dwordx4 v69, s[28:31], s64 offen offset:2048 lds
  buffer_load_dwordx4 v70, s[28:31], s64 offen offset:3072 lds
  s_add_u32 s64, s64, 128
  s_cmp_eq_u32 s64, 896
  s_cselect_b32 s64, 0, s64
  s_waitcnt vmcnt(12)
  s_barrier
  s_add_u32 m0, s48, 8192
  s_add_u32 s10, s63, 0
  buffer_load_dwordx4 v66, s[32:35], s10 offen offset:0 lds
  s_add_u32 s10, s63, 31744
  buffer_load_dwordx4 v66, s[32:35], s10 offen offset:1024 lds
  s_add_u32 s10, s63, 129024
  buffer_load_dwordx4 v66, s[32:35], s10 offen offset:2048 lds
  s_add_u32 s10, s63, 160768
  buffer_load_dwordx4 v66, s[32:35], s10 offen offset:3072 lds
  s_add_u32 s50, s50, 524288
  s_cmp_ge_u32 s50, 3670016
  s_cselect_b32 s10, 3670016, 0
  s_sub_u32 s50, s50, s10
  s_add_u32 s63, s63, 524288
  s_sub_u32 s63, s63, s10
  s_add_u32 m0, s14, 16384
  s_add_u32 s10, s14, 20480
  buffer_load_dwordx4 v7, s[20:23], s10 offen nt lds
  s_sub_u32 s10, s10, 896
  buffer_load_dwordx4 v7, s[20:23], s10 offen offset:1024 nt lds
  s_sub_u32 s10, s10, 896
  buffer_load_dwordx4 v7, s[20:23], s10 offen offset:2048 nt lds
  s_sub_u32 s10, s10, 896
  buffer_load_dwordx4 v7, s[20:23], s10 offen offset:3072 nt lds
  s_waitcnt vmcnt(8)
  s_barrier
  s_add_u32 m0, s48, 0
  s_add_u32 s10, s50, 0
  buffer_load_dwordx4 v66, s[32:35], s10 offen offset:0 lds
  s_add_u32 s10, s50, 31744
  buffer_load_dwordx4 v66, s[32:35], s10 offen offset:1024 lds
  s_add_u32 s10, s50, 129024
  buffer_load_dwordx4 v66, s[32:35], s10 offen offset:2048 lds
  s_add_u32 s10, s50, 160768
  buffer_load_dwordx4 v66, s[32:35], s10 offen offset:3072 lds
  s_add_u32 m0, s49, 0
  s_nop 0
  buffer_load_dwordx4 v67, s[28:31], s64 offen offset:0 lds
  buffer_load_dwordx4 v68, s[28:31], s64 offen offset:1024 lds
  buffer_load_dwordx4 v69, s[28:31], s64 offen offset:2048 lds
  buffer_load_dwordx4 v70, s[28:31], s64 offen offset:3072 lds
  s_add_u32 s64, s64, 128
  s_cmp_eq_u32 s64, 896
  s_cselect_b32 s64, 0, s64
  s_waitcnt vmcnt(12)
  s_barrier
  s_add_u32 m0, s48, 4096
  s_add_u32 s10, s63, 0
  buffer_load_dwordx4 v66, s[32:35], s10 offen offset:0 lds
  s_add_u32 s10, s63, 31744
  buffer_load_dwordx4 v66, s[32:35], s10 offen offset:1024 lds
  s_add_u32 s10, s63, 129024
  buffer_load_dwordx4 v66, s[32:35], s10 offen offset:2048 lds
  s_add_u32 s10, s63, 160768
  buffer_load_dwordx4 v66, s[32:35], s10 offen offset:3072 lds
  s_add_u32 s50, s50, 524288
  s_cmp_ge_u32 s50, 3670016
  s_cselect_b32 s10, 3670016, 0
  s_sub_u32 s50, s50, s10
  s_add_u32 s63, s63, 524288
  s_sub_u32 s63, s63, s10
  s_add_u32 m0, s14, 32768
  s_add_u32 s10, s14, 36864
  buffer_load_dwordx4 v7, s[20:23], s10 offen nt lds
  s_sub_u32 s10, s10, 896
  buffer_load_dwordx4 v7, s[20:23], s10 offen offset:1024 nt lds
  s_sub_u32 s10, s10, 896
  buffer_load_dwordx4 v7, s[20:23], s10 offen offset:2048 nt lds
  s_sub_u32 s10, s10, 896
  buffer_load_dwordx4 v7, s[20:23], s10 offen offset:3072 nt lds
  s_add_u32 m0, s14, 49152
  s_add_u32 s10, s14, 53248
  buffer_load_dwordx4 v7, s[20:23], s10 offen nt lds
  s_sub_u32 s10, s10, 896
  buffer_load_dwordx4 v7, s[20:23], s10 offen offset:1024 nt lds
  s_sub_u32 s10, s10, 896
  buffer_load_dwordx4 v7, s[20:23], s10 offen offset:2048 nt lds
  s_sub_u32 s10, s10, 896
  buffer_load_dwordx4 v7, s[20:23], s10 offen offset:3072 nt lds
  s_waitcnt vmcnt(12)
  s_barrier
  s_add_u32 m0, s14, 65536
  s_add_u32 s10, s14, 69632
  buffer_load_dwordx4 v7, s[20:23], s10 offen nt lds
  s_sub_u32 s10, s10, 896
  buffer_load_dwordx4 v7, s[20:23], s10 offen offset:1024 nt lds
  s_sub_u32 s10, s10, 896
  buffer_load_dwordx4 v7, s[20:23], s10 offen offset:2048 nt lds
  s_sub_u32 s10, s10, 896
  buffer_load_dwordx4 v7, s[20:23], s10 offen offset:3072 nt lds
  s_waitcnt vmcnt(12)
  s_barrier
  s_lshl_b32 s10, s7, 2
  s_add_u32 s10, s10, s4
  s_mul_i32 s10, s10, 57344
  v_bfe_u32 v9, v0, 2, 3
  v_and_b32 v10, 3, v0
  v_lshlrev_b32 v10, 7, v10
  v_lshl_add_u32 v65, v9, 13, v10
  s_mov_b64 exec, 0xfffffff
  buffer_load_dword v255, v65, s[32:35], s10 offen offset:512
  s_mov_b64 exec, -1
  s_barrier
  s_load_dwordx4 s[64:67], s[0:1], 80
  s_load_dwordx2 s[40:41], s[0:1], 96
  s_mul_i32 s17, s7, 200704
  s_mul_i32 s16, s5, 896
  s_add_u32 s17, s17, s16
  s_lshl_b32 s10, s5, 4
  s_add_u32 s10, s10, s7
  s_mul_i32 s11, s10, 831744
  s_lshl_b32 s16, s10, 11
  s_add_u32 s16, s16, 33554432
  s_mov_b32 s42, 831744
  s_mov_b32 s43, 0x20000
  s_movk_i32 s26, 2048
  s_mov_b32 s27, 0x20000
  s_mov_b32 s30, 3211264
  s_mov_b32 s31, 0x20000
  s_waitcnt lgkmcnt(0)
  s_add_u32 s24, s40, s16
  s_addc_u32 s25, s41, 0
  s_add_u32 s40, s40, s11
  s_addc_u32 s41, s41, 0
  s_mov_b32 s28, s64
  s_mov_b32 s29, s65
  s_waitcnt vmcnt(41)
  s_barrier
  s_lshl_b32 s10, s4, 11
  s_add_u32 s10, s10, 147456
  v_lshl_add_u32 v7, v0, 4, s10
  s_mul_i32 s55, s4, 14336
  s_sub_u32 s55, s55, 65536
  v_add_u32 v0, s55, v7
  s_mov_b64 s[48:49], 0
  ds_read_b128 v[64:67], v0 offset:0
  ds_read_b128 v[68:71], v0 offset:1024
  ds_read_b128 v[72:75], v0 offset:2048
  ds_read_b128 v[76:79], v0 offset:3072
  ds_read_b128 v[80:83], v0 offset:4096
  ds_read_b128 v[84:87], v0 offset:5120
  ds_read_b128 v[88:91], v0 offset:6144
  ds_read_b128 v[92:95], v0 offset:7168
  ds_read_b128 v[96:99], v0 offset:8192
  ds_read_b128 v[100:103], v0 offset:9216
  s_waitcnt lgkmcnt(4)
  ds_read_b128 v[104:107], v0 offset:10240
  ds_read_b128 v[108:111], v0 offset:11264
  ds_read_b128 v[112:115], v0 offset:12288
  ds_read_b128 v[116:119], v0 offset:13312
  ds_read_b128 v[120:123], v0 offset:14336
  ds_read_b128 v[124:127], v0 offset:15360
  ds_read_b128 v[12:15], v1 offset:0
  ds_read_b128 v[16:19], v2 offset:0
  ds_read_b128 v[20:23], v1 offset:1024
  ds_read_b128 v[24:27], v2 offset:1024
  ds_read_b128 v[28:31], v1 offset:2048
  s_waitcnt lgkmcnt(0) vmcnt(25)
  s_mov_b32 s8, 0
L_head:
  s_barrier
  s_waitcnt lgkmcnt(0)
  v_mfma_f32_16x16x32_bf16 v[32:35], v[12:15], v[64:67], 0
  v_mfma_f32_16x16x32_bf16 v[36:39], v[12:15], v[68:71], 0
  ds_read_b128 v[12:15], v2 offset:2048
  v_mul_f32 v48, v48, v10
  v_mul_f32 v49, v49, v10
  v_mfma_f32_16x16x32_bf16 v[32:35], v[16:19], v[72:75], v[32:35]
  v_mul_f32 v50, v50, v10
  v_mul_f32 v51, v51, v10
  v_mfma_f32_16x16x32_bf16 v[36:39], v[16:19], v[76:79], v[36:39]
  ds_read_b128 v[16:19], v1 offset:3072
  v_mul_f32 v52, v52, v10
  v_mul_f32 v53, v53, v10
  v_mfma_f32_16x16x32_bf16 v[32:35], v[20:23], v[80:83], v[32:35]
  v_mul_f32 v54, v54, v10
  v_mul_f32 v55, v55, v10
  v_mfma_f32_16x16x32_bf16 v[36:39], v[20:23], v[84:87], v[36:39]
  ds_read_b128 v[20:23], v2 offset:3072
  v_cvt_pk_bf16_f32 v48, v48, v49
  v_cvt_pk_bf16_f32 v49, v50, v51
  v_mfma_f32_16x16x32_bf16 v[32:35], v[24:27], v[88:91], v[32:35]
  v_cvt_pk_bf16_f32 v50, v52, v53
  v_cvt_pk_bf16_f32 v51, v54, v55
  v_mfma_f32_16x16x32_bf16 v[36:39], v[24:27], v[92:95], v[36:39]
  ds_read_b128 v[24:27], v1 offset:8192
  s_mov_b64 exec, s[48:49]
  ds_write_b128 v7, v[48:51] offset:8192
  s_mov_b64 exec, -1
  s_waitcnt lgkmcnt(4)
  v_mfma_f32_16x16x32_bf16 v[32:35], v[28:31], v[96:99], v[32:35]
  v_mul_f32 v56, v56, v11
  v_mul_f32 v57, v57, v11
  v_mfma_f32_16x16x32_bf16 v[36:39], v[28:31], v[100:103], v[36:39]
  ds_read_b128 v[28:31], v2 offset:8192
  v_mul_f32 v58, v58, v11
  v_mul_f32 v59, v59, v11
  v_mfma_f32_16x16x32_bf16 v[32:35], v[12:15], v[104:107], v[32:35]
  v_mul_f32 v60, v60, v11
  v_mul_f32 v61, v61, v11
  v_mfma_f32_16x16x32_bf16 v[36:39], v[12:15], v[108:111], v[36:39]
  ds_read_b128 v[12:15], v1 offset:9216
  v_mul_f32 v62, v62, v11
  v_mul_f32 v63, v63, v11
  s_waitcnt lgkmcnt(4)
  v_mfma_f32_16x16x32_bf16 v[32:35], v[16:19], v[112:115], v[32:35]
  v_cvt_pk_bf16_f32 v56, v56, v57
  v_cvt_pk_bf16_f32 v57, v58, v59
  v_mfma_f32_16x16x32_bf16 v[36:39], v[16:19], v[116:119], v[36:39]
  ds_read_b128 v[16:19], v2 offset:9216
  v_cvt_pk_bf16_f32 v58, v60, v61
  v_cvt_pk_bf16_f32 v59, v62, v63
  v_mfma_f32_16x16x32_bf16 v[32:35], v[20:23], v[120:123], v[32:35]
  s_mov_b64 exec, s[48:49]
  ds_write_b128 v7, v[56:59] offset:9216
  s_mov_b64 exec, -1
  v_mfma_f32_16x16x32_bf16 v[36:39], v[20:23], v[124:127], v[36:39]
  ds_read_b128 v[20:23], v1 offset:10240
  s_waitcnt lgkmcnt(4)
  v_mfma_f32_16x16x32_bf16 v[40:43], v[24:27], v[64:67], 0
  v_mfma_f32_16x16x32_bf16 v[44:47], v[24:27], v[68:71], 0
  ds_read_b128 v[24:27], v2 offset:10240
  v_mfma_f32_16x16x32_bf16 v[40:43], v[28:31], v[72:75], v[40:43]
  v_mfma_f32_16x16x32_bf16 v[44:47], v[28:31], v[76:79], v[44:47]
  ds_read_b128 v[28:31], v1 offset:11264
  v_max3_f32 v8, v32, v33, v34
  v_max_f32 v8, v8, v35
  v_max3_f32 v9, v36, v37, v38
  v_max_f32 v9, v9, v39
  v_mov_b32 v48, v8
  s_waitcnt lgkmcnt(4)
  v_mfma_f32_16x16x32_bf16 v[40:43], v[12:15], v[80:83], v[40:43]
  v_mov_b32 v49, v9
  v_permlane32_swap_b32 v8, v48
  s_nop 0
  v_permlane32_swap_b32 v9, v49
  v_max_f32 v8, v8, v48
  v_max_f32 v9, v9, v49
  v_mfma_f32_16x16x32_bf16 v[44:47], v[12:15], v[84:87], v[44:47]
  ds_read_b128 v[12:15], v2 offset:11264
  v_mov_b32 v48, v8
  v_mov_b32 v49, v9
  s_nop 0
  v_permlane16_swap_b32 v8, v48
  v_permlane16_swap_b32 v9, v49
  v_max_f32 v8, v8, v48
  v_mfma_f32_16x16x32_bf16 v[40:43], v[16:19], v[88:91], v[40:43]
  v_max_f32 v9, v9, v49
  v_mov_b32 v10, 0
  v_mov_b32 v11, 0
  v_rndne_f32 v8, -v8
  v_rndne_f32 v9, -v9
  v_mfma_f32_16x16x32_bf16 v[44:47], v[16:19], v[92:95], v[44:47]
  s_cmp_eq_u32 s45, 65536
  s_cselect_b32 s11, s61, s62
  s_add_u32 s45, s45, s11
  v_add_u32 v1, s11, v1
  v_add_u32 v2, s11, v2
  ds_read_b128 v[16:19], v1 offset:0
  s_mov_b64 exec, s[52:53]
  v_mov_b32 v9, 0xf149f2ca
  s_mov_b64 exec, -1
  v_mov_b32 v52, v8
  v_mov_b32 v53, v8
  v_mov_b32 v54, v8
  v_mov_b32 v55, v8
  s_waitcnt lgkmcnt(3)
  v_mfma_f32_16x16x32_bf16 v[40:43], v[20:23], v[96:99], v[40:43]
  v_mov_b32 v60, v9
  v_mov_b32 v61, v9
  v_mov_b32 v62, v9
  v_mov_b32 v63, v9
  v_add_f32 v32, v32, v52
  v_mfma_f32_16x16x32_bf16 v[44:47], v[20:23], v[100:103], v[44:47]
  ds_read_b128 v[20:23], v2 offset:0
  v_add_f32 v33, v33, v52
  v_add_f32 v34, v34, v52
  v_add_f32 v35, v35, v52
  v_add_f32 v36, v36, v60
  v_add_f32 v37, v37, v60
  v_mfma_f32_16x16x32_bf16 v[40:43], v[24:27], v[104:107], v[40:43]
  v_add_f32 v38, v38, v60
  v_add_f32 v39, v39, v60
  v_exp_f32 v32, v32
  v_exp_f32 v36, v36
  v_mfma_f32_16x16x32_bf16 v[44:47], v[24:27], v[108:111], v[44:47]
  ds_read_b128 v[24:27], v1 offset:1024
  v_exp_f32 v33, v33
  v_add_f32 v10, v10, v32
  v_exp_f32 v37, v37
  s_waitcnt lgkmcnt(3)
  v_mfma_f32_16x16x32_bf16 v[40:43], v[28:31], v[112:115], v[40:43]
  v_add_f32 v11, v11, v36
  v_exp_f32 v34, v34
  v_add_f32 v10, v10, v33
  v_mfma_f32_16x16x32_bf16 v[44:47], v[28:31], v[116:119], v[44:47]
  ds_read_b128 v[28:31], v2 offset:1024
  v_cvt_pk_bf16_f32 v128, v32, v33
  v_exp_f32 v38, v38
  v_add_f32 v11, v11, v37
  v_cvt_pk_bf16_f32 v132, v36, v37
  v_mfma_f32_16x16x32_bf16 v[40:43], v[12:15], v[120:123], v[40:43]
  v_exp_f32 v35, v35
  v_add_f32 v10, v10, v34
  v_exp_f32 v39, v39
  v_mfma_f32_16x16x32_bf16 v[44:47], v[12:15], v[124:127], v[44:47]
  ds_read_b128 v[12:15], v1 offset:2048
  v_add_f32 v11, v11, v38
  v_add_f32 v10, v10, v35
  v_cvt_pk_bf16_f32 v129, v34, v35
  v_add_f32 v11, v11, v39
  v_cvt_pk_bf16_f32 v133, v38, v39
  s_waitcnt vmcnt(9)
  s_barrier
  s_waitcnt lgkmcnt(3)
  v_mfma_f32_16x16x32_bf16 v[32:35], v[16:19], v[64:67], v[52:55]
  v_mfma_f32_16x16x32_bf16 v[36:39], v[16:19], v[68:71], v[60:63]
  ds_read_b128 v[16:19], v2 offset:2048
  v_mfma_f32_16x16x32_bf16 v[32:35], v[20:23], v[72:75], v[32:35]
  v_add_f32 v40, v40, v52
  v_add_f32 v41, v41, v52
  v_add_f32 v42, v42, v52
  v_mfma_f32_16x16x32_bf16 v[36:39], v[20:23], v[76:79], v[36:39]
  ds_read_b128 v[20:23], v1 offset:3072
  v_add_f32 v43, v43, v52
  v_add_f32 v44, v44, v60
  v_add_f32 v45, v45, v60
  s_waitcnt lgkmcnt(3)
  v_mfma_f32_16x16x32_bf16 v[32:35], v[24:27], v[80:83], v[32:35]
  v_add_f32 v46, v46, v60
  v_add_f32 v47, v47, v60
  v_max3_f32 v48, v40, v41, v42
  v_mfma_f32_16x16x32_bf16 v[36:39], v[24:27], v[84:87], v[36:39]
  ds_read_b128 v[24:27], v2 offset:3072
  v_max3_f32 v49, v43, v44, v45
  v_max3_f32 v48, v48, v46, v47
  v_max_f32 v48, v48, v49
  v_mfma_f32_16x16x32_bf16 v[32:35], v[28:31], v[88:91], v[32:35]
  v_cmp_lt_f32 vcc, s13, v48
  s_cbranch_vccnz L_rs0
L_rb0:
  v_exp_f32 v40, v40
  v_mfma_f32_16x16x32_bf16 v[36:39], v[28:31], v[92:95], v[36:39]
  ds_read_b128 v[28:31], v1 offset:8192
  v_exp_f32 v44, v44
  v_exp_f32 v41, v41
  s_waitcnt lgkmcnt(3)
  v_mfma_f32_16x16x32_bf16 v[32:35], v[12:15], v[96:99], v[32:35]
  v_add_f32 v10, v10, v40
  v_exp_f32 v45, v45
  v_mfma_f32_16x16x32_bf16 v[36:39], v[12:15], v[100:103], v[36:39]
  ds_read_b128 v[12:15], v2 offset:8192
  v_add_f32 v11, v11, v44
  v_exp_f32 v42, v42
  v_mfma_f32_16x16x32_bf16 v[32:35], v[16:19], v[104:107], v[32:35]
  v_add_f32 v10, v10, v41
  v_cvt_pk_bf16_f32 v130, v40, v41
  v_mfma_f32_16x16x32_bf16 v[36:39], v[16:19], v[108:111], v[36:39]
  ds_read_b128 v[16:19], v1 offset:9216
  v_exp_f32 v46, v46
  v_add_f32 v11, v11, v45
  s_waitcnt lgkmcnt(3)
  v_mfma_f32_16x16x32_bf16 v[32:35], v[20:23], v[112:115], v[32:35]
  v_cvt_pk_bf16_f32 v134, v44, v45
  v_exp_f32 v43, v43
  v_mfma_f32_16x16x32_bf16 v[36:39], v[20:23], v[116:119], v[36:39]
  ds_read_b128 v[20:23], v2 offset:9216
  v_add_f32 v10, v10, v42
  v_exp_f32 v47, v47
  v_mfma_f32_16x16x32_bf16 v[32:35], v[24:27], v[120:123], v[32:35]
  v_add_f32 v11, v11, v46
  v_add_f32 v10, v10, v43
  v_cvt_pk_bf16_f32 v131, v42, v43
  v_mfma_f32_16x16x32_bf16 v[36:39], v[24:27], v[124:127], v[36:39]
  ds_read_b128 v[24:27], v1 offset:10240
  v_add_f32 v11, v11, v47
  v_cvt_pk_bf16_f32 v135, v46, v47
  s_waitcnt lgkmcnt(3)
  v_mfma_f32_16x16x32_bf16 v[40:43], v[28:31], v[64:67], v[52:55]
  v_mfma_f32_16x16x32_bf16 v[44:47], v[28:31], v[68:71], v[60:63]
  ds_read_b128 v[28:31], v2 offset:10240
  v_mfma_f32_16x16x32_bf16 v[40:43], v[12:15], v[72:75], v[40:43]
  v_mfma_f32_16x16x32_bf16 v[44:47], v[12:15], v[76:79], v[44:47]
  ds_read_b128 v[12:15], v1 offset:11264
  v_max3_f32 v48, v32, v33, v34
  v_max3_f32 v49, v35, v36, v37
  v_max3_f32 v48, v48, v38, v39
  s_waitcnt lgkmcnt(3)
  v_mfma_f32_16x16x32_bf16 v[40:43], v[16:19], v[80:83], v[40:43]
  v_max_f32 v48, v48, v49
  v_cmp_lt_f32 vcc, s13, v48
  s_cbranch_vccnz L_rs1
L_rb1:
  v_exp_f32 v32, v32
  v_mfma_f32_16x16x32_bf16 v[44:47], v[16:19], v[84:87], v[44:47]
  ds_read_b128 v[16:19], v2 offset:11264
  v_exp_f32 v36, v36
  v_mfma_f32_16x16x32_bf16 v[40:43], v[20:23], v[88:91], v[40:43]
  v_exp_f32 v33, v33
  v_mfma_f32_16x16x32_bf16 v[44:47], v[20:23], v[92:95], v[44:47]
  s_cmp_eq_u32 s45, 65536
  s_cselect_b32 s11, s61, s62
  s_add_u32 s45, s45, s11
  v_add_u32 v1, s11, v1
  v_add_u32 v2, s11, v2
  ds_read_b128 v[20:23], v1 offset:0
  v_add_f32 v10, v10, v32
  v_exp_f32 v37, v37
  s_waitcnt lgkmcnt(3)
  v_mfma_f32_16x16x32_bf16 v[40:43], v[24:27], v[96:99], v[40:43]
  v_add_f32 v11, v11, v36
  v_exp_f32 v34, v34
  v_mfma_f32_16x16x32_bf16 v[44:47], v[24:27], v[100:103], v[44:47]
  ds_read_b128 v[24:27], v2 offset:0
  v_add_f32 v10, v10, v33
  v_mfma_f32_16x16x32_bf16 v[40:43], v[28:31], v[104:107], v[40:43]
  v_cvt_pk_bf16_f32 v136, v32, v33
  v_exp_f32 v38, v38
  v_mfma_f32_16x16x32_bf16 v[44:47], v[28:31], v[108:111], v[44:47]
  ds_read_b128 v[28:31], v1 offset:1024
  v_add_f32 v11, v11, v37
  v_cvt_pk_bf16_f32 v140, v36, v37
  s_waitcnt lgkmcnt(3)
  v_mfma_f32_16x16x32_bf16 v[40:43], v[12:15], v[112:115], v[40:43]
  v_exp_f32 v35, v35
  v_add_f32 v10, v10, v34
  v_mfma_f32_16x16x32_bf16 v[44:47], v[12:15], v[116:119], v[44:47]
  ds_read_b128 v[12:15], v2 offset:1024
  v_exp_f32 v39, v39
  v_mfma_f32_16x16x32_bf16 v[40:43], v[16:19], v[120:123], v[40:43]
  v_add_f32 v11, v11, v38
  v_add_f32 v10, v10, v35
  v_cvt_pk_bf16_f32 v137, v34, v35
  v_mfma_f32_16x16x32_bf16 v[44:47], v[16:19], v[124:127], v[44:47]
  ds_read_b128 v[16:19], v1 offset:2048
  v_add_f32 v11, v11, v39
  v_cvt_pk_bf16_f32 v141, v38, v39
  s_waitcnt vmcnt(5)
  s_barrier
  s_waitcnt lgkmcnt(3)
  v_mfma_f32_16x16x32_bf16 v[32:35], v[20:23], v[64:67], v[52:55]
  v_mfma_f32_16x16x32_bf16 v[36:39], v[20:23], v[68:71], v[60:63]
  ds_read_b128 v[20:23], v2 offset:2048
  v_mfma_f32_16x16x32_bf16 v[32:35], v[24:27], v[72:75], v[32:35]
  v_max3_f32 v48, v40, v41, v42
  v_max3_f32 v49, v43, v44, v45
  v_max3_f32 v48, v48, v46, v47
  v_mfma_f32_16x16x32_bf16 v[36:39], v[24:27], v[76:79], v[36:39]
  ds_read_b128 v[24:27], v1 offset:3072
  v_max_f32 v48, v48, v49
  v_cmp_lt_f32 vcc, s13, v48
  s_cbranch_vccnz L_rs2
L_rb2:
  s_waitcnt lgkmcnt(3)
  v_mfma_f32_16x16x32_bf16 v[32:35], v[28:31], v[80:83], v[32:35]
  v_exp_f32 v40, v40
  v_exp_f32 v44, v44
  v_mfma_f32_16x16x32_bf16 v[36:39], v[28:31], v[84:87], v[36:39]
  ds_read_b128 v[28:31], v2 offset:3072
  v_exp_f32 v41, v41
  v_mfma_f32_16x16x32_bf16 v[32:35], v[12:15], v[88:91], v[32:35]
  v_add_f32 v10, v10, v40
  v_mfma_f32_16x16x32_bf16 v[36:39], v[12:15], v[92:95], v[36:39]
  ds_read_b128 v[12:15], v1 offset:8192
  v_exp_f32 v45, v45
  v_add_f32 v11, v11, v44
  s_waitcnt lgkmcnt(3)
  v_mfma_f32_16x16x32_bf16 v[32:35], v[16:19], v[96:99], v[32:35]
  v_exp_f32 v42, v42
  v_mfma_f32_16x16x32_bf16 v[36:39], v[16:19], v[100:103], v[36:39]
  ds_read_b128 v[16:19], v2 offset:8192
  v_add_f32 v10, v10, v41
  v_cvt_pk_bf16_f32 v138, v40, v41
  v_mfma_f32_16x16x32_bf16 v[32:35], v[20:23], v[104:107], v[32:35]
  v_exp_f32 v46, v46
  v_add_f32 v11, v11, v45
  v_mfma_f32_16x16x32_bf16 v[36:39], v[20:23], v[108:111], v[36:39]
  ds_read_b128 v[20:23], v1 offset:9216
  v_cvt_pk_bf16_f32 v142, v44, v45
  v_exp_f32 v43, v43
  s_waitcnt lgkmcnt(3)
  v_mfma_f32_16x16x32_bf16 v[32:35], v[24:27], v[112:115], v[32:35]
  v_add_f32 v10, v10, v42
  v_mfma_f32_16x16x32_bf16 v[36:39], v[24:27], v[116:119], v[36:39]
  ds_read_b128 v[24:27], v2 offset:9216
  v_exp_f32 v47, v47
  v_add_f32 v11, v11, v46
  v_mfma_f32_16x16x32_bf16 v[32:35], v[28:31], v[120:123], v[32:35]
  v_add_f32 v10, v10, v43
  v_cvt_pk_bf16_f32 v139, v42, v43
  v_mfma_f32_16x16x32_bf16 v[36:39], v[28:31], v[124:127], v[36:39]
  ds_read_b128 v[28:31], v1 offset:10240
  v_add_f32 v11, v11, v47
  v_cvt_pk_bf16_f32 v143, v46, v47
  s_waitcnt lgkmcnt(3)
  v_mfma_f32_16x16x32_bf16 v[40:43], v[12:15], v[64:67], v[52:55]
  v_mfma_f32_16x16x32_bf16 v[44:47], v[12:15], v[68:71], v[60:63]
  ds_read_b128 v[12:15], v2 offset:10240
  v_mfma_f32_16x16x32_bf16 v[40:43], v[16:19], v[72:75], v[40:43]
  v_mfma_f32_16x16x32_bf16 v[44:47], v[16:19], v[76:79], v[44:47]
  ds_read_b128 v[16:19], v1 offset:11264
  v_max3_f32 v48, v32, v33, v34
  v_max3_f32 v49, v35, v36, v37
  v_max3_f32 v48, v48, v38, v39
  s_waitcnt lgkmcnt(3)
  v_mfma_f32_16x16x32_bf16 v[40:43], v[20:23], v[80:83], v[40:43]
  v_max_f32 v48, v48, v49
  v_cmp_lt_f32 vcc, s13, v48
  s_cbranch_vccnz L_rs3
L_rb3:
  v_exp_f32 v32, v32
  v_mfma_f32_16x16x32_bf16 v[44:47], v[20:23], v[84:87], v[44:47]
  ds_read_b128 v[20:23], v2 offset:11264
  v_exp_f32 v36, v36
  v_mfma_f32_16x16x32_bf16 v[40:43], v[24:27], v[88:91], v[40:43]
  v_exp_f32 v33, v33
  v_mfma_f32_16x16x32_bf16 v[44:47], v[24:27], v[92:95], v[44:47]
  s_cmp_eq_u32 s45, 65536
  s_cselect_b32 s11, s61, s62
  s_add_u32 s45, s45, s11
  v_add_u32 v1, s11, v1
  v_add_u32 v2, s11, v2
  ds_read_b128 v[24:27], v1 offset:0
  v_add_f32 v10, v10, v32
  v_exp_f32 v37, v37
  s_waitcnt lgkmcnt(3)
  v_mfma_f32_16x16x32_bf16 v[40:43], v[28:31], v[96:99], v[40:43]
  v_add_f32 v11, v11, v36
  v_exp_f32 v34, v34
  v_mfma_f32_16x16x32_bf16 v[44:47], v[28:31], v[100:103], v[44:47]
  ds_read_b128 v[28:31], v2 offset:0
  v_add_f32 v10, v10, v33
  v_mfma_f32_16x16x32_bf16 v[40:43], v[12:15], v[104:107], v[40:43]
  v_cvt_pk_bf16_f32 v144, v32, v33
  v_exp_f32 v38, v38
  v_mfma_f32_16x16x32_bf16 v[44:47], v[12:15], v[108:111], v[44:47]
  ds_read_b128 v[12:15], v1 offset:1024
  v_add_f32 v11, v11, v37
  v_cvt_pk_bf16_f32 v148, v36, v37
  s_waitcnt lgkmcnt(3)
  v_mfma_f32_16x16x32_bf16 v[40:43], v[16:19], v[112:115], v[40:43]
  v_exp_f32 v35, v35
  v_add_f32 v10, v10, v34
  v_mfma_f32_16x16x32_bf16 v[44:47], v[16:19], v[116:119], v[44:47]
  ds_read_b128 v[16:19], v2 offset:1024
  v_exp_f32 v39, v39
  v_mfma_f32_16x16x32_bf16 v[40:43], v[20:23], v[120:123], v[40:43]
  v_add_f32 v11, v11, v38
  v_add_f32 v10, v10, v35
  v_cvt_pk_bf16_f32 v145, v34, v35
  v_mfma_f32_16x16x32_bf16 v[44:47], v[20:23], v[124:127], v[44:47]
  ds_read_b128 v[20:23], v1 offset:2048
  v_add_f32 v11, v11, v39
  v_cvt_pk_bf16_f32 v149, v38, v39
  s_waitcnt vmcnt(1)
  s_barrier
  s_waitcnt lgkmcnt(3)
  v_mfma_f32_16x16x32_bf16 v[32:35], v[24:27], v[64:67], v[52:55]
  v_mfma_f32_16x16x32_bf16 v[36:39], v[24:27], v[68:71], v[60:63]
  ds_read_b128 v[24:27], v2 offset:2048
  v_mfma_f32_16x16x32_bf16 v[32:35], v[28:31], v[72:75], v[32:35]
  v_max3_f32 v48, v40, v41, v42
  v_max3_f32 v49, v43, v44, v45
  v_max3_f32 v48, v48, v46, v47
  v_mfma_f32_16x16x32_bf16 v[36:39], v[28:31], v[76:79], v[36:39]
  ds_read_b128 v[28:31], v1 offset:3072
  v_max_f32 v48, v48, v49
  v_cmp_lt_f32 vcc, s13, v48
  s_cbranch_vccnz L_rs4
L_rb4:
  s_waitcnt lgkmcnt(3)
  v_mfma_f32_16x16x32_bf16 v[32:35], v[12:15], v[80:83], v[32:35]
  v_exp_f32 v40, v40
  v_exp_f32 v44, v44
  v_mfma_f32_16x16x32_bf16 v[36:39], v[12:15], v[84:87], v[36:39]
  ds_read_b128 v[12:15], v2 offset:3072
  v_exp_f32 v41, v41
  v_mfma_f32_16x16x32_bf16 v[32:35], v[16:19], v[88:91], v[32:35]
  v_add_f32 v10, v10, v40
  v_mfma_f32_16x16x32_bf16 v[36:39], v[16:19], v[92:95], v[36:39]
  ds_read_b128 v[16:19], v1 offset:8192
  v_exp_f32 v45, v45
  v_add_f32 v11, v11, v44
  s_waitcnt lgkmcnt(3)
  v_mfma_f32_16x16x32_bf16 v[32:35], v[20:23], v[96:99], v[32:35]
  v_exp_f32 v42, v42
  v_mfma_f32_16x16x32_bf16 v[36:39], v[20:23], v[100:103], v[36:39]
  ds_read_b128 v[20:23], v2 offset:8192
  v_add_f32 v10, v10, v41
  v_cvt_pk_bf16_f32 v146, v40, v41
  v_mfma_f32_16x16x32_bf16 v[32:35], v[24:27], v[104:107], v[32:35]
  v_exp_f32 v46, v46
  v_add_f32 v11, v11, v45
  v_mfma_f32_16x16x32_bf16 v[36:39], v[24:27], v[108:111], v[36:39]
  ds_read_b128 v[24:27], v1 offset:9216
  v_cvt_pk_bf16_f32 v150, v44, v45
  v_exp_f32 v43, v43
  s_waitcnt lgkmcnt(3)
  v_mfma_f32_16x16x32_bf16 v[32:35], v[28:31], v[112:115], v[32:35]
  v_add_f32 v10, v10, v42
  v_mfma_f32_16x16x32_bf16 v[36:39], v[28:31], v[116:119], v[36:39]
  ds_read_b128 v[28:31], v2 offset:9216
  v_exp_f32 v47, v47
  v_add_f32 v11, v11, v46
  v_mfma_f32_16x16x32_bf16 v[32:35], v[12:15], v[120:123], v[32:35]
  v_add_f32 v10, v10, v43
  v_cvt_pk_bf16_f32 v147, v42, v43
  v_mfma_f32_16x16x32_bf16 v[36:39], v[12:15], v[124:127], v[36:39]
  ds_read_b128 v[12:15], v1 offset:10240
  v_add_f32 v11, v11, v47
  v_cvt_pk_bf16_f32 v151, v46, v47
  s_waitcnt lgkmcnt(3)
  v_mfma_f32_16x16x32_bf16 v[40:43], v[16:19], v[64:67], v[52:55]
  v_mfma_f32_16x16x32_bf16 v[44:47], v[16:19], v[68:71], v[60:63]
  ds_read_b128 v[16:19], v2 offset:10240
  v_mfma_f32_16x16x32_bf16 v[40:43], v[20:23], v[72:75], v[40:43]
  v_mfma_f32_16x16x32_bf16 v[44:47], v[20:23], v[76:79], v[44:47]
  ds_read_b128 v[20:23], v1 offset:11264
  v_max3_f32 v48, v32, v33, v34
  v_max3_f32 v49, v35, v36, v37
  v_max3_f32 v48, v48, v38, v39
  s_waitcnt lgkmcnt(3)
  v_mfma_f32_16x16x32_bf16 v[40:43], v[24:27], v[80:83], v[40:43]
  v_max_f32 v48, v48, v49
  v_cmp_lt_f32 vcc, s13, v48
  s_cbranch_vccnz L_rs5
L_rb5:
  v_exp_f32 v32, v32
  v_mfma_f32_16x16x32_bf16 v[44:47], v[24:27], v[84:87], v[44:47]
  ds_read_b128 v[24:27], v2 offset:11264
  v_exp_f32 v36, v36
  v_mfma_f32_16x16x32_bf16 v[40:43], v[28:31], v[88:91], v[40:43]
  v_exp_f32 v33, v33
  v_mfma_f32_16x16x32_bf16 v[44:47], v[28:31], v[92:95], v[44:47]
  s_cmp_eq_u32 s45, 65536
  s_cselect_b32 s11, s61, s62
  s_add_u32 s45, s45, s11
  v_add_u32 v1, s11, v1
  v_add_u32 v2, s11, v2
  ds_read_b128 v[28:31], v1 offset:0
  v_add_f32 v10, v10, v32
  v_exp_f32 v37, v37
  s_waitcnt lgkmcnt(3)
  v_mfma_f32_16x16x32_bf16 v[40:43], v[12:15], v[96:99], v[40:43]
  v_add_f32 v11, v11, v36
  v_exp_f32 v34, v34
  v_mfma_f32_16x16x32_bf16 v[44:47], v[12:15], v[100:103], v[44:47]
  ds_read_b128 v[12:15], v2 offset:0
  v_add_f32 v10, v10, v33
  v_mfma_f32_16x16x32_bf16 v[40:43], v[16:19], v[104:107], v[40:43]
  v_cvt_pk_bf16_f32 v152, v32, v33
  v_exp_f32 v38, v38
  v_mfma_f32_16x16x32_bf16 v[44:47], v[16:19], v[108:111], v[44:47]
  ds_read_b128 v[16:19], v1 offset:1024
  v_add_f32 v11, v11, v37
  v_cvt_pk_bf16_f32 v156, v36, v37
  s_waitcnt lgkmcnt(3)
  v_mfma_f32_16x16x32_bf16 v[40:43], v[20:23], v[112:115], v[40:43]
  v_exp_f32 v35, v35
  v_add_f32 v10, v10, v34
  v_mfma_f32_16x16x32_bf16 v[44:47], v[20:23], v[116:119], v[44:47]
  ds_read_b128 v[20:23], v2 offset:1024
  v_exp_f32 v39, v39
  v_mfma_f32_16x16x32_bf16 v[40:43], v[24:27], v[120:123], v[40:43]
  v_add_f32 v11, v11, v38
  v_add_f32 v10, v10, v35
  v_cvt_pk_bf16_f32 v153, v34, v35
  v_mfma_f32_16x16x32_bf16 v[44:47], v[24:27], v[124:127], v[44:47]
  ds_read_b128 v[24:27], v1 offset:2048
  v_add_f32 v11, v11, v39
  v_cvt_pk_bf16_f32 v157, v38, v39
  s_barrier
  s_waitcnt lgkmcnt(3)
  v_mfma_f32_16x16x32_bf16 v[32:35], v[28:31], v[64:67], v[52:55]
  s_mov_b64 exec, s[48:49]
  ds_write_b128 v7, v[176:179] offset:0
  s_mov_b64 exec, -1
  v_mfma_f32_16x16x32_bf16 v[36:39], v[28:31], v[68:71], v[60:63]
  ds_read_b128 v[28:31], v2 offset:2048
  s_mov_b64 exec, s[48:49]
  ds_write_b128 v7, v[180:183] offset:1024
  s_mov_b64 exec, -1
  v_mfma_f32_16x16x32_bf16 v[32:35], v[12:15], v[72:75], v[32:35]
  s_mov_b64 exec, s[48:49]
  ds_write_b128 v7, v[184:187] offset:8192
  s_mov_b64 exec, -1
  v_max3_f32 v48, v40, v41, v42
  v_max3_f32 v49, v43, v44, v45
  v_max3_f32 v48, v48, v46, v47
  v_mfma_f32_16x16x32_bf16 v[36:39], v[12:15], v[76:79], v[36:39]
  ds_read_b128 v[12:15], v1 offset:3072
  s_mov_b64 exec, s[48:49]
  ds_write_b128 v7, v[188:191] offset:9216
  s_mov_b64 exec, -1
  v_max_f32 v48, v48, v49
  v_cmp_lt_f32 vcc, s13, v48
  s_cbranch_vccnz L_rs6
L_rb6:
  s_waitcnt lgkmcnt(7)
  v_mfma_f32_16x16x32_bf16 v[32:35], v[16:19], v[80:83], v[32:35]
  v_exp_f32 v40, v40
  v_exp_f32 v44, v44
  v_mfma_f32_16x16x32_bf16 v[36:39], v[16:19], v[84:87], v[36:39]
  ds_read_b128 v[16:19], v2 offset:3072
  v_exp_f32 v41, v41
  v_mfma_f32_16x16x32_bf16 v[32:35], v[20:23], v[88:91], v[32:35]
  v_add_f32 v10, v10, v40
  v_mfma_f32_16x16x32_bf16 v[36:39], v[20:23], v[92:95], v[36:39]
  ds_read_b128 v[20:23], v1 offset:8192
  v_exp_f32 v45, v45
  v_add_f32 v11, v11, v44
  s_waitcnt lgkmcnt(6)
  v_mfma_f32_16x16x32_bf16 v[32:35], v[24:27], v[96:99], v[32:35]
  v_exp_f32 v42, v42
  v_mfma_f32_16x16x32_bf16 v[36:39], v[24:27], v[100:103], v[36:39]
  ds_read_b128 v[24:27], v2 offset:8192
  v_add_f32 v10, v10, v41
  v_cvt_pk_bf16_f32 v154, v40, v41
  v_mfma_f32_16x16x32_bf16 v[32:35], v[28:31], v[104:107], v[32:35]
  v_exp_f32 v46, v46
  v_add_f32 v11, v11, v45
  v_mfma_f32_16x16x32_bf16 v[36:39], v[28:31], v[108:111], v[36:39]
  ds_read_b128 v[28:31], v1 offset:9216
  v_cvt_pk_bf16_f32 v158, v44, v45
  v_exp_f32 v43, v43
  s_waitcnt lgkmcnt(3)
  v_mfma_f32_16x16x32_bf16 v[32:35], v[12:15], v[112:115], v[32:35]
  v_add_f32 v10, v10, v42
  v_mfma_f32_16x16x32_bf16 v[36:39], v[12:15], v[116:119], v[36:39]
  ds_read_b128 v[12:15], v2 offset:9216
  v_exp_f32 v47, v47
  v_add_f32 v11, v11, v46
  v_mfma_f32_16x16x32_bf16 v[32:35], v[16:19], v[120:123], v[32:35]
  v_add_f32 v10, v10, v43
  v_cvt_pk_bf16_f32 v155, v42, v43
  v_mfma_f32_16x16x32_bf16 v[36:39], v[16:19], v[124:127], v[36:39]
  ds_read_b128 v[16:19], v1 offset:10240
  v_add_f32 v11, v11, v47
  v_cvt_pk_bf16_f32 v159, v46, v47
  s_waitcnt lgkmcnt(3)
  v_mfma_f32_16x16x32_bf16 v[40:43], v[20:23], v[64:67], v[52:55]
  v_mfma_f32_16x16x32_bf16 v[44:47], v[20:23], v[68:71], v[60:63]
  ds_read_b128 v[20:23], v2 offset:10240
  v_mfma_f32_16x16x32_bf16 v[40:43], v[24:27], v[72:75], v[40:43]
  v_mfma_f32_16x16x32_bf16 v[44:47], v[24:27], v[76:79], v[44:47]
  ds_read_b128 v[24:27], v1 offset:11264
  v_max3_f32 v48, v32, v33, v34
  v_max3_f32 v49, v35, v36, v37
  v_max3_f32 v48, v48, v38, v39
  s_waitcnt lgkmcnt(3)
  v_mfma_f32_16x16x32_bf16 v[40:43], v[28:31], v[80:83], v[40:43]
  v_max_f32 v48, v48, v49
  v_cmp_lt_f32 vcc, s13, v48
  s_cbranch_vccnz L_rs7
L_rb7:
  v_exp_f32 v32, v32
  v_mfma_f32_16x16x32_bf16 v[44:47], v[28:31], v[84:87], v[44:47]
  ds_read_b128 v[28:31], v2 offset:11264
  v_exp_f32 v36, v36
  v_mfma_f32_16x16x32_bf16 v[40:43], v[12:15], v[88:91], v[40:43]
  v_exp_f32 v33, v33
  v_mfma_f32_16x16x32_bf16 v[44:47], v[12:15], v[92:95], v[44:47]
  s_cmp_eq_u32 s45, 65536
  s_cselect_b32 s11, s61, s62
  s_add_u32 s45, s45, s11
  v_add_u32 v1, s11, v1
  v_add_u32 v2, s11, v2
  ds_read_b128 v[12:15], v1 offset:0
  v_add_f32 v10, v10, v32
  v_exp_f32 v37, v37
  s_waitcnt lgkmcnt(3)
  v_mfma_f32_16x16x32_bf16 v[40:43], v[16:19], v[96:99], v[40:43]
  v_add_f32 v11, v11, v36
  v_exp_f32 v34, v34
  v_mfma_f32_16x16x32_bf16 v[44:47], v[16:19], v[100:103], v[44:47]
  ds_read_b128 v[16:19], v2 offset:0
  v_add_f32 v10, v10, v33
  v_mfma_f32_16x16x32_bf16 v[40:43], v[20:23], v[104:107], v[40:43]
  v_cvt_pk_bf16_f32 v160, v32, v33
  v_exp_f32 v38, v38
  v_mfma_f32_16x16x32_bf16 v[44:47], v[20:23], v[108:111], v[44:47]
  ds_read_b128 v[20:23], v1 offset:1024
  v_add_f32 v11, v11, v37
  v_cvt_pk_bf16_f32 v164, v36, v37
  s_waitcnt lgkmcnt(3)
  v_mfma_f32_16x16x32_bf16 v[40:43], v[24:27], v[112:115], v[40:43]
  v_exp_f32 v35, v35
  v_add_f32 v10, v10, v34
  v_mfma_f32_16x16x32_bf16 v[44:47], v[24:27], v[116:119], v[44:47]
  ds_read_b128 v[24:27], v2 offset:1024
  v_exp_f32 v39, v39
  v_mfma_f32_16x16x32_bf16 v[40:43], v[28:31], v[120:123], v[40:43]
  v_add_f32 v11, v11, v38
  v_add_f32 v10, v10, v35
  v_cvt_pk_bf16_f32 v161, v34, v35
  v_mfma_f32_16x16x32_bf16 v[44:47], v[28:31], v[124:127], v[44:47]
  ds_read_b128 v[28:31], v1 offset:2048
  v_add_f32 v11, v11, v39
  v_cvt_pk_bf16_f32 v165, v38, v39
  s_waitcnt vmcnt(0)
  s_barrier
  s_waitcnt lgkmcnt(3)
  v_mfma_f32_16x16x32_bf16 v[32:35], v[12:15], v[64:67], v[52:55]
  v_mfma_f32_16x16x32_bf16 v[36:39], v[12:15], v[68:71], v[60:63]
  ds_read_b128 v[12:15], v2 offset:2048
  v_mfma_f32_16x16x32_bf16 v[32:35], v[16:19], v[72:75], v[32:35]
  v_max3_f32 v48, v40, v41, v42
  v_max3_f32 v49, v43, v44, v45
  v_max3_f32 v48, v48, v46, v47
  v_mfma_f32_16x16x32_bf16 v[36:39], v[16:19], v[76:79], v[36:39]
  ds_read_b128 v[16:19], v1 offset:3072
  v_max_f32 v48, v48, v49
  v_cmp_lt_f32 vcc, s13, v48
  s_cbranch_vccnz L_rs8
L_rb8:
  s_waitcnt lgkmcnt(3)
  v_mfma_f32_16x16x32_bf16 v[32:35], v[20:23], v[80:83], v[32:35]
  v_exp_f32 v40, v40
  v_exp_f32 v44, v44
  v_mfma_f32_16x16x32_bf16 v[36:39], v[20:23], v[84:87], v[36:39]
  ds_read_b128 v[20:23], v2 offset:3072
  v_exp_f32 v41, v41
  v_mfma_f32_16x16x32_bf16 v[32:35], v[24:27], v[88:91], v[32:35]
  v_add_f32 v10, v10, v40
  v_mfma_f32_16x16x32_bf16 v[36:39], v[24:27], v[92:95], v[36:39]
  ds_read_b128 v[24:27], v1 offset:8192
  v_exp_f32 v45, v45
  v_add_f32 v11, v11, v44
  s_waitcnt lgkmcnt(3)
  v_mfma_f32_16x16x32_bf16 v[32:35], v[28:31], v[96:99], v[32:35]
  v_exp_f32 v42, v42
  v_mfma_f32_16x16x32_bf16 v[36:39], v[28:31], v[100:103], v[36:39]
  ds_read_b128 v[28:31], v2 offset:8192
  v_add_f32 v10, v10, v41
  v_cvt_pk_bf16_f32 v162, v40, v41
  v_mfma_f32_16x16x32_bf16 v[32:35], v[12:15], v[104:107], v[32:35]
  v_exp_f32 v46, v46
  v_add_f32 v11, v11, v45
  v_mfma_f32_16x16x32_bf16 v[36:39], v[12:15], v[108:111], v[36:39]
  ds_read_b128 v[12:15], v1 offset:9216
  v_cvt_pk_bf16_f32 v166, v44, v45
  v_exp_f32 v43, v43
  s_waitcnt lgkmcnt(3)
  v_mfma_f32_16x16x32_bf16 v[32:35], v[16:19], v[112:115], v[32:35]
  v_add_f32 v10, v10, v42
  v_mfma_f32_16x16x32_bf16 v[36:39], v[16:19], v[116:119], v[36:39]
  ds_read_b128 v[16:19], v2 offset:9216
  v_exp_f32 v47, v47
  v_add_f32 v11, v11, v46
  v_mfma_f32_16x16x32_bf16 v[32:35], v[20:23], v[120:123], v[32:35]
  v_add_f32 v10, v10, v43
  v_cvt_pk_bf16_f32 v163, v42, v43
  v_mfma_f32_16x16x32_bf16 v[36:39], v[20:23], v[124:127], v[36:39]
  ds_read_b128 v[20:23], v1 offset:10240
  v_add_f32 v11, v11, v47
  v_cvt_pk_bf16_f32 v167, v46, v47
  s_waitcnt lgkmcnt(3)
  v_mfma_f32_16x16x32_bf16 v[40:43], v[24:27], v[64:67], v[52:55]
  v_mfma_f32_16x16x32_bf16 v[44:47], v[24:27], v[68:71], v[60:63]
  ds_read_b128 v[24:27], v2 offset:10240
  v_mfma_f32_16x16x32_bf16 v[40:43], v[28:31], v[72:75], v[40:43]
  v_mfma_f32_16x16x32_bf16 v[44:47], v[28:31], v[76:79], v[44:47]
  ds_read_b128 v[28:31], v1 offset:11264
  v_max3_f32 v48, v32, v33, v34
  v_max3_f32 v49, v35, v36, v37
  v_max3_f32 v48, v48, v38, v39
  s_waitcnt lgkmcnt(3)
  v_mfma_f32_16x16x32_bf16 v[40:43], v[12:15], v[80:83], v[40:43]
  v_max_f32 v48, v48, v49
  v_cmp_lt_f32 vcc, s13, v48
  s_cbranch_vccnz L_rs9
L_rb9:
  v_exp_f32 v32, v32
  v_mfma_f32_16x16x32_bf16 v[44:47], v[12:15], v[84:87], v[44:47]
  ds_read_b128 v[12:15], v2 offset:11264
  v_exp_f32 v36, v36
  v_mfma_f32_16x16x32_bf16 v[40:43], v[16:19], v[88:91], v[40:43]
  v_exp_f32 v33, v33
  v_mfma_f32_16x16x32_bf16 v[44:47], v[16:19], v[92:95], v[44:47]
  s_cmp_eq_u32 s45, 65536
  s_cselect_b32 s11, s61, s62
  s_add_u32 s45, s45, s11
  v_add_u32 v1, s11, v1
  v_add_u32 v2, s11, v2
  ds_read_b128 v[16:19], v1 offset:0
  v_add_f32 v10, v10, v32
  v_exp_f32 v37, v37
  s_waitcnt lgkmcnt(3)
  v_mfma_f32_16x16x32_bf16 v[40:43], v[20:23], v[96:99], v[40:43]
  v_add_f32 v11, v11, v36
  v_exp_f32 v34, v34
  v_mfma_f32_16x16x32_bf16 v[44:47], v[20:23], v[100:103], v[44:47]
  ds_read_b128 v[20:23], v2 offset:0
  v_add_f32 v10, v10, v33
  v_mfma_f32_16x16x32_bf16 v[40:43], v[24:27], v[104:107], v[40:43]
  v_cvt_pk_bf16_f32 v168, v32, v33
  v_exp_f32 v38, v38
  v_mfma_f32_16x16x32_bf16 v[44:47], v[24:27], v[108:111], v[44:47]
  ds_read_b128 v[24:27], v1 offset:1024
  v_add_f32 v11, v11, v37
  v_cvt_pk_bf16_f32 v172, v36, v37
  s_waitcnt lgkmcnt(3)
  v_mfma_f32_16x16x32_bf16 v[40:43], v[28:31], v[112:115], v[40:43]
  v_exp_f32 v35, v35
  v_add_f32 v10, v10, v34
  v_mfma_f32_16x16x32_bf16 v[44:47], v[28:31], v[116:119], v[44:47]
  ds_read_b128 v[28:31], v2 offset:1024
  v_exp_f32 v39, v39
  v_mfma_f32_16x16x32_bf16 v[40:43], v[12:15], v[120:123], v[40:43]
  v_add_f32 v11, v11, v38
  v_add_f32 v10, v10, v35
  v_cvt_pk_bf16_f32 v169, v34, v35
  v_mfma_f32_16x16x32_bf16 v[44:47], v[12:15], v[124:127], v[44:47]
  ds_read_b128 v[12:15], v1 offset:2048
  v_add_f32 v11, v11, v39
  v_cvt_pk_bf16_f32 v173, v38, v39
  s_barrier
  s_waitcnt lgkmcnt(3)
  v_mfma_f32_16x16x32_bf16 v[32:35], v[16:19], v[64:67], v[52:55]
  v_mfma_f32_16x16x32_bf16 v[36:39], v[16:19], v[68:71], v[60:63]
  ds_read_b128 v[16:19], v2 offset:2048
  v_mfma_f32_16x16x32_bf16 v[32:35], v[20:23], v[72:75], v[32:35]
  v_max3_f32 v48, v40, v41, v42
  v_max3_f32 v49, v43, v44, v45
  v_max3_f32 v48, v48, v46, v47
  v_mfma_f32_16x16x32_bf16 v[36:39], v[20:23], v[76:79], v[36:39]
  ds_read_b128 v[20:23], v1 offset:3072
  v_max_f32 v48, v48, v49
  v_cmp_lt_f32 vcc, s13, v48
  s_cbranch_vccnz L_rs10
L_rb10:
  s_waitcnt lgkmcnt(3)
  v_mfma_f32_16x16x32_bf16 v[32:35], v[24:27], v[80:83], v[32:35]
  v_exp_f32 v40, v40
  v_exp_f32 v44, v44
  v_mfma_f32_16x16x32_bf16 v[36:39], v[24:27], v[84:87], v[36:39]
  ds_read_b128 v[24:27], v2 offset:3072
  v_exp_f32 v41, v41
  v_mfma_f32_16x16x32_bf16 v[32:35], v[28:31], v[88:91], v[32:35]
  v_add_f32 v10, v10, v40
  v_mfma_f32_16x16x32_bf16 v[36:39], v[28:31], v[92:95], v[36:39]
  ds_read_b128 v[28:31], v1 offset:8192
  v_exp_f32 v45, v45
  v_add_f32 v11, v11, v44
  s_waitcnt lgkmcnt(3)
  v_mfma_f32_16x16x32_bf16 v[32:35], v[12:15], v[96:99], v[32:35]
  v_exp_f32 v42, v42
  v_mfma_f32_16x16x32_bf16 v[36:39], v[12:15], v[100:103], v[36:39]
  ds_read_b128 v[12:15], v2 offset:8192
  v_add_f32 v10, v10, v41
  v_cvt_pk_bf16_f32 v170, v40, v41
  v_mfma_f32_16x16x32_bf16 v[32:35], v[16:19], v[104:107], v[32:35]
  v_exp_f32 v46, v46
  v_add_f32 v11, v11, v45
  v_mfma_f32_16x16x32_bf16 v[36:39], v[16:19], v[108:111], v[36:39]
  ds_read_b128 v[16:19], v1 offset:9216
  v_cvt_pk_bf16_f32 v174, v44, v45
  v_exp_f32 v43, v43
  s_waitcnt lgkmcnt(3)
  v_mfma_f32_16x16x32_bf16 v[32:35], v[20:23], v[112:115], v[32:35]
  v_add_f32 v10, v10, v42
  v_mfma_f32_16x16x32_bf16 v[36:39], v[20:23], v[116:119], v[36:39]
  ds_read_b128 v[20:23], v2 offset:9216
  v_exp_f32 v47, v47
  v_add_f32 v11, v11, v46
  v_mfma_f32_16x16x32_bf16 v[32:35], v[24:27], v[120:123], v[32:35]
  v_add_f32 v10, v10, v43
  v_cvt_pk_bf16_f32 v171, v42, v43
  v_mfma_f32_16x16x32_bf16 v[36:39], v[24:27], v[124:127], v[36:39]
  ds_read_b128 v[24:27], v1 offset:10240
  v_add_f32 v11, v11, v47
  v_cvt_pk_bf16_f32 v175, v46, v47
  s_waitcnt lgkmcnt(3)
  v_mfma_f32_16x16x32_bf16 v[40:43], v[28:31], v[64:67], v[52:55]
  v_mfma_f32_16x16x32_bf16 v[44:47], v[28:31], v[68:71], v[60:63]
  ds_read_b128 v[28:31], v2 offset:10240
  v_mfma_f32_16x16x32_bf16 v[40:43], v[12:15], v[72:75], v[40:43]
  v_mfma_f32_16x16x32_bf16 v[44:47], v[12:15], v[76:79], v[44:47]
  ds_read_b128 v[12:15], v1 offset:11264
  v_max3_f32 v48, v32, v33, v34
  v_max3_f32 v49, v35, v36, v37
  v_max3_f32 v48, v48, v38, v39
  s_waitcnt lgkmcnt(3)
  v_mfma_f32_16x16x32_bf16 v[40:43], v[16:19], v[80:83], v[40:43]
  v_max_f32 v48, v48, v49
  v_cmp_lt_f32 vcc, s13, v48
  s_cbranch_vccnz L_rs11
L_rb11:
  v_exp_f32 v32, v32
  v_mfma_f32_16x16x32_bf16 v[44:47], v[16:19], v[84:87], v[44:47]
  ds_read_b128 v[16:19], v2 offset:11264
  v_exp_f32 v36, v36
  v_mfma_f32_16x16x32_bf16 v[40:43], v[20:23], v[88:91], v[40:43]
  v_exp_f32 v33, v33
  v_mfma_f32_16x16x32_bf16 v[44:47], v[20:23], v[92:95], v[44:47]
  s_cmp_eq_u32 s45, 65536
  s_cselect_b32 s11, s61, s62
  s_add_u32 s45, s45, s11
  v_add_u32 v1, s11, v1
  v_add_u32 v2, s11, v2
  ds_read_b128 v[20:23], v1 offset:0
  v_add_f32 v10, v10, v32
  v_exp_f32 v37, v37
  s_waitcnt lgkmcnt(3)
  v_mfma_f32_16x16x32_bf16 v[40:43], v[24:27], v[96:99], v[40:43]
  v_add_f32 v11, v11, v36
  v_exp_f32 v34, v34
  v_mfma_f32_16x16x32_bf16 v[44:47], v[24:27], v[100:103], v[44:47]
  ds_read_b128 v[24:27], v2 offset:0
  v_add_f32 v10, v10, v33
  v_mfma_f32_16x16x32_bf16 v[40:43], v[28:31], v[104:107], v[40:43]
  v_cvt_pk_bf16_f32 v176, v32, v33
  v_exp_f32 v38, v38
  v_mfma_f32_16x16x32_bf16 v[44:47], v[28:31], v[108:111], v[44:47]
  ds_read_b128 v[28:31], v1 offset:1024
  v_add_f32 v11, v11, v37
  v_cvt_pk_bf16_f32 v180, v36, v37
  s_waitcnt lgkmcnt(3)
  v_mfma_f32_16x16x32_bf16 v[40:43], v[12:15], v[112:115], v[40:43]
  v_exp_f32 v35, v35
  v_add_f32 v10, v10, v34
  v_mfma_f32_16x16x32_bf16 v[44:47], v[12:15], v[116:119], v[44:47]
  ds_read_b128 v[12:15], v2 offset:1024
  v_exp_f32 v39, v39
  v_mfma_f32_16x16x32_bf16 v[40:43], v[16:19], v[120:123], v[40:43]
  v_add_f32 v11, v11, v38
  v_add_f32 v10, v10, v35
  v_cvt_pk_bf16_f32 v177, v34, v35
  v_mfma_f32_16x16x32_bf16 v[44:47], v[16:19], v[124:127], v[44:47]
  ds_read_b128 v[16:19], v1 offset:2048
  v_add_f32 v11, v11, v39
  v_cvt_pk_bf16_f32 v181, v38, v39
  s_barrier
  s_waitcnt lgkmcnt(3)
  v_mfma_f32_16x16x32_bf16 v[32:35], v[20:23], v[64:67], v[52:55]
  v_mfma_f32_16x16x32_bf16 v[36:39], v[20:23], v[68:71], v[60:63]
  ds_read_b128 v[20:23], v2 offset:2048
  v_mfma_f32_16x16x32_bf16 v[32:35], v[24:27], v[72:75], v[32:35]
  v_max3_f32 v48, v40, v41, v42
  v_max3_f32 v49, v43, v44, v45
  v_max3_f32 v48, v48, v46, v47
  v_mfma_f32_16x16x32_bf16 v[36:39], v[24:27], v[76:79], v[36:39]
  ds_read_b128 v[24:27], v1 offset:3072
  v_max_f32 v48, v48, v49
  v_cmp_lt_f32 vcc, s13, v48
  s_cbranch_vccnz L_rs12
L_rb12:
  s_waitcnt lgkmcnt(3)
  v_mfma_f32_16x16x32_bf16 v[32:35], v[28:31], v[80:83], v[32:35]
  v_exp_f32 v40, v40
  v_exp_f32 v44, v44
  v_mfma_f32_16x16x32_bf16 v[36:39], v[28:31], v[84:87], v[36:39]
  ds_read_b128 v[28:31], v2 offset:3072
  v_exp_f32 v41, v41
  v_mfma_f32_16x16x32_bf16 v[32:35], v[12:15], v[88:91], v[32:35]
  v_add_f32 v10, v10, v40
  v_mfma_f32_16x16x32_bf16 v[36:39], v[12:15], v[92:95], v[36:39]
  ds_read_b128 v[12:15], v1 offset:8192
  v_exp_f32 v45, v45
  v_add_f32 v11, v11, v44
  s_waitcnt lgkmcnt(3)
  v_mfma_f32_16x16x32_bf16 v[32:35], v[16:19], v[96:99], v[32:35]
  v_exp_f32 v42, v42
  v_mfma_f32_16x16x32_bf16 v[36:39], v[16:19], v[100:103], v[36:39]
  ds_read_b128 v[16:19], v2 offset:8192
  v_add_f32 v10, v10, v41
  v_cvt_pk_bf16_f32 v178, v40, v41
  v_mfma_f32_16x16x32_bf16 v[32:35], v[20:23], v[104:107], v[32:35]
  v_exp_f32 v46, v46
  v_add_f32 v11, v11, v45
  v_mfma_f32_16x16x32_bf16 v[36:39], v[20:23], v[108:111], v[36:39]
  ds_read_b128 v[20:23], v1 offset:9216
  v_cvt_pk_bf16_f32 v182, v44, v45
  v_exp_f32 v43, v43
  s_waitcnt lgkmcnt(3)
  v_mfma_f32_16x16x32_bf16 v[32:35], v[24:27], v[112:115], v[32:35]
  v_add_f32 v10, v10, v42
  v_mfma_f32_16x16x32_bf16 v[36:39], v[24:27], v[116:119], v[36:39]
  ds_read_b128 v[24:27], v2 offset:9216
  v_exp_f32 v47, v47
  v_add_f32 v11, v11, v46
  v_mfma_f32_16x16x32_bf16 v[32:35], v[28:31], v[120:123], v[32:35]
  v_add_f32 v10, v10, v43
  v_cvt_pk_bf16_f32 v179, v42, v43
  v_mfma_f32_16x16x32_bf16 v[36:39], v[28:31], v[124:127], v[36:39]
  ds_read_b128 v[28:31], v1 offset:10240
  v_add_f32 v11, v11, v47
  v_cvt_pk_bf16_f32 v183, v46, v47
  s_waitcnt lgkmcnt(3)
  v_mfma_f32_16x16x32_bf16 v[40:43], v[12:15], v[64:67], v[52:55]
  v_mfma_f32_16x16x32_bf16 v[44:47], v[12:15], v[68:71], v[60:63]
  ds_read_b128 v[12:15], v2 offset:10240
  v_mfma_f32_16x16x32_bf16 v[40:43], v[16:19], v[72:75], v[40:43]
  v_mfma_f32_16x16x32_bf16 v[44:47], v[16:19], v[76:79], v[44:47]
  ds_read_b128 v[16:19], v1 offset:11264
  v_max3_f32 v48, v32, v33, v34
  v_max3_f32 v49, v35, v36, v37
  v_max3_f32 v48, v48, v38, v39
  s_waitcnt lgkmcnt(3)
  v_mfma_f32_16x16x32_bf16 v[40:43], v[20:23], v[80:83], v[40:43]
  v_max_f32 v48, v48, v49
  v_cmp_lt_f32 vcc, s13, v48
  s_cbranch_vccnz L_rs13
L_rb13:
  v_exp_f32 v32, v32
  v_mfma_f32_16x16x32_bf16 v[44:47], v[20:23], v[84:87], v[44:47]
  ds_read_b128 v[20:23], v2 offset:11264
  v_exp_f32 v36, v36
  v_mfma_f32_16x16x32_bf16 v[40:43], v[24:27], v[88:91], v[40:43]
  v_exp_f32 v33, v33
  v_mfma_f32_16x16x32_bf16 v[44:47], v[24:27], v[92:95], v[44:47]
  s_cmp_eq_u32 s45, 65536
  s_cselect_b32 s11, s61, s62
  s_add_u32 s45, s45, s11
  v_add_u32 v1, s11, v1
  v_add_u32 v2, s11, v2
  ds_read_b128 v[24:27], v1 offset:0
  v_add_f32 v10, v10, v32
  v_exp_f32 v37, v37
  s_waitcnt lgkmcnt(3)
  v_mfma_f32_16x16x32_bf16 v[40:43], v[28:31], v[96:99], v[40:43]
  v_add_f32 v11, v11, v36
  v_exp_f32 v34, v34
  v_mfma_f32_16x16x32_bf16 v[44:47], v[28:31], v[100:103], v[44:47]
  ds_read_b128 v[28:31], v2 offset:0
  v_add_f32 v10, v10, v33
  v_mfma_f32_16x16x32_bf16 v[40:43], v[12:15], v[104:107], v[40:43]
  v_cvt_pk_bf16_f32 v184, v32, v33
  v_exp_f32 v38, v38
  v_mfma_f32_16x16x32_bf16 v[44:47], v[12:15], v[108:111], v[44:47]
  ds_read_b128 v[12:15], v1 offset:1024
  v_add_f32 v11, v11, v37
  v_cvt_pk_bf16_f32 v188, v36, v37
  s_waitcnt lgkmcnt(3)
  v_mfma_f32_16x16x32_bf16 v[40:43], v[16:19], v[112:115], v[40:43]
  v_exp_f32 v35, v35
  v_add_f32 v10, v10, v34
  v_mfma_f32_16x16x32_bf16 v[44:47], v[16:19], v[116:119], v[44:47]
  ds_read_b128 v[16:19], v2 offset:1024
  v_exp_f32 v39, v39
  v_mfma_f32_16x16x32_bf16 v[40:43], v[20:23], v[120:123], v[40:43]
  v_add_f32 v11, v11, v38
  v_add_f32 v10, v10, v35
  v_cvt_pk_bf16_f32 v185, v34, v35
  v_mfma_f32_16x16x32_bf16 v[44:47], v[20:23], v[124:127], v[44:47]
  ds_read_b128 v[20:23], v1 offset:2048
  v_add_f32 v11, v11, v39
  v_cvt_pk_bf16_f32 v189, v38, v39
  s_barrier
  s_waitcnt lgkmcnt(3)
  v_mfma_f32_16x16x32_bf16 v[32:35], v[24:27], v[64:67], v[52:55]
  v_mfma_f32_16x16x32_bf16 v[36:39], v[24:27], v[68:71], v[60:63]
  ds_read_b128 v[24:27], v2 offset:2048
  v_mfma_f32_16x16x32_bf16 v[32:35], v[28:31], v[72:75], v[32:35]
  v_max3_f32 v48, v40, v41, v42
  v_max3_f32 v49, v43, v44, v45
  v_max3_f32 v48, v48, v46, v47
  v_mfma_f32_16x16x32_bf16 v[36:39], v[28:31], v[76:79], v[36:39]
  ds_read_b128 v[28:31], v1 offset:3072
  v_max_f32 v48, v48, v49
  v_cmp_lt_f32 vcc, s13, v48
  s_cbranch_vccnz L_rs14
L_rb14:
  s_waitcnt lgkmcnt(3)
  v_mfma_f32_16x16x32_bf16 v[32:35], v[12:15], v[80:83], v[32:35]
  v_exp_f32 v40, v40
  v_exp_f32 v44, v44
  v_mfma_f32_16x16x32_bf16 v[36:39], v[12:15], v[84:87], v[36:39]
  ds_read_b128 v[12:15], v2 offset:3072
  v_exp_f32 v41, v41
  v_mfma_f32_16x16x32_bf16 v[32:35], v[16:19], v[88:91], v[32:35]
  v_add_f32 v10, v10, v40
  v_mfma_f32_16x16x32_bf16 v[36:39], v[16:19], v[92:95], v[36:39]
  ds_read_b128 v[16:19], v1 offset:8192
  v_exp_f32 v45, v45
  v_add_f32 v11, v11, v44
  s_waitcnt lgkmcnt(3)
  v_mfma_f32_16x16x32_bf16 v[32:35], v[20:23], v[96:99], v[32:35]
  v_exp_f32 v42, v42
  v_mfma_f32_16x16x32_bf16 v[36:39], v[20:23], v[100:103], v[36:39]
  ds_read_b128 v[20:23], v2 offset:8192
  v_add_f32 v10, v10, v41
  v_cvt_pk_bf16_f32 v186, v40, v41
  v_mfma_f32_16x16x32_bf16 v[32:35], v[24:27], v[104:107], v[32:35]
  v_exp_f32 v46, v46
  v_add_f32 v11, v11, v45
  v_mfma_f32_16x16x32_bf16 v[36:39], v[24:27], v[108:111], v[36:39]
  ds_read_b128 v[24:27], v1 offset:9216
  v_cvt_pk_bf16_f32 v190, v44, v45
  v_exp_f32 v43, v43
  s_waitcnt lgkmcnt(3)
  v_mfma_f32_16x16x32_bf16 v[32:35], v[28:31], v[112:115], v[32:35]
  v_add_f32 v10, v10, v42
  v_mfma_f32_16x16x32_bf16 v[36:39], v[28:31], v[116:119], v[36:39]
  ds_read_b128 v[28:31], v2 offset:9216
  v_exp_f32 v47, v47
  v_add_f32 v11, v11, v46
  v_mfma_f32_16x16x32_bf16 v[32:35], v[12:15], v[120:123], v[32:35]
  v_add_f32 v10, v10, v43
  v_cvt_pk_bf16_f32 v187, v42, v43
  v_mfma_f32_16x16x32_bf16 v[36:39], v[12:15], v[124:127], v[36:39]
  ds_read_b128 v[12:15], v1 offset:10240
  v_add_f32 v11, v11, v47
  v_cvt_pk_bf16_f32 v191, v46, v47
  s_waitcnt lgkmcnt(3)
  v_mfma_f32_16x16x32_bf16 v[40:43], v[16:19], v[64:67], v[52:55]
  v_mfma_f32_16x16x32_bf16 v[44:47], v[16:19], v[68:71], v[60:63]
  ds_read_b128 v[16:19], v2 offset:10240
  v_mfma_f32_16x16x32_bf16 v[40:43], v[20:23], v[72:75], v[40:43]
  v_mfma_f32_16x16x32_bf16 v[44:47], v[20:23], v[76:79], v[44:47]
  ds_read_b128 v[20:23], v1 offset:11264
  v_max3_f32 v48, v32, v33, v34
  v_max3_f32 v49, v35, v36, v37
  v_max3_f32 v48, v48, v38, v39
  s_waitcnt lgkmcnt(3)
  v_mfma_f32_16x16x32_bf16 v[40:43], v[24:27], v[80:83], v[40:43]
  v_max_f32 v48, v48, v49
  v_cmp_lt_f32 vcc, s13, v48
  s_cbranch_vccnz L_rs15
L_rb15:
  v_exp_f32 v32, v32
  v_mfma_f32_16x16x32_bf16 v[44:47], v[24:27], v[84:87], v[44:47]
  ds_read_b128 v[24:27], v2 offset:11264
  v_exp_f32 v36, v36
  v_mfma_f32_16x16x32_bf16 v[40:43], v[28:31], v[88:91], v[40:43]
  v_exp_f32 v33, v33
  v_mfma_f32_16x16x32_bf16 v[44:47], v[28:31], v[92:95], v[44:47]
  s_cmp_eq_u32 s45, 65536
  s_cselect_b32 s11, s61, s62
  s_add_u32 s45, s45, s11
  v_add_u32 v1, s11, v1
  v_add_u32 v2, s11, v2
  ds_read_b128 v[28:31], v1 offset:0
  v_add_f32 v10, v10, v32
  v_exp_f32 v37, v37
  s_waitcnt lgkmcnt(3)
  v_mfma_f32_16x16x32_bf16 v[40:43], v[12:15], v[96:99], v[40:43]
  v_add_f32 v11, v11, v36
  v_exp_f32 v34, v34
  v_mfma_f32_16x16x32_bf16 v[44:47], v[12:15], v[100:103], v[44:47]
  ds_read_b128 v[12:15], v2 offset:0
  v_add_f32 v10, v10, v33
  v_mfma_f32_16x16x32_bf16 v[40:43], v[16:19], v[104:107], v[40:43]
  v_cvt_pk_bf16_f32 v192, v32, v33
  v_exp_f32 v38, v38
  v_mfma_f32_16x16x32_bf16 v[44:47], v[16:19], v[108:111], v[44:47]
  ds_read_b128 v[16:19], v1 offset:1024
  v_add_f32 v11, v11, v37
  v_cvt_pk_bf16_f32 v196, v36, v37
  s_waitcnt lgkmcnt(3)
  v_mfma_f32_16x16x32_bf16 v[40:43], v[20:23], v[112:115], v[40:43]
  v_exp_f32 v35, v35
  v_add_f32 v10, v10, v34
  v_mfma_f32_16x16x32_bf16 v[44:47], v[20:23], v[116:119], v[44:47]
  ds_read_b128 v[20:23], v2 offset:1024
  v_exp_f32 v39, v39
  v_mfma_f32_16x16x32_bf16 v[40:43], v[24:27], v[120:123], v[40:43]
  v_add_f32 v11, v11, v38
  v_add_f32 v10, v10, v35
  v_cvt_pk_bf16_f32 v193, v34, v35
  v_mfma_f32_16x16x32_bf16 v[44:47], v[24:27], v[124:127], v[44:47]
  ds_read_b128 v[24:27], v1 offset:2048
  v_add_f32 v11, v11, v39
  v_cvt_pk_bf16_f32 v197, v38, v39
  s_barrier
  s_waitcnt lgkmcnt(3)
  v_mfma_f32_16x16x32_bf16 v[32:35], v[28:31], v[64:67], v[52:55]
  s_mov_b64 exec, s[48:49]
  ds_write_b128 v7, v[208:211] offset:0
  s_mov_b64 exec, -1
  v_mfma_f32_16x16x32_bf16 v[36:39], v[28:31], v[68:71], v[60:63]
  ds_read_b128 v[28:31], v2 offset:2048
  s_mov_b64 exec, s[48:49]
  ds_write_b128 v7, v[212:215] offset:1024
  s_mov_b64 exec, -1
  v_mfma_f32_16x16x32_bf16 v[32:35], v[12:15], v[72:75], v[32:35]
  s_mov_b64 exec, s[48:49]
  ds_write_b128 v7, v[216:219] offset:8192
  s_mov_b64 exec, -1
  v_max3_f32 v48, v40, v41, v42
  v_max3_f32 v49, v43, v44, v45
  v_max3_f32 v48, v48, v46, v47
  v_mfma_f32_16x16x32_bf16 v[36:39], v[12:15], v[76:79], v[36:39]
  ds_read_b128 v[12:15], v1 offset:3072
  s_mov_b64 exec, s[48:49]
  ds_write_b128 v7, v[220:223] offset:9216
  s_mov_b64 exec, -1
  v_max_f32 v48, v48, v49
  v_cmp_lt_f32 vcc, s13, v48
  s_cbranch_vccnz L_rs16
L_rb16:
  s_waitcnt lgkmcnt(7)
  v_mfma_f32_16x16x32_bf16 v[32:35], v[16:19], v[80:83], v[32:35]
  v_exp_f32 v40, v40
  v_exp_f32 v44, v44
  v_mfma_f32_16x16x32_bf16 v[36:39], v[16:19], v[84:87], v[36:39]
  ds_read_b128 v[16:19], v2 offset:3072
  v_exp_f32 v41, v41
  v_mfma_f32_16x16x32_bf16 v[32:35], v[20:23], v[88:91], v[32:35]
  v_add_f32 v10, v10, v40
  v_mfma_f32_16x16x32_bf16 v[36:39], v[20:23], v[92:95], v[36:39]
  ds_read_b128 v[20:23], v1 offset:8192
  v_exp_f32 v45, v45
  v_add_f32 v11, v11, v44
  s_waitcnt lgkmcnt(6)
  v_mfma_f32_16x16x32_bf16 v[32:35], v[24:27], v[96:99], v[32:35]
  v_exp_f32 v42, v42
  v_mfma_f32_16x16x32_bf16 v[36:39], v[24:27], v[100:103], v[36:39]
  ds_read_b128 v[24:27], v2 offset:8192
  v_add_f32 v10, v10, v41
  v_cvt_pk_bf16_f32 v194, v40, v41
  v_mfma_f32_16x16x32_bf16 v[32:35], v[28:31], v[104:107], v[32:35]
  v_exp_f32 v46, v46
  v_add_f32 v11, v11, v45
  v_mfma_f32_16x16x32_bf16 v[36:39], v[28:31], v[108:111], v[36:39]
  ds_read_b128 v[28:31], v1 offset:9216
  v_cvt_pk_bf16_f32 v198, v44, v45
  v_exp_f32 v43, v43
  s_waitcnt lgkmcnt(3)
  v_mfma_f32_16x16x32_bf16 v[32:35], v[12:15], v[112:115], v[32:35]
  v_add_f32 v10, v10, v42
  v_mfma_f32_16x16x32_bf16 v[36:39], v[12:15], v[116:119], v[36:39]
  ds_read_b128 v[12:15], v2 offset:9216
  v_exp_f32 v47, v47
  v_add_f32 v11, v11, v46
  v_mfma_f32_16x16x32_bf16 v[32:35], v[16:19], v[120:123], v[32:35]
  v_add_f32 v10, v10, v43
  v_cvt_pk_bf16_f32 v195, v42, v43
  v_mfma_f32_16x16x32_bf16 v[36:39], v[16:19], v[124:127], v[36:39]
  ds_read_b128 v[16:19], v1 offset:10240
  v_add_f32 v11, v11, v47
  v_cvt_pk_bf16_f32 v199, v46, v47
  s_waitcnt lgkmcnt(3)
  v_mfma_f32_16x16x32_bf16 v[40:43], v[20:23], v[64:67], v[52:55]
  v_mfma_f32_16x16x32_bf16 v[44:47], v[20:23], v[68:71], v[60:63]
  ds_read_b128 v[20:23], v2 offset:10240
  v_mfma_f32_16x16x32_bf16 v[40:43], v[24:27], v[72:75], v[40:43]
  v_mfma_f32_16x16x32_bf16 v[44:47], v[24:27], v[76:79], v[44:47]
  ds_read_b128 v[24:27], v1 offset:11264
  v_max3_f32 v48, v32, v33, v34
  v_max3_f32 v49, v35, v36, v37
  v_max3_f32 v48, v48, v38, v39
  s_waitcnt lgkmcnt(3)
  v_mfma_f32_16x16x32_bf16 v[40:43], v[28:31], v[80:83], v[40:43]
  v_max_f32 v48, v48, v49
  v_cmp_lt_f32 vcc, s13, v48
  s_cbranch_vccnz L_rs17
L_rb17:
  v_exp_f32 v32, v32
  v_mfma_f32_16x16x32_bf16 v[44:47], v[28:31], v[84:87], v[44:47]
  ds_read_b128 v[28:31], v2 offset:11264
  v_exp_f32 v36, v36
  v_mfma_f32_16x16x32_bf16 v[40:43], v[12:15], v[88:91], v[40:43]
  v_exp_f32 v33, v33
  v_mfma_f32_16x16x32_bf16 v[44:47], v[12:15], v[92:95], v[44:47]
  s_cmp_eq_u32 s45, 65536
  s_cselect_b32 s11, s61, s62
  s_add_u32 s45, s45, s11
  v_add_u32 v1, s11, v1
  v_add_u32 v2, s11, v2
  ds_read_b128 v[12:15], v1 offset:0
  v_add_f32 v10, v10, v32
  v_exp_f32 v37, v37
  s_waitcnt lgkmcnt(3)
  v_mfma_f32_16x16x32_bf16 v[40:43], v[16:19], v[96:99], v[40:43]
  v_add_f32 v11, v11, v36
  v_exp_f32 v34, v34
  v_mfma_f32_16x16x32_bf16 v[44:47], v[16:19], v[100:103], v[44:47]
  ds_read_b128 v[16:19], v2 offset:0
  v_add_f32 v10, v10, v33
  v_mfma_f32_16x16x32_bf16 v[40:43], v[20:23], v[104:107], v[40:43]
  v_cvt_pk_bf16_f32 v200, v32, v33
  v_exp_f32 v38, v38
  v_mfma_f32_16x16x32_bf16 v[44:47], v[20:23], v[108:111], v[44:47]
  ds_read_b128 v[20:23], v1 offset:1024
  v_add_f32 v11, v11, v37
  v_cvt_pk_bf16_f32 v204, v36, v37
  s_waitcnt lgkmcnt(3)
  v_mfma_f32_16x16x32_bf16 v[40:43], v[24:27], v[112:115], v[40:43]
  v_exp_f32 v35, v35
  v_add_f32 v10, v10, v34
  v_mfma_f32_16x16x32_bf16 v[44:47], v[24:27], v[116:119], v[44:47]
  ds_read_b128 v[24:27], v2 offset:1024
  v_exp_f32 v39, v39
  v_mfma_f32_16x16x32_bf16 v[40:43], v[28:31], v[120:123], v[40:43]
  v_add_f32 v11, v11, v38
  v_add_f32 v10, v10, v35
  v_cvt_pk_bf16_f32 v201, v34, v35
  v_mfma_f32_16x16x32_bf16 v[44:47], v[28:31], v[124:127], v[44:47]
  ds_read_b128 v[28:31], v1 offset:2048
  v_add_f32 v11, v11, v39
  v_cvt_pk_bf16_f32 v205, v38, v39
  s_barrier
  s_waitcnt lgkmcnt(3)
  v_mfma_f32_16x16x32_bf16 v[32:35], v[12:15], v[64:67], v[52:55]
  v_mfma_f32_16x16x32_bf16 v[36:39], v[12:15], v[68:71], v[60:63]
  ds_read_b128 v[12:15], v2 offset:2048
  v_mfma_f32_16x16x32_bf16 v[32:35], v[16:19], v[72:75], v[32:35]
  v_max3_f32 v48, v40, v41, v42
  v_max3_f32 v49, v43, v44, v45
  v_max3_f32 v48, v48, v46, v47
  v_mfma_f32_16x16x32_bf16 v[36:39], v[16:19], v[76:79], v[36:39]
  ds_read_b128 v[16:19], v1 offset:3072
  v_max_f32 v48, v48, v49
  v_cmp_lt_f32 vcc, s13, v48
  s_cbranch_vccnz L_rs18
L_rb18:
  s_waitcnt lgkmcnt(3)
  v_mfma_f32_16x16x32_bf16 v[32:35], v[20:23], v[80:83], v[32:35]
  v_exp_f32 v40, v40
  v_exp_f32 v44, v44
  v_mfma_f32_16x16x32_bf16 v[36:39], v[20:23], v[84:87], v[36:39]
  ds_read_b128 v[20:23], v2 offset:3072
  v_exp_f32 v41, v41
  v_mfma_f32_16x16x32_bf16 v[32:35], v[24:27], v[88:91], v[32:35]
  v_add_f32 v10, v10, v40
  v_mfma_f32_16x16x32_bf16 v[36:39], v[24:27], v[92:95], v[36:39]
  ds_read_b128 v[24:27], v1 offset:8192
  v_exp_f32 v45, v45
  v_add_f32 v11, v11, v44
  s_waitcnt lgkmcnt(3)
  v_mfma_f32_16x16x32_bf16 v[32:35], v[28:31], v[96:99], v[32:35]
  v_exp_f32 v42, v42
  v_mfma_f32_16x16x32_bf16 v[36:39], v[28:31], v[100:103], v[36:39]
  ds_read_b128 v[28:31], v2 offset:8192
  v_add_f32 v10, v10, v41
  v_cvt_pk_bf16_f32 v202, v40, v41
  v_mfma_f32_16x16x32_bf16 v[32:35], v[12:15], v[104:107], v[32:35]
  v_exp_f32 v46, v46
  v_add_f32 v11, v11, v45
  v_mfma_f32_16x16x32_bf16 v[36:39], v[12:15], v[108:111], v[36:39]
  ds_read_b128 v[12:15], v1 offset:9216
  v_cvt_pk_bf16_f32 v206, v44, v45
  v_exp_f32 v43, v43
  s_waitcnt lgkmcnt(3)
  v_mfma_f32_16x16x32_bf16 v[32:35], v[16:19], v[112:115], v[32:35]
  v_add_f32 v10, v10, v42
  v_mfma_f32_16x16x32_bf16 v[36:39], v[16:19], v[116:119], v[36:39]
  ds_read_b128 v[16:19], v2 offset:9216
  v_exp_f32 v47, v47
  v_add_f32 v11, v11, v46
  v_mfma_f32_16x16x32_bf16 v[32:35], v[20:23], v[120:123], v[32:35]
  v_add_f32 v10, v10, v43
  v_cvt_pk_bf16_f32 v203, v42, v43
  v_mfma_f32_16x16x32_bf16 v[36:39], v[20:23], v[124:127], v[36:39]
  ds_read_b128 v[20:23], v1 offset:10240
  v_add_f32 v11, v11, v47
  v_cvt_pk_bf16_f32 v207, v46, v47
  s_waitcnt lgkmcnt(3)
  v_mfma_f32_16x16x32_bf16 v[40:43], v[24:27], v[64:67], v[52:55]
  v_mfma_f32_16x16x32_bf16 v[44:47], v[24:27], v[68:71], v[60:63]
  ds_read_b128 v[24:27], v2 offset:10240
  v_mfma_f32_16x16x32_bf16 v[40:43], v[28:31], v[72:75], v[40:43]
  v_mfma_f32_16x16x32_bf16 v[44:47], v[28:31], v[76:79], v[44:47]
  ds_read_b128 v[28:31], v1 offset:11264
  v_max3_f32 v48, v32, v33, v34
  v_max3_f32 v49, v35, v36, v37
  v_max3_f32 v48, v48, v38, v39
  s_waitcnt lgkmcnt(3)
  v_mfma_f32_16x16x32_bf16 v[40:43], v[12:15], v[80:83], v[40:43]
  v_max_f32 v48, v48, v49
  v_cmp_lt_f32 vcc, s13, v48
  s_cbranch_vccnz L_rs19
L_rb19:
  v_exp_f32 v32, v32
  v_mfma_f32_16x16x32_bf16 v[44:47], v[12:15], v[84:87], v[44:47]
  ds_read_b128 v[12:15], v2 offset:11264
  v_exp_f32 v36, v36
  v_mfma_f32_16x16x32_bf16 v[40:43], v[16:19], v[88:91], v[40:43]
  v_exp_f32 v33, v33
  v_mfma_f32_16x16x32_bf16 v[44:47], v[16:19], v[92:95], v[44:47]
  s_cmp_eq_u32 s45, 65536
  s_cselect_b32 s11, s61, s62
  s_add_u32 s45, s45, s11
  v_add_u32 v1, s11, v1
  v_add_u32 v2, s11, v2
  ds_read_b128 v[16:19], v1 offset:0
  v_add_f32 v10, v10, v32
  v_exp_f32 v37, v37
  s_waitcnt lgkmcnt(3)
  v_mfma_f32_16x16x32_bf16 v[40:43], v[20:23], v[96:99], v[40:43]
  v_add_f32 v11, v11, v36
  v_exp_f32 v34, v34
  v_mfma_f32_16x16x32_bf16 v[44:47], v[20:23], v[100:103], v[44:47]
  ds_read_b128 v[20:23], v2 offset:0
  v_add_f32 v10, v10, v33
  v_mfma_f32_16x16x32_bf16 v[40:43], v[24:27], v[104:107], v[40:43]
  v_cvt_pk_bf16_f32 v208, v32, v33
  v_exp_f32 v38, v38
  v_mfma_f32_16x16x32_bf16 v[44:47], v[24:27], v[108:111], v[44:47]
  ds_read_b128 v[24:27], v1 offset:1024
  v_add_f32 v11, v11, v37
  v_cvt_pk_bf16_f32 v212, v36, v37
  s_waitcnt lgkmcnt(3)
  v_mfma_f32_16x16x32_bf16 v[40:43], v[28:31], v[112:115], v[40:43]
  v_exp_f32 v35, v35
  v_add_f32 v10, v10, v34
  v_mfma_f32_16x16x32_bf16 v[44:47], v[28:31], v[116:119], v[44:47]
  ds_read_b128 v[28:31], v2 offset:1024
  v_exp_f32 v39, v39
  v_mfma_f32_16x16x32_bf16 v[40:43], v[12:15], v[120:123], v[40:43]
  v_add_f32 v11, v11, v38
  v_add_f32 v10, v10, v35
  v_cvt_pk_bf16_f32 v209, v34, v35
  v_mfma_f32_16x16x32_bf16 v[44:47], v[12:15], v[124:127], v[44:47]
  ds_read_b128 v[12:15], v1 offset:2048
  v_add_f32 v11, v11, v39
  v_cvt_pk_bf16_f32 v213, v38, v39
  s_barrier
  s_waitcnt lgkmcnt(3)
  v_mfma_f32_16x16x32_bf16 v[32:35], v[16:19], v[64:67], v[52:55]
  v_mfma_f32_16x16x32_bf16 v[36:39], v[16:19], v[68:71], v[60:63]
  ds_read_b128 v[16:19], v2 offset:2048
  v_mfma_f32_16x16x32_bf16 v[32:35], v[20:23], v[72:75], v[32:35]
  v_max3_f32 v48, v40, v41, v42
  v_max3_f32 v49, v43, v44, v45
  v_max3_f32 v48, v48, v46, v47
  v_mfma_f32_16x16x32_bf16 v[36:39], v[20:23], v[76:79], v[36:39]
  ds_read_b128 v[20:23], v1 offset:3072
  v_max_f32 v48, v48, v49
  v_cmp_lt_f32 vcc, s13, v48
  s_cbranch_vccnz L_rs20
L_rb20:
  s_waitcnt lgkmcnt(3)
  v_mfma_f32_16x16x32_bf16 v[32:35], v[24:27], v[80:83], v[32:35]
  v_exp_f32 v40, v40
  v_exp_f32 v44, v44
  v_mfma_f32_16x16x32_bf16 v[36:39], v[24:27], v[84:87], v[36:39]
  ds_read_b128 v[24:27], v2 offset:3072
  v_exp_f32 v41, v41
  v_mfma_f32_16x16x32_bf16 v[32:35], v[28:31], v[88:91], v[32:35]
  v_add_f32 v10, v10, v40
  v_mfma_f32_16x16x32_bf16 v[36:39], v[28:31], v[92:95], v[36:39]
  ds_read_b128 v[28:31], v1 offset:8192
  v_exp_f32 v45, v45
  v_add_f32 v11, v11, v44
  s_waitcnt lgkmcnt(3)
  v_mfma_f32_16x16x32_bf16 v[32:35], v[12:15], v[96:99], v[32:35]
  v_exp_f32 v42, v42
  v_mfma_f32_16x16x32_bf16 v[36:39], v[12:15], v[100:103], v[36:39]
  ds_read_b128 v[12:15], v2 offset:8192
  v_add_f32 v10, v10, v41
  v_cvt_pk_bf16_f32 v210, v40, v41
  v_mfma_f32_16x16x32_bf16 v[32:35], v[16:19], v[104:107], v[32:35]
  v_exp_f32 v46, v46
  v_add_f32 v11, v11, v45
  v_mfma_f32_16x16x32_bf16 v[36:39], v[16:19], v[108:111], v[36:39]
  ds_read_b128 v[16:19], v1 offset:9216
  v_cvt_pk_bf16_f32 v214, v44, v45
  v_exp_f32 v43, v43
  s_waitcnt lgkmcnt(3)
  v_mfma_f32_16x16x32_bf16 v[32:35], v[20:23], v[112:115], v[32:35]
  v_add_f32 v10, v10, v42
  v_mfma_f32_16x16x32_bf16 v[36:39], v[20:23], v[116:119], v[36:39]
  ds_read_b128 v[20:23], v2 offset:9216
  v_exp_f32 v47, v47
  v_add_f32 v11, v11, v46
  v_mfma_f32_16x16x32_bf16 v[32:35], v[24:27], v[120:123], v[32:35]
  v_add_f32 v10, v10, v43
  v_cvt_pk_bf16_f32 v211, v42, v43
  v_mfma_f32_16x16x32_bf16 v[36:39], v[24:27], v[124:127], v[36:39]
  ds_read_b128 v[24:27], v1 offset:10240
  v_add_f32 v11, v11, v47
  v_cvt_pk_bf16_f32 v215, v46, v47
  s_waitcnt lgkmcnt(3)
  v_mfma_f32_16x16x32_bf16 v[40:43], v[28:31], v[64:67], v[52:55]
  v_mfma_f32_16x16x32_bf16 v[44:47], v[28:31], v[68:71], v[60:63]
  ds_read_b128 v[28:31], v2 offset:10240
  v_mfma_f32_16x16x32_bf16 v[40:43], v[12:15], v[72:75], v[40:43]
  v_mfma_f32_16x16x32_bf16 v[44:47], v[12:15], v[76:79], v[44:47]
  ds_read_b128 v[12:15], v1 offset:11264
  v_max3_f32 v48, v32, v33, v34
  v_max3_f32 v49, v35, v36, v37
  v_max3_f32 v48, v48, v38, v39
  s_waitcnt lgkmcnt(3)
  v_mfma_f32_16x16x32_bf16 v[40:43], v[16:19], v[80:83], v[40:43]
  v_max_f32 v48, v48, v49
  v_cmp_lt_f32 vcc, s13, v48
  s_cbranch_vccnz L_rs21
L_rb21:
  v_exp_f32 v32, v32
  v_mfma_f32_16x16x32_bf16 v[44:47], v[16:19], v[84:87], v[44:47]
  ds_read_b128 v[16:19], v2 offset:11264
  v_exp_f32 v36, v36
  v_mfma_f32_16x16x32_bf16 v[40:43], v[20:23], v[88:91], v[40:43]
  v_exp_f32 v33, v33
  v_mfma_f32_16x16x32_bf16 v[44:47], v[20:23], v[92:95], v[44:47]
  s_cmp_eq_u32 s45, 65536
  s_cselect_b32 s11, s61, s62
  s_add_u32 s45, s45, s11
  v_add_u32 v1, s11, v1
  v_add_u32 v2, s11, v2
  ds_read_b128 v[20:23], v1 offset:0
  v_add_f32 v10, v10, v32
  v_exp_f32 v37, v37
  s_waitcnt lgkmcnt(3)
  v_mfma_f32_16x16x32_bf16 v[40:43], v[24:27], v[96:99], v[40:43]
  v_add_f32 v11, v11, v36
  v_exp_f32 v34, v34
  v_mfma_f32_16x16x32_bf16 v[44:47], v[24:27], v[100:103], v[44:47]
  ds_read_b128 v[24:27], v2 offset:0
  v_add_f32 v10, v10, v33
  v_mfma_f32_16x16x32_bf16 v[40:43], v[28:31], v[104:107], v[40:43]
  v_cvt_pk_bf16_f32 v216, v32, v33
  v_exp_f32 v38, v38
  v_mfma_f32_16x16x32_bf16 v[44:47], v[28:31], v[108:111], v[44:47]
  ds_read_b128 v[28:31], v1 offset:1024
  v_add_f32 v11, v11, v37
  v_cvt_pk_bf16_f32 v220, v36, v37
  s_waitcnt lgkmcnt(3)
  v_mfma_f32_16x16x32_bf16 v[40:43], v[12:15], v[112:115], v[40:43]
  v_exp_f32 v35, v35
  v_add_f32 v10, v10, v34
  v_mfma_f32_16x16x32_bf16 v[44:47], v[12:15], v[116:119], v[44:47]
  ds_read_b128 v[12:15], v2 offset:1024
  v_exp_f32 v39, v39
  v_mfma_f32_16x16x32_bf16 v[40:43], v[16:19], v[120:123], v[40:43]
  v_add_f32 v11, v11, v38
  v_add_f32 v10, v10, v35
  v_cvt_pk_bf16_f32 v217, v34, v35
  v_mfma_f32_16x16x32_bf16 v[44:47], v[16:19], v[124:127], v[44:47]
  ds_read_b128 v[16:19], v1 offset:2048
  v_add_f32 v11, v11, v39
  v_cvt_pk_bf16_f32 v221, v38, v39
  s_barrier
  s_waitcnt lgkmcnt(3)
  v_mfma_f32_16x16x32_bf16 v[32:35], v[20:23], v[64:67], v[52:55]
  v_mfma_f32_16x16x32_bf16 v[36:39], v[20:23], v[68:71], v[60:63]
  ds_read_b128 v[20:23], v2 offset:2048
  v_mfma_f32_16x16x32_bf16 v[32:35], v[24:27], v[72:75], v[32:35]
  v_max3_f32 v48, v40, v41, v42
  v_max3_f32 v49, v43, v44, v45
  v_max3_f32 v48, v48, v46, v47
  v_mfma_f32_16x16x32_bf16 v[36:39], v[24:27], v[76:79], v[36:39]
  ds_read_b128 v[24:27], v1 offset:3072
  v_max_f32 v48, v48, v49
  v_cmp_lt_f32 vcc, s13, v48
  s_cbranch_vccnz L_rs22
L_rb22:
  s_waitcnt lgkmcnt(3)
  v_mfma_f32_16x16x32_bf16 v[32:35], v[28:31], v[80:83], v[32:35]
  v_exp_f32 v40, v40
  v_exp_f32 v44, v44
  v_mfma_f32_16x16x32_bf16 v[36:39], v[28:31], v[84:87], v[36:39]
  ds_read_b128 v[28:31], v2 offset:3072
  v_exp_f32 v41, v41
  v_mfma_f32_16x16x32_bf16 v[32:35], v[12:15], v[88:91], v[32:35]
  v_add_f32 v10, v10, v40
  v_mfma_f32_16x16x32_bf16 v[36:39], v[12:15], v[92:95], v[36:39]
  ds_read_b128 v[12:15], v1 offset:8192
  v_exp_f32 v45, v45
  v_add_f32 v11, v11, v44
  s_waitcnt lgkmcnt(3)
  v_mfma_f32_16x16x32_bf16 v[32:35], v[16:19], v[96:99], v[32:35]
  v_exp_f32 v42, v42
  v_mfma_f32_16x16x32_bf16 v[36:39], v[16:19], v[100:103], v[36:39]
  ds_read_b128 v[16:19], v2 offset:8192
  v_add_f32 v10, v10, v41
  v_cvt_pk_bf16_f32 v218, v40, v41
  v_mfma_f32_16x16x32_bf16 v[32:35], v[20:23], v[104:107], v[32:35]
  v_exp_f32 v46, v46
  v_add_f32 v11, v11, v45
  v_mfma_f32_16x16x32_bf16 v[36:39], v[20:23], v[108:111], v[36:39]
  ds_read_b128 v[20:23], v1 offset:9216
  v_cvt_pk_bf16_f32 v222, v44, v45
  v_exp_f32 v43, v43
  s_waitcnt lgkmcnt(3)
  v_mfma_f32_16x16x32_bf16 v[32:35], v[24:27], v[112:115], v[32:35]
  v_add_f32 v10, v10, v42
  v_mfma_f32_16x16x32_bf16 v[36:39], v[24:27], v[116:119], v[36:39]
  ds_read_b128 v[24:27], v2 offset:9216
  v_exp_f32 v47, v47
  v_add_f32 v11, v11, v46
  v_mfma_f32_16x16x32_bf16 v[32:35], v[28:31], v[120:123], v[32:35]
  v_add_f32 v10, v10, v43
  v_cvt_pk_bf16_f32 v219, v42, v43
  v_mfma_f32_16x16x32_bf16 v[36:39], v[28:31], v[124:127], v[36:39]
  ds_read_b128 v[28:31], v1 offset:10240
  v_add_f32 v11, v11, v47
  v_cvt_pk_bf16_f32 v223, v46, v47
  s_waitcnt lgkmcnt(3)
  v_mfma_f32_16x16x32_bf16 v[40:43], v[12:15], v[64:67], v[52:55]
  v_mfma_f32_16x16x32_bf16 v[44:47], v[12:15], v[68:71], v[60:63]
  ds_read_b128 v[12:15], v2 offset:10240
  v_mfma_f32_16x16x32_bf16 v[40:43], v[16:19], v[72:75], v[40:43]
  v_mfma_f32_16x16x32_bf16 v[44:47], v[16:19], v[76:79], v[44:47]
  ds_read_b128 v[16:19], v1 offset:11264
  v_max3_f32 v48, v32, v33, v34
  v_max3_f32 v49, v35, v36, v37
  v_max3_f32 v48, v48, v38, v39
  s_waitcnt lgkmcnt(3)
  v_mfma_f32_16x16x32_bf16 v[40:43], v[20:23], v[80:83], v[40:43]
  v_max_f32 v48, v48, v49
  v_cmp_lt_f32 vcc, s13, v48
  s_cbranch_vccnz L_rs23
L_rb23:
  v_exp_f32 v32, v32
  v_mfma_f32_16x16x32_bf16 v[44:47], v[20:23], v[84:87], v[44:47]
  ds_read_b128 v[20:23], v2 offset:11264
  v_exp_f32 v36, v36
  v_mfma_f32_16x16x32_bf16 v[40:43], v[24:27], v[88:91], v[40:43]
  v_exp_f32 v33, v33
  v_mfma_f32_16x16x32_bf16 v[44:47], v[24:27], v[92:95], v[44:47]
  s_cmp_eq_u32 s45, 65536
  s_cselect_b32 s11, s61, s62
  s_add_u32 s45, s45, s11
  v_add_u32 v1, s11, v1
  v_add_u32 v2, s11, v2
  ds_read_b128 v[24:27], v1 offset:0
  v_add_f32 v10, v10, v32
  v_exp_f32 v37, v37
  s_waitcnt lgkmcnt(3)
  v_mfma_f32_16x16x32_bf16 v[40:43], v[28:31], v[96:99], v[40:43]
  v_add_f32 v11, v11, v36
  v_exp_f32 v34, v34
  v_mfma_f32_16x16x32_bf16 v[44:47], v[28:31], v[100:103], v[44:47]
  ds_read_b128 v[28:31], v2 offset:0
  v_add_f32 v10, v10, v33
  v_mfma_f32_16x16x32_bf16 v[40:43], v[12:15], v[104:107], v[40:43]
  v_cvt_pk_bf16_f32 v224, v32, v33
  v_exp_f32 v38, v38
  v_mfma_f32_16x16x32_bf16 v[44:47], v[12:15], v[108:111], v[44:47]
  ds_read_b128 v[12:15], v1 offset:1024
  v_add_f32 v11, v11, v37
  v_cvt_pk_bf16_f32 v228, v36, v37
  s_waitcnt lgkmcnt(3)
  v_mfma_f32_16x16x32_bf16 v[40:43], v[16:19], v[112:115], v[40:43]
  v_exp_f32 v35, v35
  v_add_f32 v10, v10, v34
  v_mfma_f32_16x16x32_bf16 v[44:47], v[16:19], v[116:119], v[44:47]
  ds_read_b128 v[16:19], v2 offset:1024
  v_exp_f32 v39, v39
  v_mfma_f32_16x16x32_bf16 v[40:43], v[20:23], v[120:123], v[40:43]
  v_add_f32 v11, v11, v38
  v_add_f32 v10, v10, v35
  v_cvt_pk_bf16_f32 v225, v34, v35
  v_mfma_f32_16x16x32_bf16 v[44:47], v[20:23], v[124:127], v[44:47]
  ds_read_b128 v[20:23], v1 offset:2048
  v_add_f32 v11, v11, v39
  v_cvt_pk_bf16_f32 v229, v38, v39
  s_barrier
  s_waitcnt lgkmcnt(3)
  v_mfma_f32_16x16x32_bf16 v[32:35], v[24:27], v[64:67], v[52:55]
  s_mov_b64 exec, s[48:49]
  ds_write_b128 v7, v[232:235] offset:0
  s_mov_b64 exec, -1
  v_mfma_f32_16x16x32_bf16 v[36:39], v[24:27], v[68:71], v[60:63]
  ds_read_b128 v[24:27], v2 offset:2048
  s_mov_b64 exec, s[48:49]
  ds_write_b128 v7, v[236:239] offset:1024
  s_mov_b64 exec, -1
  v_mfma_f32_16x16x32_bf16 v[32:35], v[28:31], v[72:75], v[32:35]
  s_mov_b64 exec, s[48:49]
  ds_write_b128 v7, v[240:243] offset:8192
  s_mov_b64 exec, -1
  v_max3_f32 v48, v40, v41, v42
  v_max3_f32 v49, v43, v44, v45
  v_max3_f32 v48, v48, v46, v47
  v_mfma_f32_16x16x32_bf16 v[36:39], v[28:31], v[76:79], v[36:39]
  ds_read_b128 v[28:31], v1 offset:3072
  s_mov_b64 exec, s[48:49]
  ds_write_b128 v7, v[244:247] offset:9216
  s_mov_b64 exec, -1
  v_max_f32 v48, v48, v49
  v_cmp_lt_f32 vcc, s13, v48
  s_cbranch_vccnz L_rs24
L_rb24:
  s_waitcnt lgkmcnt(7)
  v_mfma_f32_16x16x32_bf16 v[32:35], v[12:15], v[80:83], v[32:35]
  v_exp_f32 v40, v40
  v_exp_f32 v44, v44
  v_mfma_f32_16x16x32_bf16 v[36:39], v[12:15], v[84:87], v[36:39]
  ds_read_b128 v[12:15], v2 offset:3072
  v_exp_f32 v41, v41
  v_mfma_f32_16x16x32_bf16 v[32:35], v[16:19], v[88:91], v[32:35]
  v_add_f32 v10, v10, v40
  v_mfma_f32_16x16x32_bf16 v[36:39], v[16:19], v[92:95], v[36:39]
  ds_read_b128 v[16:19], v1 offset:8192
  v_exp_f32 v45, v45
  v_add_f32 v11, v11, v44
  s_waitcnt lgkmcnt(6)
  v_mfma_f32_16x16x32_bf16 v[32:35], v[20:23], v[96:99], v[32:35]
  v_exp_f32 v42, v42
  v_mfma_f32_16x16x32_bf16 v[36:39], v[20:23], v[100:103], v[36:39]
  ds_read_b128 v[20:23], v2 offset:8192
  v_add_f32 v10, v10, v41
  v_cvt_pk_bf16_f32 v226, v40, v41
  v_mfma_f32_16x16x32_bf16 v[32:35], v[24:27], v[104:107], v[32:35]
  v_exp_f32 v46, v46
  v_add_f32 v11, v11, v45
  v_mfma_f32_16x16x32_bf16 v[36:39], v[24:27], v[108:111], v[36:39]
  ds_read_b128 v[24:27], v1 offset:9216
  v_cvt_pk_bf16_f32 v230, v44, v45
  v_exp_f32 v43, v43
  s_waitcnt lgkmcnt(3)
  v_mfma_f32_16x16x32_bf16 v[32:35], v[28:31], v[112:115], v[32:35]
  v_add_f32 v10, v10, v42
  v_mfma_f32_16x16x32_bf16 v[36:39], v[28:31], v[116:119], v[36:39]
  ds_read_b128 v[28:31], v2 offset:9216
  v_exp_f32 v47, v47
  v_add_f32 v11, v11, v46
  v_mfma_f32_16x16x32_bf16 v[32:35], v[12:15], v[120:123], v[32:35]
  v_add_f32 v10, v10, v43
  v_cvt_pk_bf16_f32 v227, v42, v43
  v_mfma_f32_16x16x32_bf16 v[36:39], v[12:15], v[124:127], v[36:39]
  ds_read_b128 v[12:15], v1 offset:10240
  v_add_f32 v11, v11, v47
  v_cvt_pk_bf16_f32 v231, v46, v47
  s_waitcnt lgkmcnt(3)
  v_mfma_f32_16x16x32_bf16 v[40:43], v[16:19], v[64:67], v[52:55]
  v_mfma_f32_16x16x32_bf16 v[44:47], v[16:19], v[68:71], v[60:63]
  ds_read_b128 v[16:19], v2 offset:10240
  v_mfma_f32_16x16x32_bf16 v[40:43], v[20:23], v[72:75], v[40:43]
  v_mfma_f32_16x16x32_bf16 v[44:47], v[20:23], v[76:79], v[44:47]
  ds_read_b128 v[20:23], v1 offset:11264
  v_max3_f32 v48, v32, v33, v34
  v_max3_f32 v49, v35, v36, v37
  v_max3_f32 v48, v48, v38, v39
  s_waitcnt lgkmcnt(3)
  v_mfma_f32_16x16x32_bf16 v[40:43], v[24:27], v[80:83], v[40:43]
  v_max_f32 v48, v48, v49
  v_cmp_lt_f32 vcc, s13, v48
  s_cbranch_vccnz L_rs25
L_rb25:
  v_exp_f32 v32, v32
  v_mfma_f32_16x16x32_bf16 v[44:47], v[24:27], v[84:87], v[44:47]
  ds_read_b128 v[24:27], v2 offset:11264
  v_exp_f32 v36, v36
  v_mfma_f32_16x16x32_bf16 v[40:43], v[28:31], v[88:91], v[40:43]
  v_exp_f32 v33, v33
  v_mfma_f32_16x16x32_bf16 v[44:47], v[28:31], v[92:95], v[44:47]
  s_cmp_eq_u32 s45, 65536
  s_cselect_b32 s11, s61, s62
  s_add_u32 s45, s45, s11
  v_add_u32 v1, s11, v1
  v_add_u32 v2, s11, v2
  ds_read_b128 v[28:31], v1 offset:0
  v_add_f32 v10, v10, v32
  v_exp_f32 v37, v37
  s_waitcnt lgkmcnt(3)
  v_mfma_f32_16x16x32_bf16 v[40:43], v[12:15], v[96:99], v[40:43]
  v_add_f32 v11, v11, v36
  v_exp_f32 v34, v34
  v_mfma_f32_16x16x32_bf16 v[44:47], v[12:15], v[100:103], v[44:47]
  ds_read_b128 v[12:15], v2 offset:0
  v_add_f32 v10, v10, v33
  v_mfma_f32_16x16x32_bf16 v[40:43], v[16:19], v[104:107], v[40:43]
  v_cvt_pk_bf16_f32 v232, v32, v33
  v_exp_f32 v38, v38
  v_mfma_f32_16x16x32_bf16 v[44:47], v[16:19], v[108:111], v[44:47]
  ds_read_b128 v[16:19], v1 offset:1024
  v_add_f32 v11, v11, v37
  v_cvt_pk_bf16_f32 v236, v36, v37
  s_waitcnt lgkmcnt(3)
  v_mfma_f32_16x16x32_bf16 v[40:43], v[20:23], v[112:115], v[40:43]
  v_exp_f32 v35, v35
  v_add_f32 v10, v10, v34
  v_mfma_f32_16x16x32_bf16 v[44:47], v[20:23], v[116:119], v[44:47]
  ds_read_b128 v[20:23], v2 offset:1024
  v_exp_f32 v39, v39
  v_mfma_f32_16x16x32_bf16 v[40:43], v[24:27], v[120:123], v[40:43]
  v_add_f32 v11, v11, v38
  v_add_f32 v10, v10, v35
  v_cvt_pk_bf16_f32 v233, v34, v35
  v_mfma_f32_16x16x32_bf16 v[44:47], v[24:27], v[124:127], v[44:47]
  ds_read_b128 v[24:27], v1 offset:2048
  v_add_f32 v11, v11, v39
  v_cvt_pk_bf16_f32 v237, v38, v39
  s_barrier
  s_waitcnt lgkmcnt(3)
  v_mfma_f32_16x16x32_bf16 v[32:35], v[28:31], v[64:67], v[52:55]
  v_mfma_f32_16x16x32_bf16 v[36:39], v[28:31], v[68:71], v[60:63]
  ds_read_b128 v[28:31], v2 offset:2048
  v_mfma_f32_16x16x32_bf16 v[32:35], v[12:15], v[72:75], v[32:35]
  v_max3_f32 v48, v40, v41, v42
  v_max3_f32 v49, v43, v44, v45
  v_max3_f32 v48, v48, v46, v47
  v_mfma_f32_16x16x32_bf16 v[36:39], v[12:15], v[76:79], v[36:39]
  ds_read_b128 v[12:15], v1 offset:3072
  v_max_f32 v48, v48, v49
  v_cmp_lt_f32 vcc, s13, v48
  s_cbranch_vccnz L_rs26
L_rb26:
  s_waitcnt lgkmcnt(3)
  v_mfma_f32_16x16x32_bf16 v[32:35], v[16:19], v[80:83], v[32:35]
  v_exp_f32 v40, v40
  v_exp_f32 v44, v44
  v_mfma_f32_16x16x32_bf16 v[36:39], v[16:19], v[84:87], v[36:39]
  ds_read_b128 v[16:19], v2 offset:3072
  v_exp_f32 v41, v41
  v_mfma_f32_16x16x32_bf16 v[32:35], v[20:23], v[88:91], v[32:35]
  v_add_f32 v10, v10, v40
  v_mfma_f32_16x16x32_bf16 v[36:39], v[20:23], v[92:95], v[36:39]
  ds_read_b128 v[20:23], v1 offset:8192
  v_exp_f32 v45, v45
  v_add_f32 v11, v11, v44
  s_waitcnt lgkmcnt(3)
  v_mfma_f32_16x16x32_bf16 v[32:35], v[24:27], v[96:99], v[32:35]
  v_exp_f32 v42, v42
  v_mfma_f32_16x16x32_bf16 v[36:39], v[24:27], v[100:103], v[36:39]
  ds_read_b128 v[24:27], v2 offset:8192
  v_add_f32 v10, v10, v41
  v_cvt_pk_bf16_f32 v234, v40, v41
  v_mfma_f32_16x16x32_bf16 v[32:35], v[28:31], v[104:107], v[32:35]
  v_exp_f32 v46, v46
  v_add_f32 v11, v11, v45
  v_mfma_f32_16x16x32_bf16 v[36:39], v[28:31], v[108:111], v[36:39]
  ds_read_b128 v[28:31], v1 offset:9216
  v_cvt_pk_bf16_f32 v238, v44, v45
  v_exp_f32 v43, v43
  s_waitcnt lgkmcnt(3)
  v_mfma_f32_16x16x32_bf16 v[32:35], v[12:15], v[112:115], v[32:35]
  v_add_f32 v10, v10, v42
  v_mfma_f32_16x16x32_bf16 v[36:39], v[12:15], v[116:119], v[36:39]
  ds_read_b128 v[12:15], v2 offset:9216
  v_exp_f32 v47, v47
  v_add_f32 v11, v11, v46
  v_mfma_f32_16x16x32_bf16 v[32:35], v[16:19], v[120:123], v[32:35]
  v_add_f32 v10, v10, v43
  v_cvt_pk_bf16_f32 v235, v42, v43
  v_mfma_f32_16x16x32_bf16 v[36:39], v[16:19], v[124:127], v[36:39]
  ds_read_b128 v[16:19], v1 offset:10240
  v_add_f32 v11, v11, v47
  v_cvt_pk_bf16_f32 v239, v46, v47
  s_waitcnt lgkmcnt(3)
  v_mfma_f32_16x16x32_bf16 v[40:43], v[20:23], v[64:67], v[52:55]
  v_mfma_f32_16x16x32_bf16 v[44:47], v[20:23], v[68:71], v[60:63]
  ds_read_b128 v[20:23], v2 offset:10240
  v_mfma_f32_16x16x32_bf16 v[40:43], v[24:27], v[72:75], v[40:43]
  v_mfma_f32_16x16x32_bf16 v[44:47], v[24:27], v[76:79], v[44:47]
  ds_read_b128 v[24:27], v1 offset:11264
  v_max3_f32 v48, v32, v33, v34
  v_max3_f32 v49, v35, v36, v37
  v_max3_f32 v48, v48, v38, v39
  s_waitcnt lgkmcnt(3)
  v_mfma_f32_16x16x32_bf16 v[40:43], v[28:31], v[80:83], v[40:43]
  v_max_f32 v48, v48, v49
  v_cmp_lt_f32 vcc, s13, v48
  s_cbranch_vccnz L_rs27
L_rb27:
  v_exp_f32 v32, v32
  v_mfma_f32_16x16x32_bf16 v[44:47], v[28:31], v[84:87], v[44:47]
  ds_read_b128 v[28:31], v2 offset:11264
  v_exp_f32 v36, v36
  v_mfma_f32_16x16x32_bf16 v[40:43], v[12:15], v[88:91], v[40:43]
  v_exp_f32 v33, v33
  v_mfma_f32_16x16x32_bf16 v[44:47], v[12:15], v[92:95], v[44:47]
  s_cmp_eq_u32 s45, 65536
  s_cselect_b32 s11, s61, s62
  s_add_u32 s45, s45, s11
  v_add_u32 v1, s11, v1
  v_add_u32 v2, s11, v2
  ds_read_b128 v[12:15], v1 offset:0
  v_add_f32 v10, v10, v32
  v_exp_f32 v37, v37
  s_waitcnt lgkmcnt(3)
  v_mfma_f32_16x16x32_bf16 v[40:43], v[16:19], v[96:99], v[40:43]
  v_add_f32 v11, v11, v36
  v_exp_f32 v34, v34
  v_mfma_f32_16x16x32_bf16 v[44:47], v[16:19], v[100:103], v[44:47]
  ds_read_b128 v[16:19], v2 offset:0
  v_add_f32 v10, v10, v33
  v_mfma_f32_16x16x32_bf16 v[40:43], v[20:23], v[104:107], v[40:43]
  v_cvt_pk_bf16_f32 v240, v32, v33
  v_exp_f32 v38, v38
  v_mfma_f32_16x16x32_bf16 v[44:47], v[20:23], v[108:111], v[44:47]
  ds_read_b128 v[20:23], v1 offset:1024
  v_add_f32 v11, v11, v37
  v_cvt_pk_bf16_f32 v244, v36, v37
  s_waitcnt lgkmcnt(3)
  v_mfma_f32_16x16x32_bf16 v[40:43], v[24:27], v[112:115], v[40:43]
  v_exp_f32 v35, v35
  v_add_f32 v10, v10, v34
  v_mfma_f32_16x16x32_bf16 v[44:47], v[24:27], v[116:119], v[44:47]
  ds_read_b128 v[24:27], v2 offset:1024
  v_exp_f32 v39, v39
  v_mfma_f32_16x16x32_bf16 v[40:43], v[28:31], v[120:123], v[40:43]
  v_add_f32 v11, v11, v38
  v_add_f32 v10, v10, v35
  v_cvt_pk_bf16_f32 v241, v34, v35
  v_mfma_f32_16x16x32_bf16 v[44:47], v[28:31], v[124:127], v[44:47]
  ds_read_b128 v[28:31], v1 offset:2048
  v_add_f32 v11, v11, v39
  v_cvt_pk_bf16_f32 v245, v38, v39
  s_barrier
  s_waitcnt lgkmcnt(3)
  v_mfma_f32_16x16x32_bf16 v[32:35], v[12:15], v[64:67], v[52:55]
  v_mfma_f32_16x16x32_bf16 v[36:39], v[12:15], v[68:71], v[60:63]
  ds_read_b128 v[12:15], v2 offset:2048
  v_mfma_f32_16x16x32_bf16 v[32:35], v[16:19], v[72:75], v[32:35]
  v_max3_f32 v48, v40, v41, v42
  v_max3_f32 v49, v43, v44, v45
  v_max3_f32 v48, v48, v46, v47
  v_mfma_f32_16x16x32_bf16 v[36:39], v[16:19], v[76:79], v[36:39]
  ds_read_b128 v[16:19], v1 offset:3072
  v_max_f32 v48, v48, v49
  v_cmp_lt_f32 vcc, s13, v48
  s_cbranch_vccnz L_rs28
L_rb28:
  s_waitcnt lgkmcnt(3)
  v_mfma_f32_16x16x32_bf16 v[32:35], v[20:23], v[80:83], v[32:35]
  v_exp_f32 v40, v40
  v_exp_f32 v44, v44
  v_mfma_f32_16x16x32_bf16 v[36:39], v[20:23], v[84:87], v[36:39]
  ds_read_b128 v[20:23], v2 offset:3072
  v_exp_f32 v41, v41
  v_mfma_f32_16x16x32_bf16 v[32:35], v[24:27], v[88:91], v[32:35]
  v_add_f32 v10, v10, v40
  v_mfma_f32_16x16x32_bf16 v[36:39], v[24:27], v[92:95], v[36:39]
  ds_read_b128 v[24:27], v1 offset:8192
  v_exp_f32 v45, v45
  v_add_f32 v11, v11, v44
  s_waitcnt lgkmcnt(3)
  v_mfma_f32_16x16x32_bf16 v[32:35], v[28:31], v[96:99], v[32:35]
  v_exp_f32 v42, v42
  v_mfma_f32_16x16x32_bf16 v[36:39], v[28:31], v[100:103], v[36:39]
  ds_read_b128 v[28:31], v2 offset:8192
  v_add_f32 v10, v10, v41
  v_cvt_pk_bf16_f32 v242, v40, v41
  v_mfma_f32_16x16x32_bf16 v[32:35], v[12:15], v[104:107], v[32:35]
  v_exp_f32 v46, v46
  v_add_f32 v11, v11, v45
  v_mfma_f32_16x16x32_bf16 v[36:39], v[12:15], v[108:111], v[36:39]
  ds_read_b128 v[12:15], v1 offset:9216
  v_cvt_pk_bf16_f32 v246, v44, v45
  v_exp_f32 v43, v43
  s_waitcnt lgkmcnt(3)
  v_mfma_f32_16x16x32_bf16 v[32:35], v[16:19], v[112:115], v[32:35]
  v_add_f32 v10, v10, v42
  v_mfma_f32_16x16x32_bf16 v[36:39], v[16:19], v[116:119], v[36:39]
  ds_read_b128 v[16:19], v2 offset:9216
  v_exp_f32 v47, v47
  v_add_f32 v11, v11, v46
  v_mfma_f32_16x16x32_bf16 v[32:35], v[20:23], v[120:123], v[32:35]
  v_add_f32 v10, v10, v43
  v_cvt_pk_bf16_f32 v243, v42, v43
  v_mfma_f32_16x16x32_bf16 v[36:39], v[20:23], v[124:127], v[36:39]
  ds_read_b128 v[20:23], v1 offset:10240
  v_add_f32 v11, v11, v47
  v_cvt_pk_bf16_f32 v247, v46, v47
  s_waitcnt lgkmcnt(3)
  v_mfma_f32_16x16x32_bf16 v[56:59], v[24:27], v[64:67], v[52:55]
  v_mfma_f32_16x16x32_bf16 v[60:63], v[24:27], v[68:71], v[60:63]
  ds_read_b128 v[24:27], v2 offset:10240
  v_mfma_f32_16x16x32_bf16 v[56:59], v[28:31], v[72:75], v[56:59]
  v_mfma_f32_16x16x32_bf16 v[60:63], v[28:31], v[76:79], v[60:63]
  ds_read_b128 v[28:31], v1 offset:11264
  v_max3_f32 v48, v32, v33, v34
  v_max3_f32 v49, v35, v36, v37
  v_max3_f32 v48, v48, v38, v39
  s_waitcnt lgkmcnt(3)
  v_mfma_f32_16x16x32_bf16 v[56:59], v[12:15], v[80:83], v[56:59]
  v_max_f32 v48, v48, v49
  v_cmp_lt_f32 vcc, s13, v48
  s_cbranch_vccnz L_rs29
L_rb29:
  v_exp_f32 v32, v32
  v_mfma_f32_16x16x32_bf16 v[60:63], v[12:15], v[84:87], v[60:63]
  ds_read_b128 v[12:15], v2 offset:11264
  v_exp_f32 v36, v36
  v_mfma_f32_16x16x32_bf16 v[56:59], v[16:19], v[88:91], v[56:59]
  v_exp_f32 v33, v33
  v_mfma_f32_16x16x32_bf16 v[60:63], v[16:19], v[92:95], v[60:63]
  s_mov_b32 s46, s45
  s_add_u32 s45, s45, 16384
  s_cmp_eq_u32 s45, 81920
  s_cselect_b32 s45, 0, s45
  s_sub_u32 s11, s45, s47
  v_add_u32 v3, s11, v3
  v_add_u32 v4, s11, v4
  v_add_u32 v5, s11, v5
  v_add_u32 v6, s11, v6
  ds_read_b64_tr_b16 v[16:17], v4 offset:0
  ds_read_b64_tr_b16 v[18:19], v4 offset:2048
  v_add_f32 v10, v10, v32
  v_exp_f32 v37, v37
  s_waitcnt lgkmcnt(4)
  v_mfma_f32_16x16x32_bf16 v[56:59], v[20:23], v[96:99], v[56:59]
  v_add_f32 v11, v11, v36
  v_exp_f32 v34, v34
  v_mfma_f32_16x16x32_bf16 v[60:63], v[20:23], v[100:103], v[60:63]
  ds_read_b64_tr_b16 v[20:21], v3 offset:4096
  ds_read_b64_tr_b16 v[22:23], v3 offset:6144
  v_add_f32 v10, v10, v33
  v_mfma_f32_16x16x32_bf16 v[56:59], v[24:27], v[104:107], v[56:59]
  v_cvt_pk_bf16_f32 v248, v32, v33
  v_exp_f32 v38, v38
  v_mfma_f32_16x16x32_bf16 v[60:63], v[24:27], v[108:111], v[60:63]
  ds_read_b64_tr_b16 v[24:25], v4 offset:4096
  ds_read_b64_tr_b16 v[26:27], v4 offset:6144
  v_add_f32 v11, v11, v37
  v_cvt_pk_bf16_f32 v252, v36, v37
  s_waitcnt lgkmcnt(6)
  v_mfma_f32_16x16x32_bf16 v[56:59], v[28:31], v[112:115], v[56:59]
  v_exp_f32 v35, v35
  v_add_f32 v10, v10, v34
  v_mfma_f32_16x16x32_bf16 v[60:63], v[28:31], v[116:119], v[60:63]
  ds_read_b64_tr_b16 v[28:29], v3 offset:8192
  ds_read_b64_tr_b16 v[30:31], v3 offset:10240
  v_exp_f32 v39, v39
  v_mfma_f32_16x16x32_bf16 v[56:59], v[12:15], v[120:123], v[56:59]
  v_add_f32 v11, v11, v38
  v_add_f32 v10, v10, v35
  v_cvt_pk_bf16_f32 v249, v34, v35
  v_mfma_f32_16x16x32_bf16 v[60:63], v[12:15], v[124:127], v[60:63]
  ds_read_b64_tr_b16 v[12:13], v3 offset:0
  ds_read_b64_tr_b16 v[14:15], v3 offset:2048
  v_add_f32 v11, v11, v39
  v_cvt_pk_bf16_f32 v253, v38, v39
  v_max3_f32 v48, v56, v57, v58
  s_nop 2
  v_max3_f32 v49, v59, v60, v61
  v_max3_f32 v48, v48, v62, v63
  v_max_f32 v48, v48, v49
  v_cmp_lt_f32 vcc, s13, v48
  s_cbranch_vccnz L_rs30
L_rb30:
  s_barrier
  s_waitcnt lgkmcnt(8)
  s_waitcnt lgkmcnt(0)
  v_mfma_f32_16x16x32_bf16 v[32:35], v[12:15], v[128:131], 0
  v_exp_f32 v56, v56
  v_exp_f32 v60, v60
  v_mfma_f32_16x16x32_bf16 v[40:43], v[12:15], v[132:135], 0
  ds_read_b64_tr_b16 v[12:13], v4 offset:8192
  ds_read_b64_tr_b16 v[14:15], v4 offset:10240
  v_exp_f32 v57, v57
  v_mfma_f32_16x16x32_bf16 v[36:39], v[16:19], v[128:131], 0
  v_add_f32 v10, v10, v56
  v_exp_f32 v61, v61
  v_mfma_f32_16x16x32_bf16 v[44:47], v[16:19], v[132:135], 0
  ds_read_b64_tr_b16 v[16:17], v3 offset:12288
  ds_read_b64_tr_b16 v[18:19], v3 offset:14336
  v_add_f32 v11, v11, v60
  v_exp_f32 v58, v58
  v_mfma_f32_16x16x32_bf16 v[32:35], v[20:23], v[136:139], v[32:35]
  v_add_f32 v10, v10, v57
  v_cvt_pk_bf16_f32 v250, v56, v57
  v_mfma_f32_16x16x32_bf16 v[40:43], v[20:23], v[140:143], v[40:43]
  ds_read_b64_tr_b16 v[20:21], v4 offset:12288
  ds_read_b64_tr_b16 v[22:23], v4 offset:14336
  v_exp_f32 v62, v62
  v_mfma_f32_16x16x32_bf16 v[36:39], v[24:27], v[136:139], v[36:39]
  v_add_f32 v11, v11, v61
  v_cvt_pk_bf16_f32 v254, v60, v61
  v_exp_f32 v59, v59
  v_mfma_f32_16x16x32_bf16 v[44:47], v[24:27], v[140:143], v[44:47]
  ds_read_b64_tr_b16 v[24:25], v5 offset:0
  ds_read_b64_tr_b16 v[26:27], v5 offset:2048
  v_add_f32 v10, v10, v58
  s_waitcnt lgkmcnt(6)
  v_mfma_f32_16x16x32_bf16 v[32:35], v[28:31], v[144:147], v[32:35]
  v_exp_f32 v63, v63
  v_add_f32 v11, v11, v62
  v_mfma_f32_16x16x32_bf16 v[40:43], v[28:31], v[148:151], v[40:43]
  ds_read_b64_tr_b16 v[28:29], v6 offset:0
  ds_read_b64_tr_b16 v[30:31], v6 offset:2048
  v_add_f32 v10, v10, v59
  v_cvt_pk_bf16_f32 v251, v58, v59
  v_add_f32 v11, v11, v63
  v_mfma_f32_16x16x32_bf16 v[36:39], v[12:15], v[144:147], v[36:39]
  v_cvt_pk_bf16_f32 v255, v62, v63
  v_mov_b32 v48, v10
  v_mfma_f32_16x16x32_bf16 v[44:47], v[12:15], v[148:151], v[44:47]
  ds_read_b64_tr_b16 v[12:13], v5 offset:4096
  ds_read_b64_tr_b16 v[14:15], v5 offset:6144
  v_mov_b32 v49, v11
  v_permlane32_swap_b32 v10, v48
  s_nop 0
  v_permlane32_swap_b32 v11, v49
  s_waitcnt lgkmcnt(6)
  v_mfma_f32_16x16x32_bf16 v[32:35], v[16:19], v[152:155], v[32:35]
  v_add_f32 v10, v10, v48
  v_add_f32 v11, v11, v49
  v_mov_b32 v48, v10
  v_mfma_f32_16x16x32_bf16 v[40:43], v[16:19], v[156:159], v[40:43]
  ds_read_b64_tr_b16 v[16:17], v6 offset:4096
  ds_read_b64_tr_b16 v[18:19], v6 offset:6144
  v_mov_b32 v49, v11
  v_permlane16_swap_b32 v10, v48
  v_mfma_f32_16x16x32_bf16 v[36:39], v[20:23], v[152:155], v[36:39]
  v_permlane16_swap_b32 v11, v49
  v_add_f32 v10, v10, v48
  v_add_f32 v11, v11, v49
  v_mfma_f32_16x16x32_bf16 v[44:47], v[20:23], v[156:159], v[44:47]
  ds_read_b64_tr_b16 v[20:21], v5 offset:8192
  ds_read_b64_tr_b16 v[22:23], v5 offset:10240
  v_rcp_f32 v10, v10
  v_rcp_f32 v11, v11
  s_waitcnt lgkmcnt(6)
  v_mfma_f32_16x16x32_bf16 v[48:51], v[24:27], v[128:131], 0
  v_mfma_f32_16x16x32_bf16 v[56:59], v[24:27], v[132:135], 0
  ds_read_b64_tr_b16 v[24:25], v6 offset:8192
  ds_read_b64_tr_b16 v[26:27], v6 offset:10240
  v_mfma_f32_16x16x32_bf16 v[52:55], v[28:31], v[128:131], 0
  v_mfma_f32_16x16x32_bf16 v[60:63], v[28:31], v[132:135], 0
  ds_read_b64_tr_b16 v[28:29], v5 offset:12288
  ds_read_b64_tr_b16 v[30:31], v5 offset:14336
  s_waitcnt lgkmcnt(6)
  v_mfma_f32_16x16x32_bf16 v[48:51], v[12:15], v[136:139], v[48:51]
  v_mfma_f32_16x16x32_bf16 v[56:59], v[12:15], v[140:143], v[56:59]
  ds_read_b64_tr_b16 v[12:13], v6 offset:12288
  ds_read_b64_tr_b16 v[14:15], v6 offset:14336
  v_mfma_f32_16x16x32_bf16 v[52:55], v[16:19], v[136:139], v[52:55]
  v_mfma_f32_16x16x32_bf16 v[60:63], v[16:19], v[140:143], v[60:63]
  s_cmp_eq_u32 s45, 65536
  s_cselect_b32 s11, s61, s62
  s_add_u32 s45, s45, s11
  v_add_u32 v3, s11, v3
  v_add_u32 v4, s11, v4
  v_add_u32 v5, s11, v5
  v_add_u32 v6, s11, v6
  ds_read_b64_tr_b16 v[16:17], v3 offset:0
  ds_read_b64_tr_b16 v[18:19], v3 offset:2048
  s_waitcnt lgkmcnt(6)
  v_mfma_f32_16x16x32_bf16 v[48:51], v[20:23], v[144:147], v[48:51]
  v_mfma_f32_16x16x32_bf16 v[56:59], v[20:23], v[148:151], v[56:59]
  ds_read_b64_tr_b16 v[20:21], v4 offset:0
  ds_read_b64_tr_b16 v[22:23], v4 offset:2048
  v_mfma_f32_16x16x32_bf16 v[52:55], v[24:27], v[144:147], v[52:55]
  v_mfma_f32_16x16x32_bf16 v[60:63], v[24:27], v[148:151], v[60:63]
  ds_read_b64_tr_b16 v[24:25], v3 offset:4096
  ds_read_b64_tr_b16 v[26:27], v3 offset:6144
  s_waitcnt lgkmcnt(6)
  v_mfma_f32_16x16x32_bf16 v[48:51], v[28:31], v[152:155], v[48:51]
  v_mfma_f32_16x16x32_bf16 v[56:59], v[28:31], v[156:159], v[56:59]
  ds_read_b64_tr_b16 v[28:29], v4 offset:4096
  ds_read_b64_tr_b16 v[30:31], v4 offset:6144
  v_mfma_f32_16x16x32_bf16 v[52:55], v[12:15], v[152:155], v[52:55]
  v_mfma_f32_16x16x32_bf16 v[60:63], v[12:15], v[156:159], v[60:63]
  ds_read_b64_tr_b16 v[12:13], v3 offset:8192
  ds_read_b64_tr_b16 v[14:15], v3 offset:10240
  s_barrier
  s_waitcnt lgkmcnt(6)
  v_mfma_f32_16x16x32_bf16 v[32:35], v[16:19], v[160:163], v[32:35]
  v_mfma_f32_16x16x32_bf16 v[40:43], v[16:19], v[164:167], v[40:43]
  ds_read_b64_tr_b16 v[16:17], v4 offset:8192
  ds_read_b64_tr_b16 v[18:19], v4 offset:10240
  v_mfma_f32_16x16x32_bf16 v[36:39], v[20:23], v[160:163], v[36:39]
  v_mfma_f32_16x16x32_bf16 v[44:47], v[20:23], v[164:167], v[44:47]
  ds_read_b64_tr_b16 v[20:21], v3 offset:12288
  ds_read_b64_tr_b16 v[22:23], v3 offset:14336
  s_waitcnt lgkmcnt(6)
  v_mfma_f32_16x16x32_bf16 v[32:35], v[24:27], v[168:171], v[32:35]
  v_mfma_f32_16x16x32_bf16 v[40:43], v[24:27], v[172:175], v[40:43]
  ds_read_b64_tr_b16 v[24:25], v4 offset:12288
  ds_read_b64_tr_b16 v[26:27], v4 offset:14336
  v_mfma_f32_16x16x32_bf16 v[36:39], v[28:31], v[168:171], v[36:39]
  v_mfma_f32_16x16x32_bf16 v[44:47], v[28:31], v[172:175], v[44:47]
  ds_read_b64_tr_b16 v[28:29], v5 offset:0
  ds_read_b64_tr_b16 v[30:31], v5 offset:2048
  s_waitcnt lgkmcnt(6)
  v_mfma_f32_16x16x32_bf16 v[32:35], v[12:15], v[176:179], v[32:35]
  v_mfma_f32_16x16x32_bf16 v[40:43], v[12:15], v[180:183], v[40:43]
  ds_read_b64_tr_b16 v[12:13], v6 offset:0
  ds_read_b64_tr_b16 v[14:15], v6 offset:2048
  v_mfma_f32_16x16x32_bf16 v[36:39], v[16:19], v[176:179], v[36:39]
  v_mfma_f32_16x16x32_bf16 v[44:47], v[16:19], v[180:183], v[44:47]
  ds_read_b64_tr_b16 v[16:17], v5 offset:4096
  ds_read_b64_tr_b16 v[18:19], v5 offset:6144
  s_waitcnt lgkmcnt(6)
  v_mfma_f32_16x16x32_bf16 v[32:35], v[20:23], v[184:187], v[32:35]
  v_mfma_f32_16x16x32_bf16 v[40:43], v[20:23], v[188:191], v[40:43]
  ds_read_b64_tr_b16 v[20:21], v6 offset:4096
  ds_read_b64_tr_b16 v[22:23], v6 offset:6144
  v_mfma_f32_16x16x32_bf16 v[36:39], v[24:27], v[184:187], v[36:39]
  v_mfma_f32_16x16x32_bf16 v[44:47], v[24:27], v[188:191], v[44:47]
  ds_read_b64_tr_b16 v[24:25], v5 offset:8192
  ds_read_b64_tr_b16 v[26:27], v5 offset:10240
  s_waitcnt lgkmcnt(6)
  v_mfma_f32_16x16x32_bf16 v[48:51], v[28:31], v[160:163], v[48:51]
  v_mfma_f32_16x16x32_bf16 v[56:59], v[28:31], v[164:167], v[56:59]
  ds_read_b64_tr_b16 v[28:29], v6 offset:8192
  ds_read_b64_tr_b16 v[30:31], v6 offset:10240
  v_mfma_f32_16x16x32_bf16 v[52:55], v[12:15], v[160:163], v[52:55]
  v_mfma_f32_16x16x32_bf16 v[60:63], v[12:15], v[164:167], v[60:63]
  ds_read_b64_tr_b16 v[12:13], v5 offset:12288
  ds_read_b64_tr_b16 v[14:15], v5 offset:14336
  s_waitcnt lgkmcnt(6)
  v_mfma_f32_16x16x32_bf16 v[48:51], v[16:19], v[168:171], v[48:51]
  v_mfma_f32_16x16x32_bf16 v[56:59], v[16:19], v[172:175], v[56:59]
  ds_read_b64_tr_b16 v[16:17], v6 offset:12288
  ds_read_b64_tr_b16 v[18:19], v6 offset:14336
  v_mfma_f32_16x16x32_bf16 v[52:55], v[20:23], v[168:171], v[52:55]
  v_mfma_f32_16x16x32_bf16 v[60:63], v[20:23], v[172:175], v[60:63]
  s_cmp_eq_u32 s45, 65536
  s_cselect_b32 s11, s61, s62
  s_add_u32 s45, s45, s11
  v_add_u32 v3, s11, v3
  v_add_u32 v4, s11, v4
  v_add_u32 v5, s11, v5
  v_add_u32 v6, s11, v6
  ds_read_b64_tr_b16 v[20:21], v3 offset:0
  ds_read_b64_tr_b16 v[22:23], v3 offset:2048
  s_waitcnt lgkmcnt(6)
  v_mfma_f32_16x16x32_bf16 v[48:51], v[24:27], v[176:179], v[48:51]
  v_mfma_f32_16x16x32_bf16 v[56:59], v[24:27], v[180:183], v[56:59]
  ds_read_b64_tr_b16 v[24:25], v4 offset:0
  ds_read_b64_tr_b16 v[26:27], v4 offset:2048
  v_mfma_f32_16x16x32_bf16 v[52:55], v[28:31], v[176:179], v[52:55]
  v_mfma_f32_16x16x32_bf16 v[60:63], v[28:31], v[180:183], v[60:63]
  ds_read_b64_tr_b16 v[28:29], v3 offset:4096
  ds_read_b64_tr_b16 v[30:31], v3 offset:6144
  s_waitcnt lgkmcnt(6)
  v_mfma_f32_16x16x32_bf16 v[48:51], v[12:15], v[184:187], v[48:51]
  v_mfma_f32_16x16x32_bf16 v[56:59], v[12:15], v[188:191], v[56:59]
  ds_read_b64_tr_b16 v[12:13], v4 offset:4096
  ds_read_b64_tr_b16 v[14:15], v4 offset:6144
  v_mfma_f32_16x16x32_bf16 v[52:55], v[16:19], v[184:187], v[52:55]
  v_mfma_f32_16x16x32_bf16 v[60:63], v[16:19], v[188:191], v[60:63]
  ds_read_b64_tr_b16 v[16:17], v3 offset:8192
  ds_read_b64_tr_b16 v[18:19], v3 offset:10240
  s_barrier
  s_waitcnt lgkmcnt(6)
  v_mfma_f32_16x16x32_bf16 v[32:35], v[20:23], v[192:195], v[32:35]
  v_mfma_f32_16x16x32_bf16 v[40:43], v[20:23], v[196:199], v[40:43]
  ds_read_b64_tr_b16 v[20:21], v4 offset:8192
  ds_read_b64_tr_b16 v[22:23], v4 offset:10240
  v_mfma_f32_16x16x32_bf16 v[36:39], v[24:27], v[192:195], v[36:39]
  v_mfma_f32_16x16x32_bf16 v[44:47], v[24:27], v[196:199], v[44:47]
  ds_read_b64_tr_b16 v[24:25], v3 offset:12288
  ds_read_b64_tr_b16 v[26:27], v3 offset:14336
  s_waitcnt lgkmcnt(6)
  v_mfma_f32_16x16x32_bf16 v[32:35], v[28:31], v[200:203], v[32:35]
  v_mfma_f32_16x16x32_bf16 v[40:43], v[28:31], v[204:207], v[40:43]
  ds_read_b64_tr_b16 v[28:29], v4 offset:12288
  ds_read_b64_tr_b16 v[30:31], v4 offset:14336
  v_mfma_f32_16x16x32_bf16 v[36:39], v[12:15], v[200:203], v[36:39]
  v_mfma_f32_16x16x32_bf16 v[44:47], v[12:15], v[204:207], v[44:47]
  ds_read_b64_tr_b16 v[12:13], v5 offset:0
  ds_read_b64_tr_b16 v[14:15], v5 offset:2048
  s_waitcnt lgkmcnt(6)
  v_mfma_f32_16x16x32_bf16 v[32:35], v[16:19], v[208:211], v[32:35]
  v_mfma_f32_16x16x32_bf16 v[40:43], v[16:19], v[212:215], v[40:43]
  ds_read_b64_tr_b16 v[16:17], v6 offset:0
  ds_read_b64_tr_b16 v[18:19], v6 offset:2048
  v_mfma_f32_16x16x32_bf16 v[36:39], v[20:23], v[208:211], v[36:39]
  v_mfma_f32_16x16x32_bf16 v[44:47], v[20:23], v[212:215], v[44:47]
  ds_read_b64_tr_b16 v[20:21], v5 offset:4096
  ds_read_b64_tr_b16 v[22:23], v5 offset:6144
  s_waitcnt lgkmcnt(6)
  v_mfma_f32_16x16x32_bf16 v[32:35], v[24:27], v[216:219], v[32:35]
  v_mfma_f32_16x16x32_bf16 v[40:43], v[24:27], v[220:223], v[40:43]
  ds_read_b64_tr_b16 v[24:25], v6 offset:4096
  ds_read_b64_tr_b16 v[26:27], v6 offset:6144
  v_mfma_f32_16x16x32_bf16 v[36:39], v[28:31], v[216:219], v[36:39]
  v_mfma_f32_16x16x32_bf16 v[44:47], v[28:31], v[220:223], v[44:47]
  ds_read_b64_tr_b16 v[28:29], v5 offset:8192
  ds_read_b64_tr_b16 v[30:31], v5 offset:10240
  s_waitcnt lgkmcnt(6)
  v_mfma_f32_16x16x32_bf16 v[48:51], v[12:15], v[192:195], v[48:51]
  v_mfma_f32_16x16x32_bf16 v[56:59], v[12:15], v[196:199], v[56:59]
  ds_read_b64_tr_b16 v[12:13], v6 offset:8192
  ds_read_b64_tr_b16 v[14:15], v6 offset:10240
  v_mfma_f32_16x16x32_bf16 v[52:55], v[16:19], v[192:195], v[52:55]
  v_mfma_f32_16x16x32_bf16 v[60:63], v[16:19], v[196:199], v[60:63]
  ds_read_b64_tr_b16 v[16:17], v5 offset:12288
  ds_read_b64_tr_b16 v[18:19], v5 offset:14336
  s_waitcnt lgkmcnt(6)
  v_mfma_f32_16x16x32_bf16 v[48:51], v[20:23], v[200:203], v[48:51]
  v_mfma_f32_16x16x32_bf16 v[56:59], v[20:23], v[204:207], v[56:59]
  ds_read_b64_tr_b16 v[20:21], v6 offset:12288
  ds_read_b64_tr_b16 v[22:23], v6 offset:14336
  v_mfma_f32_16x16x32_bf16 v[52:55], v[24:27], v[200:203], v[52:55]
  v_mfma_f32_16x16x32_bf16 v[60:63], v[24:27], v[204:207], v[60:63]
  s_cmp_eq_u32 s45, 65536
  s_cselect_b32 s11, s61, s62
  s_add_u32 s45, s45, s11
  v_add_u32 v3, s11, v3
  v_add_u32 v4, s11, v4
  v_add_u32 v5, s11, v5
  v_add_u32 v6, s11, v6
  ds_read_b64_tr_b16 v[24:25], v3 offset:0
  ds_read_b64_tr_b16 v[26:27], v3 offset:2048
  s_waitcnt lgkmcnt(6)
  v_mfma_f32_16x16x32_bf16 v[48:51], v[28:31], v[208:211], v[48:51]
  v_mfma_f32_16x16x32_bf16 v[56:59], v[28:31], v[212:215], v[56:59]
  ds_read_b64_tr_b16 v[28:29], v4 offset:0
  ds_read_b64_tr_b16 v[30:31], v4 offset:2048
  v_mfma_f32_16x16x32_bf16 v[52:55], v[12:15], v[208:211], v[52:55]
  v_mfma_f32_16x16x32_bf16 v[60:63], v[12:15], v[212:215], v[60:63]
  ds_read_b64_tr_b16 v[12:13], v3 offset:4096
  ds_read_b64_tr_b16 v[14:15], v3 offset:6144
  s_waitcnt lgkmcnt(6)
  v_mfma_f32_16x16x32_bf16 v[48:51], v[16:19], v[216:219], v[48:51]
  v_mfma_f32_16x16x32_bf16 v[56:59], v[16:19], v[220:223], v[56:59]
  ds_read_b64_tr_b16 v[16:17], v4 offset:4096
  ds_read_b64_tr_b16 v[18:19], v4 offset:6144
  v_mfma_f32_16x16x32_bf16 v[52:55], v[20:23], v[216:219], v[52:55]
  v_mfma_f32_16x16x32_bf16 v[60:63], v[20:23], v[220:223], v[60:63]
  ds_read_b64_tr_b16 v[20:21], v3 offset:8192
  ds_read_b64_tr_b16 v[22:23], v3 offset:10240
  s_barrier
  s_waitcnt lgkmcnt(6)
  v_mfma_f32_16x16x32_bf16 v[32:35], v[24:27], v[224:227], v[32:35]
  v_mfma_f32_16x16x32_bf16 v[40:43], v[24:27], v[228:231], v[40:43]
  ds_read_b64_tr_b16 v[24:25], v4 offset:8192
  ds_read_b64_tr_b16 v[26:27], v4 offset:10240
  v_mfma_f32_16x16x32_bf16 v[36:39], v[28:31], v[224:227], v[36:39]
  v_mfma_f32_16x16x32_bf16 v[44:47], v[28:31], v[228:231], v[44:47]
  ds_read_b64_tr_b16 v[28:29], v3 offset:12288
  ds_read_b64_tr_b16 v[30:31], v3 offset:14336
  s_waitcnt lgkmcnt(6)
  v_mfma_f32_16x16x32_bf16 v[32:35], v[12:15], v[232:235], v[32:35]
  v_mfma_f32_16x16x32_bf16 v[40:43], v[12:15], v[236:239], v[40:43]
  ds_read_b64_tr_b16 v[12:13], v4 offset:12288
  ds_read_b64_tr_b16 v[14:15], v4 offset:14336
  v_mfma_f32_16x16x32_bf16 v[36:39], v[16:19], v[232:235], v[36:39]
  v_mfma_f32_16x16x32_bf16 v[44:47], v[16:19], v[236:239], v[44:47]
  ds_read_b64_tr_b16 v[16:17], v5 offset:0
  ds_read_b64_tr_b16 v[18:19], v5 offset:2048
  s_waitcnt lgkmcnt(6)
  v_mfma_f32_16x16x32_bf16 v[32:35], v[20:23], v[240:243], v[32:35]
  v_mfma_f32_16x16x32_bf16 v[40:43], v[20:23], v[244:247], v[40:43]
  ds_read_b64_tr_b16 v[20:21], v6 offset:0
  ds_read_b64_tr_b16 v[22:23], v6 offset:2048
  v_mfma_f32_16x16x32_bf16 v[36:39], v[24:27], v[240:243], v[36:39]
  v_mfma_f32_16x16x32_bf16 v[44:47], v[24:27], v[244:247], v[44:47]
  ds_read_b64_tr_b16 v[24:25], v5 offset:4096
  ds_read_b64_tr_b16 v[26:27], v5 offset:6144
  s_waitcnt lgkmcnt(6)
  v_mfma_f32_16x16x32_bf16 v[32:35], v[28:31], v[248:251], v[32:35]
  v_mfma_f32_16x16x32_bf16 v[40:43], v[28:31], v[252:255], v[40:43]
  ds_read_b64_tr_b16 v[28:29], v6 offset:4096
  ds_read_b64_tr_b16 v[30:31], v6 offset:6144
  v_mfma_f32_16x16x32_bf16 v[36:39], v[12:15], v[248:251], v[36:39]
  v_mfma_f32_16x16x32_bf16 v[44:47], v[12:15], v[252:255], v[44:47]
  ds_read_b64_tr_b16 v[12:13], v5 offset:8192
  ds_read_b64_tr_b16 v[14:15], v5 offset:10240
  s_waitcnt lgkmcnt(6)
  v_mfma_f32_16x16x32_bf16 v[48:51], v[16:19], v[224:227], v[48:51]
  v_mfma_f32_16x16x32_bf16 v[56:59], v[16:19], v[228:231], v[56:59]
  ds_read_b64_tr_b16 v[16:17], v6 offset:8192
  ds_read_b64_tr_b16 v[18:19], v6 offset:10240
  v_mfma_f32_16x16x32_bf16 v[52:55], v[20:23], v[224:227], v[52:55]
  v_mfma_f32_16x16x32_bf16 v[60:63], v[20:23], v[228:231], v[60:63]
  ds_read_b64_tr_b16 v[20:21], v5 offset:12288
  ds_read_b64_tr_b16 v[22:23], v5 offset:14336
  v_mul_f32 v32, v32, v10
  v_mul_f32 v33, v33, v10
  v_mul_f32 v34, v34, v10
  s_waitcnt lgkmcnt(6)
  v_mfma_f32_16x16x32_bf16 v[48:51], v[24:27], v[232:235], v[48:51]
  v_mul_f32 v35, v35, v10
  v_mul_f32 v36, v36, v10
  v_mfma_f32_16x16x32_bf16 v[56:59], v[24:27], v[236:239], v[56:59]
  ds_read_b64_tr_b16 v[24:25], v6 offset:12288
  ds_read_b64_tr_b16 v[26:27], v6 offset:14336
  v_mul_f32 v37, v37, v10
  v_mul_f32 v38, v38, v10
  v_mul_f32 v39, v39, v10
  v_mfma_f32_16x16x32_bf16 v[52:55], v[28:31], v[232:235], v[52:55]
  v_cvt_pk_bf16_f32 v64, v32, v33
  v_cvt_pk_bf16_f32 v65, v34, v35
  v_mfma_f32_16x16x32_bf16 v[60:63], v[28:31], v[236:239], v[60:63]
  s_cmp_eq_u32 s45, 65536
  s_cselect_b32 s11, s61, s62
  s_add_u32 s45, s45, s11
  v_add_u32 v3, s11, v3
  v_add_u32 v4, s11, v4
  v_add_u32 v5, s11, v5
  v_add_u32 v6, s11, v6
  ds_read_b64_tr_b16 v[28:29], v3 offset:0
  ds_read_b64_tr_b16 v[30:31], v3 offset:2048
  v_cvt_pk_bf16_f32 v66, v36, v37
  v_cvt_pk_bf16_f32 v67, v38, v39
  s_waitcnt lgkmcnt(6)
  v_mfma_f32_16x16x32_bf16 v[48:51], v[12:15], v[240:243], v[48:51]
  s_mov_b64 exec, s[48:49]
  ds_write_b128 v7, v[64:67] offset:0
  s_mov_b64 exec, -1
  v_mul_f32 v40, v40, v11
  v_mul_f32 v41, v41, v11
  v_mfma_f32_16x16x32_bf16 v[56:59], v[12:15], v[244:247], v[56:59]
  ds_read_b64_tr_b16 v[12:13], v4 offset:0
  ds_read_b64_tr_b16 v[14:15], v4 offset:2048
  v_mul_f32 v42, v42, v11
  v_mul_f32 v43, v43, v11
  v_mfma_f32_16x16x32_bf16 v[52:55], v[16:19], v[240:243], v[52:55]
  v_mul_f32 v44, v44, v11
  v_mul_f32 v45, v45, v11
  v_mfma_f32_16x16x32_bf16 v[60:63], v[16:19], v[244:247], v[60:63]
  ds_read_b64_tr_b16 v[16:17], v3 offset:4096
  ds_read_b64_tr_b16 v[18:19], v3 offset:6144
  v_mul_f32 v46, v46, v11
  v_mul_f32 v47, v47, v11
  v_cvt_pk_bf16_f32 v68, v40, v41
  s_waitcnt lgkmcnt(7)
  v_mfma_f32_16x16x32_bf16 v[48:51], v[20:23], v[248:251], v[48:51]
  v_cvt_pk_bf16_f32 v69, v42, v43
  v_cvt_pk_bf16_f32 v70, v44, v45
  v_mfma_f32_16x16x32_bf16 v[56:59], v[20:23], v[252:255], v[56:59]
  ds_read_b64_tr_b16 v[20:21], v4 offset:4096
  ds_read_b64_tr_b16 v[22:23], v4 offset:6144
  v_cvt_pk_bf16_f32 v71, v46, v47
  s_mov_b64 exec, s[48:49]
  ds_write_b128 v7, v[68:71] offset:1024
  s_mov_b64 exec, -1
  v_mfma_f32_16x16x32_bf16 v[52:55], v[24:27], v[248:251], v[52:55]
  v_mfma_f32_16x16x32_bf16 v[60:63], v[24:27], v[252:255], v[60:63]
  ds_read_b64_tr_b16 v[24:25], v3 offset:8192
  ds_read_b64_tr_b16 v[26:27], v3 offset:10240
  s_waitcnt lgkmcnt(2)
  s_barrier
  v_mfma_f32_16x16x32_bf16 v[32:35], v[28:31], v[128:131], 0
  v_mfma_f32_16x16x32_bf16 v[40:43], v[28:31], v[132:135], 0
  ds_read_b64_tr_b16 v[28:29], v4 offset:8192
  ds_read_b64_tr_b16 v[30:31], v4 offset:10240
  v_mfma_f32_16x16x32_bf16 v[36:39], v[12:15], v[128:131], 0
  v_mul_f32 v48, v48, v10
  v_mul_f32 v49, v49, v10
  v_mul_f32 v50, v50, v10
  v_mfma_f32_16x16x32_bf16 v[44:47], v[12:15], v[132:135], 0
  ds_read_b64_tr_b16 v[12:13], v3 offset:12288
  ds_read_b64_tr_b16 v[14:15], v3 offset:14336
  v_mul_f32 v51, v51, v10
  v_mul_f32 v52, v52, v10
  v_mfma_f32_16x16x32_bf16 v[32:35], v[16:19], v[136:139], v[32:35]
  v_mul_f32 v53, v53, v10
  v_mul_f32 v54, v54, v10
  v_mfma_f32_16x16x32_bf16 v[40:43], v[16:19], v[140:143], v[40:43]
  ds_read_b64_tr_b16 v[16:17], v4 offset:12288
  ds_read_b64_tr_b16 v[18:19], v4 offset:14336
  v_mul_f32 v55, v55, v10
  v_cvt_pk_bf16_f32 v72, v48, v49
  v_mfma_f32_16x16x32_bf16 v[36:39], v[20:23], v[136:139], v[36:39]
  v_cvt_pk_bf16_f32 v73, v50, v51
  v_cvt_pk_bf16_f32 v74, v52, v53
  v_mfma_f32_16x16x32_bf16 v[44:47], v[20:23], v[140:143], v[44:47]
  ds_read_b64_tr_b16 v[20:21], v5 offset:0
  ds_read_b64_tr_b16 v[22:23], v5 offset:2048
  v_cvt_pk_bf16_f32 v75, v54, v55
  s_mov_b64 exec, s[48:49]
  ds_write_b128 v7, v[72:75] offset:8192
  s_mov_b64 exec, -1
  s_waitcnt lgkmcnt(7)
  v_mfma_f32_16x16x32_bf16 v[32:35], v[24:27], v[144:147], v[32:35]
  v_mul_f32 v56, v56, v11
  v_mul_f32 v57, v57, v11
  v_mul_f32 v58, v58, v11
  v_mfma_f32_16x16x32_bf16 v[40:43], v[24:27], v[148:151], v[40:43]
  ds_read_b64_tr_b16 v[24:25], v6 offset:0
  ds_read_b64_tr_b16 v[26:27], v6 offset:2048
  v_mul_f32 v59, v59, v11
  v_mul_f32 v60, v60, v11
  v_mfma_f32_16x16x32_bf16 v[36:39], v[28:31], v[144:147], v[36:39]
  v_mul_f32 v61, v61, v11
  v_mul_f32 v62, v62, v11
  v_mfma_f32_16x16x32_bf16 v[44:47], v[28:31], v[148:151], v[44:47]
  ds_read_b64_tr_b16 v[28:29], v5 offset:4096
  ds_read_b64_tr_b16 v[30:31], v5 offset:6144
  v_mul_f32 v63, v63, v11
  v_cvt_pk_bf16_f32 v76, v56, v57
  s_waitcnt lgkmcnt(7)
  v_mfma_f32_16x16x32_bf16 v[32:35], v[12:15], v[152:155], v[32:35]
  v_cvt_pk_bf16_f32 v77, v58, v59
  v_cvt_pk_bf16_f32 v78, v60, v61
  v_mfma_f32_16x16x32_bf16 v[40:43], v[12:15], v[156:159], v[40:43]
  ds_read_b64_tr_b16 v[12:13], v6 offset:4096
  ds_read_b64_tr_b16 v[14:15], v6 offset:6144
  v_cvt_pk_bf16_f32 v79, v62, v63
  s_mov_b64 exec, s[48:49]
  ds_write_b128 v7, v[76:79] offset:9216
  s_mov_b64 exec, -1
  v_mfma_f32_16x16x32_bf16 v[36:39], v[16:19], v[152:155], v[36:39]
  v_mfma_f32_16x16x32_bf16 v[44:47], v[16:19], v[156:159], v[44:47]
  ds_read_b64_tr_b16 v[16:17], v5 offset:8192
  ds_read_b64_tr_b16 v[18:19], v5 offset:10240
  s_waitcnt lgkmcnt(7)
  v_mfma_f32_16x16x32_bf16 v[48:51], v[20:23], v[128:131], 0
  v_mfma_f32_16x16x32_bf16 v[56:59], v[20:23], v[132:135], 0
  ds_read_b64_tr_b16 v[20:21], v6 offset:8192
  ds_read_b64_tr_b16 v[22:23], v6 offset:10240
  v_mfma_f32_16x16x32_bf16 v[52:55], v[24:27], v[128:131], 0
  v_mfma_f32_16x16x32_bf16 v[60:63], v[24:27], v[132:135], 0
  ds_read_b64_tr_b16 v[24:25], v5 offset:12288
  ds_read_b64_tr_b16 v[26:27], v5 offset:14336
  s_waitcnt lgkmcnt(7)
  v_mfma_f32_16x16x32_bf16 v[48:51], v[28:31], v[136:139], v[48:51]
  v_mfma_f32_16x16x32_bf16 v[56:59], v[28:31], v[140:143], v[56:59]
  ds_read_b64_tr_b16 v[28:29], v6 offset:12288
  ds_read_b64_tr_b16 v[30:31], v6 offset:14336
  v_mfma_f32_16x16x32_bf16 v[52:55], v[12:15], v[136:139], v[52:55]
  v_mfma_f32_16x16x32_bf16 v[60:63], v[12:15], v[140:143], v[60:63]
  s_cmp_eq_u32 s45, 65536
  s_cselect_b32 s11, s61, s62
  s_add_u32 s45, s45, s11
  v_add_u32 v3, s11, v3
  v_add_u32 v4, s11, v4
  v_add_u32 v5, s11, v5
  v_add_u32 v6, s11, v6
  ds_read_b64_tr_b16 v[12:13], v3 offset:0
  ds_read_b64_tr_b16 v[14:15], v3 offset:2048
  s_waitcnt lgkmcnt(6)
  v_mfma_f32_16x16x32_bf16 v[48:51], v[16:19], v[144:147], v[48:51]
  v_mfma_f32_16x16x32_bf16 v[56:59], v[16:19], v[148:151], v[56:59]
  ds_read_b64_tr_b16 v[16:17], v4 offset:0
  ds_read_b64_tr_b16 v[18:19], v4 offset:2048
  v_mfma_f32_16x16x32_bf16 v[52:55], v[20:23], v[144:147], v[52:55]
  v_mfma_f32_16x16x32_bf16 v[60:63], v[20:23], v[148:151], v[60:63]
  ds_read_b64_tr_b16 v[20:21], v3 offset:4096
  ds_read_b64_tr_b16 v[22:23], v3 offset:6144
  s_waitcnt lgkmcnt(6)
  v_mfma_f32_16x16x32_bf16 v[48:51], v[24:27], v[152:155], v[48:51]
  v_mfma_f32_16x16x32_bf16 v[56:59], v[24:27], v[156:159], v[56:59]
  ds_read_b64_tr_b16 v[24:25], v4 offset:4096
  ds_read_b64_tr_b16 v[26:27], v4 offset:6144
  v_mfma_f32_16x16x32_bf16 v[52:55], v[28:31], v[152:155], v[52:55]
  v_mfma_f32_16x16x32_bf16 v[60:63], v[28:31], v[156:159], v[60:63]
  ds_read_b64_tr_b16 v[28:29], v3 offset:8192
  ds_read_b64_tr_b16 v[30:31], v3 offset:10240
  s_barrier
  s_waitcnt lgkmcnt(6)
  v_mfma_f32_16x16x32_bf16 v[32:35], v[12:15], v[160:163], v[32:35]
  v_mfma_f32_16x16x32_bf16 v[40:43], v[12:15], v[164:167], v[40:43]
  ds_read_b64_tr_b16 v[12:13], v4 offset:8192
  ds_read_b64_tr_b16 v[14:15], v4 offset:10240
  v_mfma_f32_16x16x32_bf16 v[36:39], v[16:19], v[160:163], v[36:39]
  v_mfma_f32_16x16x32_bf16 v[44:47], v[16:19], v[164:167], v[44:47]
  ds_read_b64_tr_b16 v[16:17], v3 offset:12288
  ds_read_b64_tr_b16 v[18:19], v3 offset:14336
  s_waitcnt lgkmcnt(6)
  v_mfma_f32_16x16x32_bf16 v[32:35], v[20:23], v[168:171], v[32:35]
  v_mfma_f32_16x16x32_bf16 v[40:43], v[20:23], v[172:175], v[40:43]
  ds_read_b64_tr_b16 v[20:21], v4 offset:12288
  ds_read_b64_tr_b16 v[22:23], v4 offset:14336
  v_mfma_f32_16x16x32_bf16 v[36:39], v[24:27], v[168:171], v[36:39]
  v_mfma_f32_16x16x32_bf16 v[44:47], v[24:27], v[172:175], v[44:47]
  ds_read_b64_tr_b16 v[24:25], v5 offset:0
  ds_read_b64_tr_b16 v[26:27], v5 offset:2048
  s_waitcnt lgkmcnt(6)
  v_mfma_f32_16x16x32_bf16 v[32:35], v[28:31], v[176:179], v[32:35]
  v_mfma_f32_16x16x32_bf16 v[40:43], v[28:31], v[180:183], v[40:43]
  ds_read_b64_tr_b16 v[28:29], v6 offset:0
  ds_read_b64_tr_b16 v[30:31], v6 offset:2048
  v_mfma_f32_16x16x32_bf16 v[36:39], v[12:15], v[176:179], v[36:39]
  v_mfma_f32_16x16x32_bf16 v[44:47], v[12:15], v[180:183], v[44:47]
  ds_read_b64_tr_b16 v[12:13], v5 offset:4096
  ds_read_b64_tr_b16 v[14:15], v5 offset:6144
  s_waitcnt lgkmcnt(6)
  v_mfma_f32_16x16x32_bf16 v[32:35], v[16:19], v[184:187], v[32:35]
  v_mfma_f32_16x16x32_bf16 v[40:43], v[16:19], v[188:191], v[40:43]
  ds_read_b64_tr_b16 v[16:17], v6 offset:4096
  ds_read_b64_tr_b16 v[18:19], v6 offset:6144
  v_mfma_f32_16x16x32_bf16 v[36:39], v[20:23], v[184:187], v[36:39]
  v_mfma_f32_16x16x32_bf16 v[44:47], v[20:23], v[188:191], v[44:47]
  ds_read_b64_tr_b16 v[20:21], v5 offset:8192
  ds_read_b64_tr_b16 v[22:23], v5 offset:10240
  s_waitcnt lgkmcnt(6)
  v_mfma_f32_16x16x32_bf16 v[48:51], v[24:27], v[160:163], v[48:51]
  v_mfma_f32_16x16x32_bf16 v[56:59], v[24:27], v[164:167], v[56:59]
  ds_read_b64_tr_b16 v[24:25], v6 offset:8192
  ds_read_b64_tr_b16 v[26:27], v6 offset:10240
  v_mfma_f32_16x16x32_bf16 v[52:55], v[28:31], v[160:163], v[52:55]
  v_mfma_f32_16x16x32_bf16 v[60:63], v[28:31], v[164:167], v[60:63]
  ds_read_b64_tr_b16 v[28:29], v5 offset:12288
  ds_read_b64_tr_b16 v[30:31], v5 offset:14336
  s_waitcnt lgkmcnt(6)
  v_mfma_f32_16x16x32_bf16 v[48:51], v[12:15], v[168:171], v[48:51]
  v_mfma_f32_16x16x32_bf16 v[56:59], v[12:15], v[172:175], v[56:59]
  ds_read_b64_tr_b16 v[12:13], v6 offset:12288
  ds_read_b64_tr_b16 v[14:15], v6 offset:14336
  v_mfma_f32_16x16x32_bf16 v[52:55], v[16:19], v[168:171], v[52:55]
  v_mfma_f32_16x16x32_bf16 v[60:63], v[16:19], v[172:175], v[60:63]
  s_cmp_eq_u32 s45, 65536
  s_cselect_b32 s11, s61, s62
  s_add_u32 s45, s45, s11
  v_add_u32 v3, s11, v3
  v_add_u32 v4, s11, v4
  v_add_u32 v5, s11, v5
  v_add_u32 v6, s11, v6
  ds_read_b64_tr_b16 v[16:17], v3 offset:0
  ds_read_b64_tr_b16 v[18:19], v3 offset:2048
  s_waitcnt lgkmcnt(6)
  v_mfma_f32_16x16x32_bf16 v[48:51], v[20:23], v[176:179], v[48:51]
  v_mfma_f32_16x16x32_bf16 v[56:59], v[20:23], v[180:183], v[56:59]
  ds_read_b64_tr_b16 v[20:21], v4 offset:0
  ds_read_b64_tr_b16 v[22:23], v4 offset:2048
  v_mfma_f32_16x16x32_bf16 v[52:55], v[24:27], v[176:179], v[52:55]
  v_mfma_f32_16x16x32_bf16 v[60:63], v[24:27], v[180:183], v[60:63]
  ds_read_b64_tr_b16 v[24:25], v3 offset:4096
  ds_read_b64_tr_b16 v[26:27], v3 offset:6144
  s_waitcnt lgkmcnt(6)
  v_mfma_f32_16x16x32_bf16 v[48:51], v[28:31], v[184:187], v[48:51]
  v_mfma_f32_16x16x32_bf16 v[56:59], v[28:31], v[188:191], v[56:59]
  ds_read_b64_tr_b16 v[28:29], v4 offset:4096
  ds_read_b64_tr_b16 v[30:31], v4 offset:6144
  v_mfma_f32_16x16x32_bf16 v[52:55], v[12:15], v[184:187], v[52:55]
  v_mfma_f32_16x16x32_bf16 v[60:63], v[12:15], v[188:191], v[60:63]
  ds_read_b64_tr_b16 v[12:13], v3 offset:8192
  ds_read_b64_tr_b16 v[14:15], v3 offset:10240
  s_barrier
  s_waitcnt lgkmcnt(6)
  v_mfma_f32_16x16x32_bf16 v[32:35], v[16:19], v[192:195], v[32:35]
  v_mfma_f32_16x16x32_bf16 v[40:43], v[16:19], v[196:199], v[40:43]
  ds_read_b64_tr_b16 v[16:17], v4 offset:8192
  ds_read_b64_tr_b16 v[18:19], v4 offset:10240
  v_mfma_f32_16x16x32_bf16 v[36:39], v[20:23], v[192:195], v[36:39]
  v_mfma_f32_16x16x32_bf16 v[44:47], v[20:23], v[196:199], v[44:47]
  ds_read_b64_tr_b16 v[20:21], v3 offset:12288
  ds_read_b64_tr_b16 v[22:23], v3 offset:14336
  s_waitcnt lgkmcnt(6)
  v_mfma_f32_16x16x32_bf16 v[32:35], v[24:27], v[200:203], v[32:35]
  v_mfma_f32_16x16x32_bf16 v[40:43], v[24:27], v[204:207], v[40:43]
  ds_read_b64_tr_b16 v[24:25], v4 offset:12288
  ds_read_b64_tr_b16 v[26:27], v4 offset:14336
  v_mfma_f32_16x16x32_bf16 v[36:39], v[28:31], v[200:203], v[36:39]
  v_mfma_f32_16x16x32_bf16 v[44:47], v[28:31], v[204:207], v[44:47]
  ds_read_b64_tr_b16 v[28:29], v5 offset:0
  ds_read_b64_tr_b16 v[30:31], v5 offset:2048
  s_waitcnt lgkmcnt(6)
  v_mfma_f32_16x16x32_bf16 v[32:35], v[12:15], v[208:211], v[32:35]
  v_mfma_f32_16x16x32_bf16 v[40:43], v[12:15], v[212:215], v[40:43]
  ds_read_b64_tr_b16 v[12:13], v6 offset:0
  ds_read_b64_tr_b16 v[14:15], v6 offset:2048
  v_mfma_f32_16x16x32_bf16 v[36:39], v[16:19], v[208:211], v[36:39]
  v_mfma_f32_16x16x32_bf16 v[44:47], v[16:19], v[212:215], v[44:47]
  ds_read_b64_tr_b16 v[16:17], v5 offset:4096
  ds_read_b64_tr_b16 v[18:19], v5 offset:6144
  s_waitcnt lgkmcnt(6)
  v_mfma_f32_16x16x32_bf16 v[32:35], v[20:23], v[216:219], v[32:35]
  v_mfma_f32_16x16x32_bf16 v[40:43], v[20:23], v[220:223], v[40:43]
  ds_read_b64_tr_b16 v[20:21], v6 offset:4096
  ds_read_b64_tr_b16 v[22:23], v6 offset:6144
  v_mfma_f32_16x16x32_bf16 v[36:39], v[24:27], v[216:219], v[36:39]
  v_mfma_f32_16x16x32_bf16 v[44:47], v[24:27], v[220:223], v[44:47]
  ds_read_b64_tr_b16 v[24:25], v5 offset:8192
  ds_read_b64_tr_b16 v[26:27], v5 offset:10240
  s_waitcnt lgkmcnt(6)
  v_mfma_f32_16x16x32_bf16 v[48:51], v[28:31], v[192:195], v[48:51]
  v_mfma_f32_16x16x32_bf16 v[56:59], v[28:31], v[196:199], v[56:59]
  ds_read_b64_tr_b16 v[28:29], v6 offset:8192
  ds_read_b64_tr_b16 v[30:31], v6 offset:10240
  v_mfma_f32_16x16x32_bf16 v[52:55], v[12:15], v[192:195], v[52:55]
  v_mfma_f32_16x16x32_bf16 v[60:63], v[12:15], v[196:199], v[60:63]
  ds_read_b64_tr_b16 v[12:13], v5 offset:12288
  ds_read_b64_tr_b16 v[14:15], v5 offset:14336
  s_waitcnt lgkmcnt(6)
  v_mfma_f32_16x16x32_bf16 v[48:51], v[16:19], v[200:203], v[48:51]
  v_mfma_f32_16x16x32_bf16 v[56:59], v[16:19], v[204:207], v[56:59]
  ds_read_b64_tr_b16 v[16:17], v6 offset:12288
  ds_read_b64_tr_b16 v[18:19], v6 offset:14336
  v_mfma_f32_16x16x32_bf16 v[52:55], v[20:23], v[200:203], v[52:55]
  v_mfma_f32_16x16x32_bf16 v[60:63], v[20:23], v[204:207], v[60:63]
  s_cmp_eq_u32 s45, 65536
  s_cselect_b32 s11, s61, s62
  s_add_u32 s45, s45, s11
  v_add_u32 v3, s11, v3
  v_add_u32 v4, s11, v4
  v_add_u32 v5, s11, v5
  v_add_u32 v6, s11, v6
  ds_read_b64_tr_b16 v[20:21], v3 offset:0
  ds_read_b64_tr_b16 v[22:23], v3 offset:2048
  s_waitcnt lgkmcnt(6)
  v_mfma_f32_16x16x32_bf16 v[48:51], v[24:27], v[208:211], v[48:51]
  v_mfma_f32_16x16x32_bf16 v[56:59], v[24:27], v[212:215], v[56:59]
  ds_read_b64_tr_b16 v[24:25], v4 offset:0
  ds_read_b64_tr_b16 v[26:27], v4 offset:2048
  v_mfma_f32_16x16x32_bf16 v[52:55], v[28:31], v[208:211], v[52:55]
  v_mfma_f32_16x16x32_bf16 v[60:63], v[28:31], v[212:215], v[60:63]
  ds_read_b64_tr_b16 v[28:29], v3 offset:4096
  ds_read_b64_tr_b16 v[30:31], v3 offset:6144
  s_waitcnt lgkmcnt(6)
  v_mfma_f32_16x16x32_bf16 v[48:51], v[12:15], v[216:219], v[48:51]
  v_mfma_f32_16x16x32_bf16 v[56:59], v[12:15], v[220:223], v[56:59]
  ds_read_b64_tr_b16 v[12:13], v4 offset:4096
  ds_read_b64_tr_b16 v[14:15], v4 offset:6144
  v_mfma_f32_16x16x32_bf16 v[52:55], v[16:19], v[216:219], v[52:55]
  v_mfma_f32_16x16x32_bf16 v[60:63], v[16:19], v[220:223], v[60:63]
  ds_read_b64_tr_b16 v[16:17], v3 offset:8192
  ds_read_b64_tr_b16 v[18:19], v3 offset:10240
  s_barrier
  s_waitcnt lgkmcnt(6)
  v_mfma_f32_16x16x32_bf16 v[32:35], v[20:23], v[224:227], v[32:35]
  v_mfma_f32_16x16x32_bf16 v[40:43], v[20:23], v[228:231], v[40:43]
  ds_read_b64_tr_b16 v[20:21], v4 offset:8192
  ds_read_b64_tr_b16 v[22:23], v4 offset:10240
  v_mfma_f32_16x16x32_bf16 v[36:39], v[24:27], v[224:227], v[36:39]
  v_mfma_f32_16x16x32_bf16 v[44:47], v[24:27], v[228:231], v[44:47]
  ds_read_b64_tr_b16 v[24:25], v3 offset:12288
  ds_read_b64_tr_b16 v[26:27], v3 offset:14336
  s_waitcnt lgkmcnt(6)
  v_mfma_f32_16x16x32_bf16 v[32:35], v[28:31], v[232:235], v[32:35]
  v_mfma_f32_16x16x32_bf16 v[40:43], v[28:31], v[236:239], v[40:43]
  ds_read_b64_tr_b16 v[28:29], v4 offset:12288
  ds_read_b64_tr_b16 v[30:31], v4 offset:14336
  v_mfma_f32_16x16x32_bf16 v[36:39], v[12:15], v[232:235], v[36:39]
  v_mfma_f32_16x16x32_bf16 v[44:47], v[12:15], v[236:239], v[44:47]
  ds_read_b64_tr_b16 v[12:13], v5 offset:0
  ds_read_b64_tr_b16 v[14:15], v5 offset:2048
  s_waitcnt lgkmcnt(6)
  v_mfma_f32_16x16x32_bf16 v[32:35], v[16:19], v[240:243], v[32:35]
  v_mfma_f32_16x16x32_bf16 v[40:43], v[16:19], v[244:247], v[40:43]
  ds_read_b64_tr_b16 v[16:17], v6 offset:0
  ds_read_b64_tr_b16 v[18:19], v6 offset:2048
  v_mfma_f32_16x16x32_bf16 v[36:39], v[20:23], v[240:243], v[36:39]
  v_mfma_f32_16x16x32_bf16 v[44:47], v[20:23], v[244:247], v[44:47]
  ds_read_b64_tr_b16 v[20:21], v5 offset:4096
  ds_read_b64_tr_b16 v[22:23], v5 offset:6144
  s_waitcnt lgkmcnt(6)
  v_mfma_f32_16x16x32_bf16 v[32:35], v[24:27], v[248:251], v[32:35]
  v_mfma_f32_16x16x32_bf16 v[40:43], v[24:27], v[252:255], v[40:43]
  ds_read_b64_tr_b16 v[24:25], v6 offset:4096
  ds_read_b64_tr_b16 v[26:27], v6 offset:6144
  v_mfma_f32_16x16x32_bf16 v[36:39], v[28:31], v[248:251], v[36:39]
  v_mfma_f32_16x16x32_bf16 v[44:47], v[28:31], v[252:255], v[44:47]
  ds_read_b64_tr_b16 v[28:29], v5 offset:8192
  ds_read_b64_tr_b16 v[30:31], v5 offset:10240
  s_waitcnt lgkmcnt(6)
  v_mfma_f32_16x16x32_bf16 v[48:51], v[12:15], v[224:227], v[48:51]
  v_mfma_f32_16x16x32_bf16 v[56:59], v[12:15], v[228:231], v[56:59]
  ds_read_b64_tr_b16 v[12:13], v6 offset:8192
  ds_read_b64_tr_b16 v[14:15], v6 offset:10240
  v_mfma_f32_16x16x32_bf16 v[52:55], v[16:19], v[224:227], v[52:55]
  v_mfma_f32_16x16x32_bf16 v[60:63], v[16:19], v[228:231], v[60:63]
  ds_read_b64_tr_b16 v[16:17], v5 offset:12288
  ds_read_b64_tr_b16 v[18:19], v5 offset:14336
  v_mul_f32 v32, v32, v10
  v_mul_f32 v33, v33, v10
  v_mul_f32 v34, v34, v10
  s_waitcnt lgkmcnt(6)
  v_mfma_f32_16x16x32_bf16 v[48:51], v[20:23], v[232:235], v[48:51]
  v_mul_f32 v35, v35, v10
  v_mul_f32 v36, v36, v10
  v_mfma_f32_16x16x32_bf16 v[56:59], v[20:23], v[236:239], v[56:59]
  ds_read_b64_tr_b16 v[20:21], v6 offset:12288
  ds_read_b64_tr_b16 v[22:23], v6 offset:14336
  v_mul_f32 v37, v37, v10
  v_mul_f32 v38, v38, v10
  v_mul_f32 v39, v39, v10
  v_mfma_f32_16x16x32_bf16 v[52:55], v[24:27], v[232:235], v[52:55]
  v_cvt_pk_bf16_f32 v80, v32, v33
  v_cvt_pk_bf16_f32 v81, v34, v35
  v_mfma_f32_16x16x32_bf16 v[60:63], v[24:27], v[236:239], v[60:63]
  s_cmp_eq_u32 s45, 65536
  s_cselect_b32 s11, s61, s62
  s_add_u32 s45, s45, s11
  v_add_u32 v3, s11, v3
  v_add_u32 v4, s11, v4
  v_add_u32 v5, s11, v5
  v_add_u32 v6, s11, v6
  ds_read_b64_tr_b16 v[24:25], v3 offset:0
  ds_read_b64_tr_b16 v[26:27], v3 offset:2048
  v_cvt_pk_bf16_f32 v82, v36, v37
  v_cvt_pk_bf16_f32 v83, v38, v39
  s_waitcnt lgkmcnt(6)
  v_mfma_f32_16x16x32_bf16 v[48:51], v[28:31], v[240:243], v[48:51]
  s_mov_b64 exec, s[48:49]
  ds_write_b128 v7, v[80:83] offset:0
  s_mov_b64 exec, -1
  v_mul_f32 v40, v40, v11
  v_mul_f32 v41, v41, v11
  v_mfma_f32_16x16x32_bf16 v[56:59], v[28:31], v[244:247], v[56:59]
  ds_read_b64_tr_b16 v[28:29], v4 offset:0
  ds_read_b64_tr_b16 v[30:31], v4 offset:2048
  v_mul_f32 v42, v42, v11
  v_mul_f32 v43, v43, v11
  v_mfma_f32_16x16x32_bf16 v[52:55], v[12:15], v[240:243], v[52:55]
  v_mul_f32 v44, v44, v11
  v_mul_f32 v45, v45, v11
  v_mfma_f32_16x16x32_bf16 v[60:63], v[12:15], v[244:247], v[60:63]
  ds_read_b64_tr_b16 v[12:13], v3 offset:4096
  ds_read_b64_tr_b16 v[14:15], v3 offset:6144
  v_mul_f32 v46, v46, v11
  v_mul_f32 v47, v47, v11
  v_cvt_pk_bf16_f32 v84, v40, v41
  s_waitcnt lgkmcnt(7)
  v_mfma_f32_16x16x32_bf16 v[48:51], v[16:19], v[248:251], v[48:51]
  v_cvt_pk_bf16_f32 v85, v42, v43
  v_cvt_pk_bf16_f32 v86, v44, v45
  v_mfma_f32_16x16x32_bf16 v[56:59], v[16:19], v[252:255], v[56:59]
  ds_read_b64_tr_b16 v[16:17], v4 offset:4096
  ds_read_b64_tr_b16 v[18:19], v4 offset:6144
  v_cvt_pk_bf16_f32 v87, v46, v47
  s_mov_b64 exec, s[48:49]
  ds_write_b128 v7, v[84:87] offset:1024
  s_mov_b64 exec, -1
  v_mfma_f32_16x16x32_bf16 v[52:55], v[20:23], v[248:251], v[52:55]
  v_mfma_f32_16x16x32_bf16 v[60:63], v[20:23], v[252:255], v[60:63]
  ds_read_b64_tr_b16 v[20:21], v3 offset:8192
  ds_read_b64_tr_b16 v[22:23], v3 offset:10240
  s_waitcnt lgkmcnt(2)
  s_barrier
  v_mfma_f32_16x16x32_bf16 v[32:35], v[24:27], v[128:131], 0
  v_mfma_f32_16x16x32_bf16 v[40:43], v[24:27], v[132:135], 0
  ds_read_b64_tr_b16 v[24:25], v4 offset:8192
  ds_read_b64_tr_b16 v[26:27], v4 offset:10240
  v_mfma_f32_16x16x32_bf16 v[36:39], v[28:31], v[128:131], 0
  v_mul_f32 v48, v48, v10
  v_mul_f32 v49, v49, v10
  v_mul_f32 v50, v50, v10
  v_mfma_f32_16x16x32_bf16 v[44:47], v[28:31], v[132:135], 0
  ds_read_b64_tr_b16 v[28:29], v3 offset:12288
  ds_read_b64_tr_b16 v[30:31], v3 offset:14336
  v_mul_f32 v51, v51, v10
  v_mul_f32 v52, v52, v10
  v_mfma_f32_16x16x32_bf16 v[32:35], v[12:15], v[136:139], v[32:35]
  v_mul_f32 v53, v53, v10
  v_mul_f32 v54, v54, v10
  v_mfma_f32_16x16x32_bf16 v[40:43], v[12:15], v[140:143], v[40:43]
  ds_read_b64_tr_b16 v[12:13], v4 offset:12288
  ds_read_b64_tr_b16 v[14:15], v4 offset:14336
  v_mul_f32 v55, v55, v10
  v_cvt_pk_bf16_f32 v88, v48, v49
  v_mfma_f32_16x16x32_bf16 v[36:39], v[16:19], v[136:139], v[36:39]
  v_cvt_pk_bf16_f32 v89, v50, v51
  v_cvt_pk_bf16_f32 v90, v52, v53
  v_mfma_f32_16x16x32_bf16 v[44:47], v[16:19], v[140:143], v[44:47]
  ds_read_b64_tr_b16 v[16:17], v5 offset:0
  ds_read_b64_tr_b16 v[18:19], v5 offset:2048
  v_cvt_pk_bf16_f32 v91, v54, v55
  s_mov_b64 exec, s[48:49]
  ds_write_b128 v7, v[88:91] offset:8192
  s_mov_b64 exec, -1
  s_waitcnt lgkmcnt(7)
  v_mfma_f32_16x16x32_bf16 v[32:35], v[20:23], v[144:147], v[32:35]
  v_mul_f32 v56, v56, v11
  v_mul_f32 v57, v57, v11
  v_mul_f32 v58, v58, v11
  v_mfma_f32_16x16x32_bf16 v[40:43], v[20:23], v[148:151], v[40:43]
  ds_read_b64_tr_b16 v[20:21], v6 offset:0
  ds_read_b64_tr_b16 v[22:23], v6 offset:2048
  v_mul_f32 v59, v59, v11
  v_mul_f32 v60, v60, v11
  v_mfma_f32_16x16x32_bf16 v[36:39], v[24:27], v[144:147], v[36:39]
  v_mul_f32 v61, v61, v11
  v_mul_f32 v62, v62, v11
  v_mfma_f32_16x16x32_bf16 v[44:47], v[24:27], v[148:151], v[44:47]
  ds_read_b64_tr_b16 v[24:25], v5 offset:4096
  ds_read_b64_tr_b16 v[26:27], v5 offset:6144
  v_mul_f32 v63, v63, v11
  v_cvt_pk_bf16_f32 v92, v56, v57
  s_waitcnt lgkmcnt(7)
  v_mfma_f32_16x16x32_bf16 v[32:35], v[28:31], v[152:155], v[32:35]
  v_cvt_pk_bf16_f32 v93, v58, v59
  v_cvt_pk_bf16_f32 v94, v60, v61
  v_mfma_f32_16x16x32_bf16 v[40:43], v[28:31], v[156:159], v[40:43]
  ds_read_b64_tr_b16 v[28:29], v6 offset:4096
  ds_read_b64_tr_b16 v[30:31], v6 offset:6144
  v_cvt_pk_bf16_f32 v95, v62, v63
  s_mov_b64 exec, s[48:49]
  ds_write_b128 v7, v[92:95] offset:9216
  s_mov_b64 exec, -1
  v_mfma_f32_16x16x32_bf16 v[36:39], v[12:15], v[152:155], v[36:39]
  v_mfma_f32_16x16x32_bf16 v[44:47], v[12:15], v[156:159], v[44:47]
  ds_read_b64_tr_b16 v[12:13], v5 offset:8192
  ds_read_b64_tr_b16 v[14:15], v5 offset:10240
  s_waitcnt lgkmcnt(7)
  v_mfma_f32_16x16x32_bf16 v[48:51], v[16:19], v[128:131], 0
  v_mfma_f32_16x16x32_bf16 v[56:59], v[16:19], v[132:135], 0
  ds_read_b64_tr_b16 v[16:17], v6 offset:8192
  ds_read_b64_tr_b16 v[18:19], v6 offset:10240
  v_mfma_f32_16x16x32_bf16 v[52:55], v[20:23], v[128:131], 0
  v_mfma_f32_16x16x32_bf16 v[60:63], v[20:23], v[132:135], 0
  ds_read_b64_tr_b16 v[20:21], v5 offset:12288
  ds_read_b64_tr_b16 v[22:23], v5 offset:14336
  s_waitcnt lgkmcnt(7)
  v_mfma_f32_16x16x32_bf16 v[48:51], v[24:27], v[136:139], v[48:51]
  v_mfma_f32_16x16x32_bf16 v[56:59], v[24:27], v[140:143], v[56:59]
  ds_read_b64_tr_b16 v[24:25], v6 offset:12288
  ds_read_b64_tr_b16 v[26:27], v6 offset:14336
  v_mfma_f32_16x16x32_bf16 v[52:55], v[28:31], v[136:139], v[52:55]
  v_mfma_f32_16x16x32_bf16 v[60:63], v[28:31], v[140:143], v[60:63]
  s_cmp_eq_u32 s45, 65536
  s_cselect_b32 s11, s61, s62
  s_add_u32 s45, s45, s11
  v_add_u32 v3, s11, v3
  v_add_u32 v4, s11, v4
  v_add_u32 v5, s11, v5
  v_add_u32 v6, s11, v6
  ds_read_b64_tr_b16 v[28:29], v3 offset:0
  ds_read_b64_tr_b16 v[30:31], v3 offset:2048
  s_waitcnt lgkmcnt(6)
  v_mfma_f32_16x16x32_bf16 v[48:51], v[12:15], v[144:147], v[48:51]
  v_mfma_f32_16x16x32_bf16 v[56:59], v[12:15], v[148:151], v[56:59]
  ds_read_b64_tr_b16 v[12:13], v4 offset:0
  ds_read_b64_tr_b16 v[14:15], v4 offset:2048
  v_mfma_f32_16x16x32_bf16 v[52:55], v[16:19], v[144:147], v[52:55]
  v_mfma_f32_16x16x32_bf16 v[60:63], v[16:19], v[148:151], v[60:63]
  ds_read_b64_tr_b16 v[16:17], v3 offset:4096
  ds_read_b64_tr_b16 v[18:19], v3 offset:6144
  s_waitcnt lgkmcnt(6)
  v_mfma_f32_16x16x32_bf16 v[48:51], v[20:23], v[152:155], v[48:51]
  v_mfma_f32_16x16x32_bf16 v[56:59], v[20:23], v[156:159], v[56:59]
  ds_read_b64_tr_b16 v[20:21], v4 offset:4096
  ds_read_b64_tr_b16 v[22:23], v4 offset:6144
  v_mfma_f32_16x16x32_bf16 v[52:55], v[24:27], v[152:155], v[52:55]
  v_mfma_f32_16x16x32_bf16 v[60:63], v[24:27], v[156:159], v[60:63]
  ds_read_b64_tr_b16 v[24:25], v3 offset:8192
  ds_read_b64_tr_b16 v[26:27], v3 offset:10240
  s_barrier
  s_waitcnt lgkmcnt(6)
  v_mfma_f32_16x16x32_bf16 v[32:35], v[28:31], v[160:163], v[32:35]
  v_mfma_f32_16x16x32_bf16 v[40:43], v[28:31], v[164:167], v[40:43]
  ds_read_b64_tr_b16 v[28:29], v4 offset:8192
  ds_read_b64_tr_b16 v[30:31], v4 offset:10240
  v_mfma_f32_16x16x32_bf16 v[36:39], v[12:15], v[160:163], v[36:39]
  v_mfma_f32_16x16x32_bf16 v[44:47], v[12:15], v[164:167], v[44:47]
  ds_read_b64_tr_b16 v[12:13], v3 offset:12288
  ds_read_b64_tr_b16 v[14:15], v3 offset:14336
  s_waitcnt lgkmcnt(6)
  v_mfma_f32_16x16x32_bf16 v[32:35], v[16:19], v[168:171], v[32:35]
  v_mfma_f32_16x16x32_bf16 v[40:43], v[16:19], v[172:175], v[40:43]
  ds_read_b64_tr_b16 v[16:17], v4 offset:12288
  ds_read_b64_tr_b16 v[18:19], v4 offset:14336
  v_mfma_f32_16x16x32_bf16 v[36:39], v[20:23], v[168:171], v[36:39]
  v_mfma_f32_16x16x32_bf16 v[44:47], v[20:23], v[172:175], v[44:47]
  ds_read_b64_tr_b16 v[20:21], v5 offset:0
  ds_read_b64_tr_b16 v[22:23], v5 offset:2048
  s_waitcnt lgkmcnt(6)
  v_mfma_f32_16x16x32_bf16 v[32:35], v[24:27], v[176:179], v[32:35]
  v_mfma_f32_16x16x32_bf16 v[40:43], v[24:27], v[180:183], v[40:43]
  ds_read_b64_tr_b16 v[24:25], v6 offset:0
  ds_read_b64_tr_b16 v[26:27], v6 offset:2048
  v_mfma_f32_16x16x32_bf16 v[36:39], v[28:31], v[176:179], v[36:39]
  v_mfma_f32_16x16x32_bf16 v[44:47], v[28:31], v[180:183], v[44:47]
  ds_read_b64_tr_b16 v[28:29], v5 offset:4096
  ds_read_b64_tr_b16 v[30:31], v5 offset:6144
  s_waitcnt lgkmcnt(6)
  v_mfma_f32_16x16x32_bf16 v[32:35], v[12:15], v[184:187], v[32:35]
  v_mfma_f32_16x16x32_bf16 v[40:43], v[12:15], v[188:191], v[40:43]
  ds_read_b64_tr_b16 v[12:13], v6 offset:4096
  ds_read_b64_tr_b16 v[14:15], v6 offset:6144
  v_mfma_f32_16x16x32_bf16 v[36:39], v[16:19], v[184:187], v[36:39]
  v_mfma_f32_16x16x32_bf16 v[44:47], v[16:19], v[188:191], v[44:47]
  ds_read_b64_tr_b16 v[16:17], v5 offset:8192
  ds_read_b64_tr_b16 v[18:19], v5 offset:10240
  s_waitcnt lgkmcnt(6)
  v_mfma_f32_16x16x32_bf16 v[48:51], v[20:23], v[160:163], v[48:51]
  v_mfma_f32_16x16x32_bf16 v[56:59], v[20:23], v[164:167], v[56:59]
  ds_read_b64_tr_b16 v[20:21], v6 offset:8192
  ds_read_b64_tr_b16 v[22:23], v6 offset:10240
  v_mfma_f32_16x16x32_bf16 v[52:55], v[24:27], v[160:163], v[52:55]
  v_mfma_f32_16x16x32_bf16 v[60:63], v[24:27], v[164:167], v[60:63]
  ds_read_b64_tr_b16 v[24:25], v5 offset:12288
  ds_read_b64_tr_b16 v[26:27], v5 offset:14336
  s_waitcnt lgkmcnt(6)
  v_mfma_f32_16x16x32_bf16 v[48:51], v[28:31], v[168:171], v[48:51]
  v_mfma_f32_16x16x32_bf16 v[56:59], v[28:31], v[172:175], v[56:59]
  ds_read_b64_tr_b16 v[28:29], v6 offset:12288
  ds_read_b64_tr_b16 v[30:31], v6 offset:14336
  v_mfma_f32_16x16x32_bf16 v[52:55], v[12:15], v[168:171], v[52:55]
  v_mfma_f32_16x16x32_bf16 v[60:63], v[12:15], v[172:175], v[60:63]
  s_cmp_eq_u32 s45, 65536
  s_cselect_b32 s11, s61, s62
  s_add_u32 s45, s45, s11
  v_add_u32 v3, s11, v3
  v_add_u32 v4, s11, v4
  v_add_u32 v5, s11, v5
  v_add_u32 v6, s11, v6
  ds_read_b64_tr_b16 v[12:13], v3 offset:0
  ds_read_b64_tr_b16 v[14:15], v3 offset:2048
  s_waitcnt lgkmcnt(6)
  v_mfma_f32_16x16x32_bf16 v[48:51], v[16:19], v[176:179], v[48:51]
  v_mfma_f32_16x16x32_bf16 v[56:59], v[16:19], v[180:183], v[56:59]
  ds_read_b64_tr_b16 v[16:17], v4 offset:0
  ds_read_b64_tr_b16 v[18:19], v4 offset:2048
  v_mfma_f32_16x16x32_bf16 v[52:55], v[20:23], v[176:179], v[52:55]
  v_mfma_f32_16x16x32_bf16 v[60:63], v[20:23], v[180:183], v[60:63]
  ds_read_b64_tr_b16 v[20:21], v3 offset:4096
  ds_read_b64_tr_b16 v[22:23], v3 offset:6144
  s_waitcnt lgkmcnt(6)
  v_mfma_f32_16x16x32_bf16 v[48:51], v[24:27], v[184:187], v[48:51]
  v_mfma_f32_16x16x32_bf16 v[56:59], v[24:27], v[188:191], v[56:59]
  ds_read_b64_tr_b16 v[24:25], v4 offset:4096
  ds_read_b64_tr_b16 v[26:27], v4 offset:6144
  v_mfma_f32_16x16x32_bf16 v[52:55], v[28:31], v[184:187], v[52:55]
  v_mfma_f32_16x16x32_bf16 v[60:63], v[28:31], v[188:191], v[60:63]
  ds_read_b64_tr_b16 v[28:29], v3 offset:8192
  ds_read_b64_tr_b16 v[30:31], v3 offset:10240
  s_barrier
  s_waitcnt lgkmcnt(6)
  v_mfma_f32_16x16x32_bf16 v[32:35], v[12:15], v[192:195], v[32:35]
  v_mfma_f32_16x16x32_bf16 v[40:43], v[12:15], v[196:199], v[40:43]
  ds_read_b64_tr_b16 v[12:13], v4 offset:8192
  ds_read_b64_tr_b16 v[14:15], v4 offset:10240
  v_mfma_f32_16x16x32_bf16 v[36:39], v[16:19], v[192:195], v[36:39]
  v_mfma_f32_16x16x32_bf16 v[44:47], v[16:19], v[196:199], v[44:47]
  ds_read_b64_tr_b16 v[16:17], v3 offset:12288
  ds_read_b64_tr_b16 v[18:19], v3 offset:14336
  s_waitcnt lgkmcnt(6)
  v_mfma_f32_16x16x32_bf16 v[32:35], v[20:23], v[200:203], v[32:35]
  v_mfma_f32_16x16x32_bf16 v[40:43], v[20:23], v[204:207], v[40:43]
  ds_read_b64_tr_b16 v[20:21], v4 offset:12288
  ds_read_b64_tr_b16 v[22:23], v4 offset:14336
  v_mfma_f32_16x16x32_bf16 v[36:39], v[24:27], v[200:203], v[36:39]
  v_mfma_f32_16x16x32_bf16 v[44:47], v[24:27], v[204:207], v[44:47]
  ds_read_b64_tr_b16 v[24:25], v5 offset:0
  ds_read_b64_tr_b16 v[26:27], v5 offset:2048
  s_waitcnt lgkmcnt(6)
  v_mfma_f32_16x16x32_bf16 v[32:35], v[28:31], v[208:211], v[32:35]
  v_mfma_f32_16x16x32_bf16 v[40:43], v[28:31], v[212:215], v[40:43]
  ds_read_b64_tr_b16 v[28:29], v6 offset:0
  ds_read_b64_tr_b16 v[30:31], v6 offset:2048
  v_mfma_f32_16x16x32_bf16 v[36:39], v[12:15], v[208:211], v[36:39]
  v_mfma_f32_16x16x32_bf16 v[44:47], v[12:15], v[212:215], v[44:47]
  ds_read_b64_tr_b16 v[12:13], v5 offset:4096
  ds_read_b64_tr_b16 v[14:15], v5 offset:6144
  s_waitcnt lgkmcnt(6)
  v_mfma_f32_16x16x32_bf16 v[32:35], v[16:19], v[216:219], v[32:35]
  v_mfma_f32_16x16x32_bf16 v[40:43], v[16:19], v[220:223], v[40:43]
  ds_read_b64_tr_b16 v[16:17], v6 offset:4096
  ds_read_b64_tr_b16 v[18:19], v6 offset:6144
  v_mfma_f32_16x16x32_bf16 v[36:39], v[20:23], v[216:219], v[36:39]
  v_mfma_f32_16x16x32_bf16 v[44:47], v[20:23], v[220:223], v[44:47]
  ds_read_b64_tr_b16 v[20:21], v5 offset:8192
  ds_read_b64_tr_b16 v[22:23], v5 offset:10240
  s_waitcnt lgkmcnt(6)
  v_mfma_f32_16x16x32_bf16 v[48:51], v[24:27], v[192:195], v[48:51]
  v_mfma_f32_16x16x32_bf16 v[56:59], v[24:27], v[196:199], v[56:59]
  ds_read_b64_tr_b16 v[24:25], v6 offset:8192
  ds_read_b64_tr_b16 v[26:27], v6 offset:10240
  v_mfma_f32_16x16x32_bf16 v[52:55], v[28:31], v[192:195], v[52:55]
  v_mfma_f32_16x16x32_bf16 v[60:63], v[28:31], v[196:199], v[60:63]
  ds_read_b64_tr_b16 v[28:29], v5 offset:12288
  ds_read_b64_tr_b16 v[30:31], v5 offset:14336
  s_waitcnt lgkmcnt(6)
  v_mfma_f32_16x16x32_bf16 v[48:51], v[12:15], v[200:203], v[48:51]
  v_mfma_f32_16x16x32_bf16 v[56:59], v[12:15], v[204:207], v[56:59]
  ds_read_b64_tr_b16 v[12:13], v6 offset:12288
  ds_read_b64_tr_b16 v[14:15], v6 offset:14336
  v_mfma_f32_16x16x32_bf16 v[52:55], v[16:19], v[200:203], v[52:55]
  v_mfma_f32_16x16x32_bf16 v[60:63], v[16:19], v[204:207], v[60:63]
  s_cmp_eq_u32 s45, 65536
  s_cselect_b32 s11, s61, s62
  s_add_u32 s45, s45, s11
  v_add_u32 v3, s11, v3
  v_add_u32 v4, s11, v4
  v_add_u32 v5, s11, v5
  v_add_u32 v6, s11, v6
  ds_read_b64_tr_b16 v[16:17], v3 offset:0
  ds_read_b64_tr_b16 v[18:19], v3 offset:2048
  s_waitcnt lgkmcnt(6)
  v_mfma_f32_16x16x32_bf16 v[48:51], v[20:23], v[208:211], v[48:51]
  v_mfma_f32_16x16x32_bf16 v[56:59], v[20:23], v[212:215], v[56:59]
  ds_read_b64_tr_b16 v[20:21], v4 offset:0
  ds_read_b64_tr_b16 v[22:23], v4 offset:2048
  v_mfma_f32_16x16x32_bf16 v[52:55], v[24:27], v[208:211], v[52:55]
  v_mfma_f32_16x16x32_bf16 v[60:63], v[24:27], v[212:215], v[60:63]
  ds_read_b64_tr_b16 v[24:25], v3 offset:4096
  ds_read_b64_tr_b16 v[26:27], v3 offset:6144
  s_waitcnt lgkmcnt(6)
  v_mfma_f32_16x16x32_bf16 v[48:51], v[28:31], v[216:219], v[48:51]
  v_mfma_f32_16x16x32_bf16 v[56:59], v[28:31], v[220:223], v[56:59]
  ds_read_b64_tr_b16 v[28:29], v4 offset:4096
  ds_read_b64_tr_b16 v[30:31], v4 offset:6144
  v_mfma_f32_16x16x32_bf16 v[52:55], v[12:15], v[216:219], v[52:55]
  v_mfma_f32_16x16x32_bf16 v[60:63], v[12:15], v[220:223], v[60:63]
  ds_read_b64_tr_b16 v[12:13], v3 offset:8192
  ds_read_b64_tr_b16 v[14:15], v3 offset:10240
  s_barrier
  s_waitcnt lgkmcnt(6)
  v_mfma_f32_16x16x32_bf16 v[32:35], v[16:19], v[224:227], v[32:35]
  v_mfma_f32_16x16x32_bf16 v[40:43], v[16:19], v[228:231], v[40:43]
  ds_read_b64_tr_b16 v[16:17], v4 offset:8192
  ds_read_b64_tr_b16 v[18:19], v4 offset:10240
  v_mfma_f32_16x16x32_bf16 v[36:39], v[20:23], v[224:227], v[36:39]
  v_mfma_f32_16x16x32_bf16 v[44:47], v[20:23], v[228:231], v[44:47]
  ds_read_b64_tr_b16 v[20:21], v3 offset:12288
  ds_read_b64_tr_b16 v[22:23], v3 offset:14336
  s_waitcnt lgkmcnt(6)
  v_mfma_f32_16x16x32_bf16 v[32:35], v[24:27], v[232:235], v[32:35]
  v_mfma_f32_16x16x32_bf16 v[40:43], v[24:27], v[236:239], v[40:43]
  ds_read_b64_tr_b16 v[24:25], v4 offset:12288
  ds_read_b64_tr_b16 v[26:27], v4 offset:14336
  v_mfma_f32_16x16x32_bf16 v[36:39], v[28:31], v[232:235], v[36:39]
  v_mfma_f32_16x16x32_bf16 v[44:47], v[28:31], v[236:239], v[44:47]
  ds_read_b64_tr_b16 v[28:29], v5 offset:0
  ds_read_b64_tr_b16 v[30:31], v5 offset:2048
  s_waitcnt lgkmcnt(6)
  v_mfma_f32_16x16x32_bf16 v[32:35], v[12:15], v[240:243], v[32:35]
  v_mfma_f32_16x16x32_bf16 v[40:43], v[12:15], v[244:247], v[40:43]
  ds_read_b64_tr_b16 v[12:13], v6 offset:0
  ds_read_b64_tr_b16 v[14:15], v6 offset:2048
  v_mfma_f32_16x16x32_bf16 v[36:39], v[16:19], v[240:243], v[36:39]
  v_mfma_f32_16x16x32_bf16 v[44:47], v[16:19], v[244:247], v[44:47]
  ds_read_b64_tr_b16 v[16:17], v5 offset:4096
  ds_read_b64_tr_b16 v[18:19], v5 offset:6144
  s_waitcnt lgkmcnt(6)
  v_mfma_f32_16x16x32_bf16 v[32:35], v[20:23], v[248:251], v[32:35]
  v_mfma_f32_16x16x32_bf16 v[40:43], v[20:23], v[252:255], v[40:43]
  ds_read_b64_tr_b16 v[20:21], v6 offset:4096
  ds_read_b64_tr_b16 v[22:23], v6 offset:6144
  v_mfma_f32_16x16x32_bf16 v[36:39], v[24:27], v[248:251], v[36:39]
  v_mfma_f32_16x16x32_bf16 v[44:47], v[24:27], v[252:255], v[44:47]
  ds_read_b64_tr_b16 v[24:25], v5 offset:8192
  ds_read_b64_tr_b16 v[26:27], v5 offset:10240
  s_waitcnt lgkmcnt(6)
  v_mfma_f32_16x16x32_bf16 v[48:51], v[28:31], v[224:227], v[48:51]
  v_mfma_f32_16x16x32_bf16 v[56:59], v[28:31], v[228:231], v[56:59]
  ds_read_b64_tr_b16 v[28:29], v6 offset:8192
  ds_read_b64_tr_b16 v[30:31], v6 offset:10240
  v_mfma_f32_16x16x32_bf16 v[52:55], v[12:15], v[224:227], v[52:55]
  v_mfma_f32_16x16x32_bf16 v[60:63], v[12:15], v[228:231], v[60:63]
  ds_read_b64_tr_b16 v[12:13], v5 offset:12288
  ds_read_b64_tr_b16 v[14:15], v5 offset:14336
  v_mul_f32 v32, v32, v10
  v_mul_f32 v33, v33, v10
  v_mul_f32 v34, v34, v10
  s_waitcnt lgkmcnt(6)
  v_mfma_f32_16x16x32_bf16 v[48:51], v[16:19], v[232:235], v[48:51]
  v_mul_f32 v35, v35, v10
  v_mul_f32 v36, v36, v10
  v_mfma_f32_16x16x32_bf16 v[56:59], v[16:19], v[236:239], v[56:59]
  ds_read_b64_tr_b16 v[16:17], v6 offset:12288
  ds_read_b64_tr_b16 v[18:19], v6 offset:14336
  v_mul_f32 v37, v37, v10
  v_mul_f32 v38, v38, v10
  v_mul_f32 v39, v39, v10
  v_mfma_f32_16x16x32_bf16 v[52:55], v[20:23], v[232:235], v[52:55]
  v_cvt_pk_bf16_f32 v96, v32, v33
  v_cvt_pk_bf16_f32 v97, v34, v35
  v_mfma_f32_16x16x32_bf16 v[60:63], v[20:23], v[236:239], v[60:63]
  s_cmp_eq_u32 s45, 65536
  s_cselect_b32 s11, s61, s62
  s_add_u32 s45, s45, s11
  v_add_u32 v3, s11, v3
  v_add_u32 v4, s11, v4
  v_add_u32 v5, s11, v5
  v_add_u32 v6, s11, v6
  ds_read_b64_tr_b16 v[20:21], v3 offset:0
  ds_read_b64_tr_b16 v[22:23], v3 offset:2048
  v_cvt_pk_bf16_f32 v98, v36, v37
  v_cvt_pk_bf16_f32 v99, v38, v39
  s_waitcnt lgkmcnt(6)
  v_mfma_f32_16x16x32_bf16 v[48:51], v[24:27], v[240:243], v[48:51]
  s_mov_b64 exec, s[48:49]
  ds_write_b128 v7, v[96:99] offset:0
  s_mov_b64 exec, -1
  v_mul_f32 v40, v40, v11
  v_mul_f32 v41, v41, v11
  v_mfma_f32_16x16x32_bf16 v[56:59], v[24:27], v[244:247], v[56:59]
  ds_read_b64_tr_b16 v[24:25], v4 offset:0
  ds_read_b64_tr_b16 v[26:27], v4 offset:2048
  v_mul_f32 v42, v42, v11
  v_mul_f32 v43, v43, v11
  v_mfma_f32_16x16x32_bf16 v[52:55], v[28:31], v[240:243], v[52:55]
  v_mul_f32 v44, v44, v11
  v_mul_f32 v45, v45, v11
  v_mfma_f32_16x16x32_bf16 v[60:63], v[28:31], v[244:247], v[60:63]
  ds_read_b64_tr_b16 v[28:29], v3 offset:4096
  ds_read_b64_tr_b16 v[30:31], v3 offset:6144
  v_mul_f32 v46, v46, v11
  v_mul_f32 v47, v47, v11
  v_cvt_pk_bf16_f32 v100, v40, v41
  s_waitcnt lgkmcnt(7)
  v_mfma_f32_16x16x32_bf16 v[48:51], v[12:15], v[248:251], v[48:51]
  v_cvt_pk_bf16_f32 v101, v42, v43
  v_cvt_pk_bf16_f32 v102, v44, v45
  v_mfma_f32_16x16x32_bf16 v[56:59], v[12:15], v[252:255], v[56:59]
  ds_read_b64_tr_b16 v[12:13], v4 offset:4096
  ds_read_b64_tr_b16 v[14:15], v4 offset:6144
  v_cvt_pk_bf16_f32 v103, v46, v47
  s_mov_b64 exec, s[48:49]
  ds_write_b128 v7, v[100:103] offset:1024
  s_mov_b64 exec, -1
  v_mfma_f32_16x16x32_bf16 v[52:55], v[16:19], v[248:251], v[52:55]
  v_mfma_f32_16x16x32_bf16 v[60:63], v[16:19], v[252:255], v[60:63]
  ds_read_b64_tr_b16 v[16:17], v3 offset:8192
  ds_read_b64_tr_b16 v[18:19], v3 offset:10240
  s_waitcnt lgkmcnt(2)
  s_barrier
  v_mfma_f32_16x16x32_bf16 v[32:35], v[20:23], v[128:131], 0
  v_mfma_f32_16x16x32_bf16 v[40:43], v[20:23], v[132:135], 0
  ds_read_b64_tr_b16 v[20:21], v4 offset:8192
  ds_read_b64_tr_b16 v[22:23], v4 offset:10240
  v_mfma_f32_16x16x32_bf16 v[36:39], v[24:27], v[128:131], 0
  v_mul_f32 v48, v48, v10
  v_mul_f32 v49, v49, v10
  v_mul_f32 v50, v50, v10
  v_mfma_f32_16x16x32_bf16 v[44:47], v[24:27], v[132:135], 0
  ds_read_b64_tr_b16 v[24:25], v3 offset:12288
  ds_read_b64_tr_b16 v[26:27], v3 offset:14336
  v_mul_f32 v51, v51, v10
  v_mul_f32 v52, v52, v10
  v_mfma_f32_16x16x32_bf16 v[32:35], v[28:31], v[136:139], v[32:35]
  v_mul_f32 v53, v53, v10
  v_mul_f32 v54, v54, v10
  v_mfma_f32_16x16x32_bf16 v[40:43], v[28:31], v[140:143], v[40:43]
  ds_read_b64_tr_b16 v[28:29], v4 offset:12288
  ds_read_b64_tr_b16 v[30:31], v4 offset:14336
  v_mul_f32 v55, v55, v10
  v_cvt_pk_bf16_f32 v104, v48, v49
  v_mfma_f32_16x16x32_bf16 v[36:39], v[12:15], v[136:139], v[36:39]
  v_cvt_pk_bf16_f32 v105, v50, v51
  v_cvt_pk_bf16_f32 v106, v52, v53
  v_mfma_f32_16x16x32_bf16 v[44:47], v[12:15], v[140:143], v[44:47]
  ds_read_b64_tr_b16 v[12:13], v5 offset:0
  ds_read_b64_tr_b16 v[14:15], v5 offset:2048
  v_cvt_pk_bf16_f32 v107, v54, v55
  s_mov_b64 exec, s[48:49]
  ds_write_b128 v7, v[104:107] offset:8192
  s_mov_b64 exec, -1
  s_waitcnt lgkmcnt(7)
  v_mfma_f32_16x16x32_bf16 v[32:35], v[16:19], v[144:147], v[32:35]
  v_mul_f32 v56, v56, v11
  v_mul_f32 v57, v57, v11
  v_mul_f32 v58, v58, v11
  v_mfma_f32_16x16x32_bf16 v[40:43], v[16:19], v[148:151], v[40:43]
  ds_read_b64_tr_b16 v[16:17], v6 offset:0
  ds_read_b64_tr_b16 v[18:19], v6 offset:2048
  v_mul_f32 v59, v59, v11
  v_mul_f32 v60, v60, v11
  v_mfma_f32_16x16x32_bf16 v[36:39], v[20:23], v[144:147], v[36:39]
  v_mul_f32 v61, v61, v11
  v_mul_f32 v62, v62, v11
  v_mfma_f32_16x16x32_bf16 v[44:47], v[20:23], v[148:151], v[44:47]
  ds_read_b64_tr_b16 v[20:21], v5 offset:4096
  ds_read_b64_tr_b16 v[22:23], v5 offset:6144
  v_mul_f32 v63, v63, v11
  v_cvt_pk_bf16_f32 v108, v56, v57
  s_waitcnt lgkmcnt(7)
  v_mfma_f32_16x16x32_bf16 v[32:35], v[24:27], v[152:155], v[32:35]
  v_cvt_pk_bf16_f32 v109, v58, v59
  v_cvt_pk_bf16_f32 v110, v60, v61
  v_mfma_f32_16x16x32_bf16 v[40:43], v[24:27], v[156:159], v[40:43]
  ds_read_b64_tr_b16 v[24:25], v6 offset:4096
  ds_read_b64_tr_b16 v[26:27], v6 offset:6144
  v_cvt_pk_bf16_f32 v111, v62, v63
  s_mov_b64 exec, s[48:49]
  ds_write_b128 v7, v[108:111] offset:9216
  s_mov_b64 exec, -1
  v_mfma_f32_16x16x32_bf16 v[36:39], v[28:31], v[152:155], v[36:39]
  v_mfma_f32_16x16x32_bf16 v[44:47], v[28:31], v[156:159], v[44:47]
  ds_read_b64_tr_b16 v[28:29], v5 offset:8192
  ds_read_b64_tr_b16 v[30:31], v5 offset:10240
  s_waitcnt lgkmcnt(7)
  v_mfma_f32_16x16x32_bf16 v[48:51], v[12:15], v[128:131], 0
  v_mfma_f32_16x16x32_bf16 v[56:59], v[12:15], v[132:135], 0
  ds_read_b64_tr_b16 v[12:13], v6 offset:8192
  ds_read_b64_tr_b16 v[14:15], v6 offset:10240
  v_mfma_f32_16x16x32_bf16 v[52:55], v[16:19], v[128:131], 0
  v_mfma_f32_16x16x32_bf16 v[60:63], v[16:19], v[132:135], 0
  ds_read_b64_tr_b16 v[16:17], v5 offset:12288
  ds_read_b64_tr_b16 v[18:19], v5 offset:14336
  s_waitcnt lgkmcnt(7)
  v_mfma_f32_16x16x32_bf16 v[48:51], v[20:23], v[136:139], v[48:51]
  v_mfma_f32_16x16x32_bf16 v[56:59], v[20:23], v[140:143], v[56:59]
  ds_read_b64_tr_b16 v[20:21], v6 offset:12288
  ds_read_b64_tr_b16 v[22:23], v6 offset:14336
  v_mfma_f32_16x16x32_bf16 v[52:55], v[24:27], v[136:139], v[52:55]
  v_mfma_f32_16x16x32_bf16 v[60:63], v[24:27], v[140:143], v[60:63]
  s_cmp_eq_u32 s45, 65536
  s_cselect_b32 s11, s61, s62
  s_add_u32 s45, s45, s11
  v_add_u32 v3, s11, v3
  v_add_u32 v4, s11, v4
  v_add_u32 v5, s11, v5
  v_add_u32 v6, s11, v6
  ds_read_b64_tr_b16 v[24:25], v3 offset:0
  ds_read_b64_tr_b16 v[26:27], v3 offset:2048
  s_waitcnt lgkmcnt(6)
  v_mfma_f32_16x16x32_bf16 v[48:51], v[28:31], v[144:147], v[48:51]
  v_mfma_f32_16x16x32_bf16 v[56:59], v[28:31], v[148:151], v[56:59]
  ds_read_b64_tr_b16 v[28:29], v4 offset:0
  ds_read_b64_tr_b16 v[30:31], v4 offset:2048
  v_mfma_f32_16x16x32_bf16 v[52:55], v[12:15], v[144:147], v[52:55]
  v_mfma_f32_16x16x32_bf16 v[60:63], v[12:15], v[148:151], v[60:63]
  ds_read_b64_tr_b16 v[12:13], v3 offset:4096
  ds_read_b64_tr_b16 v[14:15], v3 offset:6144
  s_waitcnt lgkmcnt(6)
  v_mfma_f32_16x16x32_bf16 v[48:51], v[16:19], v[152:155], v[48:51]
  v_mfma_f32_16x16x32_bf16 v[56:59], v[16:19], v[156:159], v[56:59]
  ds_read_b64_tr_b16 v[16:17], v4 offset:4096
  ds_read_b64_tr_b16 v[18:19], v4 offset:6144
  v_mfma_f32_16x16x32_bf16 v[52:55], v[20:23], v[152:155], v[52:55]
  v_mfma_f32_16x16x32_bf16 v[60:63], v[20:23], v[156:159], v[60:63]
  ds_read_b64_tr_b16 v[20:21], v3 offset:8192
  ds_read_b64_tr_b16 v[22:23], v3 offset:10240
  s_barrier
  s_waitcnt lgkmcnt(6)
  v_mfma_f32_16x16x32_bf16 v[32:35], v[24:27], v[160:163], v[32:35]
  v_mov_b32 v8, 0
  s_mov_b32 s10, s17
  s_mov_b64 exec, 1
  buffer_load_dword v9, v8, s[40:43], 0 offen sc1
  buffer_load_dword v9, v8, s[28:31], s10 offen sc1
  s_mov_b32 s10, 831616
  buffer_load_dword v9, v8, s[40:43], s10 offen sc1
  buffer_load_dword v9, v8, s[24:27], 0 offen offset:128 sc1
  s_mov_b64 exec, -1
  v_mfma_f32_16x16x32_bf16 v[40:43], v[24:27], v[164:167], v[40:43]
  ds_read_b64_tr_b16 v[24:25], v4 offset:8192
  ds_read_b64_tr_b16 v[26:27], v4 offset:10240
  v_mfma_f32_16x16x32_bf16 v[36:39], v[28:31], v[160:163], v[36:39]
  v_mfma_f32_16x16x32_bf16 v[44:47], v[28:31], v[164:167], v[44:47]
  ds_read_b64_tr_b16 v[28:29], v3 offset:12288
  ds_read_b64_tr_b16 v[30:31], v3 offset:14336
  s_waitcnt lgkmcnt(6)
  v_mfma_f32_16x16x32_bf16 v[32:35], v[12:15], v[168:171], v[32:35]
  v_mfma_f32_16x16x32_bf16 v[40:43], v[12:15], v[172:175], v[40:43]
  ds_read_b64_tr_b16 v[12:13], v4 offset:12288
  ds_read_b64_tr_b16 v[14:15], v4 offset:14336
  v_mfma_f32_16x16x32_bf16 v[36:39], v[16:19], v[168:171], v[36:39]
  v_mfma_f32_16x16x32_bf16 v[44:47], v[16:19], v[172:175], v[44:47]
  ds_read_b64_tr_b16 v[16:17], v5 offset:0
  ds_read_b64_tr_b16 v[18:19], v5 offset:2048
  s_waitcnt lgkmcnt(6)
  v_mfma_f32_16x16x32_bf16 v[32:35], v[20:23], v[176:179], v[32:35]
  v_mfma_f32_16x16x32_bf16 v[40:43], v[20:23], v[180:183], v[40:43]
  ds_read_b64_tr_b16 v[20:21], v6 offset:0
  ds_read_b64_tr_b16 v[22:23], v6 offset:2048
  v_mfma_f32_16x16x32_bf16 v[36:39], v[24:27], v[176:179], v[36:39]
  v_mfma_f32_16x16x32_bf16 v[44:47], v[24:27], v[180:183], v[44:47]
  ds_read_b64_tr_b16 v[24:25], v5 offset:4096
  ds_read_b64_tr_b16 v[26:27], v5 offset:6144
  s_waitcnt lgkmcnt(6)
  v_mfma_f32_16x16x32_bf16 v[32:35], v[28:31], v[184:187], v[32:35]
  v_mfma_f32_16x16x32_bf16 v[40:43], v[28:31], v[188:191], v[40:43]
  ds_read_b64_tr_b16 v[28:29], v6 offset:4096
  ds_read_b64_tr_b16 v[30:31], v6 offset:6144
  v_mfma_f32_16x16x32_bf16 v[36:39], v[12:15], v[184:187], v[36:39]
  v_mfma_f32_16x16x32_bf16 v[44:47], v[12:15], v[188:191], v[44:47]
  ds_read_b64_tr_b16 v[12:13], v5 offset:8192
  ds_read_b64_tr_b16 v[14:15], v5 offset:10240
  s_waitcnt lgkmcnt(6)
  v_mfma_f32_16x16x32_bf16 v[48:51], v[16:19], v[160:163], v[48:51]
  v_mfma_f32_16x16x32_bf16 v[56:59], v[16:19], v[164:167], v[56:59]
  ds_read_b64_tr_b16 v[16:17], v6 offset:8192
  ds_read_b64_tr_b16 v[18:19], v6 offset:10240
  v_mfma_f32_16x16x32_bf16 v[52:55], v[20:23], v[160:163], v[52:55]
  v_mfma_f32_16x16x32_bf16 v[60:63], v[20:23], v[164:167], v[60:63]
  ds_read_b64_tr_b16 v[20:21], v5 offset:12288
  ds_read_b64_tr_b16 v[22:23], v5 offset:14336
  s_waitcnt lgkmcnt(6)
  v_mfma_f32_16x16x32_bf16 v[48:51], v[24:27], v[168:171], v[48:51]
  v_mfma_f32_16x16x32_bf16 v[56:59], v[24:27], v[172:175], v[56:59]
  ds_read_b64_tr_b16 v[24:25], v6 offset:12288
  ds_read_b64_tr_b16 v[26:27], v6 offset:14336
  v_mfma_f32_16x16x32_bf16 v[52:55], v[28:31], v[168:171], v[52:55]
  v_mfma_f32_16x16x32_bf16 v[60:63], v[28:31], v[172:175], v[60:63]
  s_cmp_eq_u32 s45, 65536
  s_cselect_b32 s11, s61, s62
  s_add_u32 s45, s45, s11
  v_add_u32 v3, s11, v3
  v_add_u32 v4, s11, v4
  v_add_u32 v5, s11, v5
  v_add_u32 v6, s11, v6
  ds_read_b64_tr_b16 v[28:29], v3 offset:0
  ds_read_b64_tr_b16 v[30:31], v3 offset:2048
  s_waitcnt lgkmcnt(6)
  v_mfma_f32_16x16x32_bf16 v[48:51], v[12:15], v[176:179], v[48:51]
  v_mfma_f32_16x16x32_bf16 v[56:59], v[12:15], v[180:183], v[56:59]
  ds_read_b64_tr_b16 v[12:13], v4 offset:0
  ds_read_b64_tr_b16 v[14:15], v4 offset:2048
  v_mfma_f32_16x16x32_bf16 v[52:55], v[16:19], v[176:179], v[52:55]
  v_mfma_f32_16x16x32_bf16 v[60:63], v[16:19], v[180:183], v[60:63]
  ds_read_b64_tr_b16 v[16:17], v3 offset:4096
  ds_read_b64_tr_b16 v[18:19], v3 offset:6144
  s_waitcnt lgkmcnt(6)
  v_mfma_f32_16x16x32_bf16 v[48:51], v[20:23], v[184:187], v[48:51]
  v_mfma_f32_16x16x32_bf16 v[56:59], v[20:23], v[188:191], v[56:59]
  ds_read_b64_tr_b16 v[20:21], v4 offset:4096
  ds_read_b64_tr_b16 v[22:23], v4 offset:6144
  v_mfma_f32_16x16x32_bf16 v[52:55], v[24:27], v[184:187], v[52:55]
  v_mfma_f32_16x16x32_bf16 v[60:63], v[24:27], v[188:191], v[60:63]
  ds_read_b64_tr_b16 v[24:25], v3 offset:8192
  ds_read_b64_tr_b16 v[26:27], v3 offset:10240
  s_barrier
  s_waitcnt lgkmcnt(6)
  v_mfma_f32_16x16x32_bf16 v[32:35], v[28:31], v[192:195], v[32:35]
  v_mfma_f32_16x16x32_bf16 v[40:43], v[28:31], v[196:199], v[40:43]
  ds_read_b64_tr_b16 v[28:29], v4 offset:8192
  ds_read_b64_tr_b16 v[30:31], v4 offset:10240
  v_mfma_f32_16x16x32_bf16 v[36:39], v[12:15], v[192:195], v[36:39]
  v_mfma_f32_16x16x32_bf16 v[44:47], v[12:15], v[196:199], v[44:47]
  ds_read_b64_tr_b16 v[12:13], v3 offset:12288
  ds_read_b64_tr_b16 v[14:15], v3 offset:14336
  s_waitcnt lgkmcnt(6)
  v_mfma_f32_16x16x32_bf16 v[32:35], v[16:19], v[200:203], v[32:35]
  v_mfma_f32_16x16x32_bf16 v[40:43], v[16:19], v[204:207], v[40:43]
  ds_read_b64_tr_b16 v[16:17], v4 offset:12288
  ds_read_b64_tr_b16 v[18:19], v4 offset:14336
  v_mfma_f32_16x16x32_bf16 v[36:39], v[20:23], v[200:203], v[36:39]
  v_mfma_f32_16x16x32_bf16 v[44:47], v[20:23], v[204:207], v[44:47]
  ds_read_b64_tr_b16 v[20:21], v5 offset:0
  ds_read_b64_tr_b16 v[22:23], v5 offset:2048
  s_waitcnt lgkmcnt(6)
  v_mfma_f32_16x16x32_bf16 v[32:35], v[24:27], v[208:211], v[32:35]
  v_mfma_f32_16x16x32_bf16 v[40:43], v[24:27], v[212:215], v[40:43]
  ds_read_b64_tr_b16 v[24:25], v6 offset:0
  ds_read_b64_tr_b16 v[26:27], v6 offset:2048
  v_mfma_f32_16x16x32_bf16 v[36:39], v[28:31], v[208:211], v[36:39]
  v_mfma_f32_16x16x32_bf16 v[44:47], v[28:31], v[212:215], v[44:47]
  ds_read_b64_tr_b16 v[28:29], v5 offset:4096
  ds_read_b64_tr_b16 v[30:31], v5 offset:6144
  s_waitcnt lgkmcnt(6)
  v_mfma_f32_16x16x32_bf16 v[32:35], v[12:15], v[216:219], v[32:35]
  v_mfma_f32_16x16x32_bf16 v[40:43], v[12:15], v[220:223], v[40:43]
  ds_read_b64_tr_b16 v[12:13], v6 offset:4096
  ds_read_b64_tr_b16 v[14:15], v6 offset:6144
  v_mfma_f32_16x16x32_bf16 v[36:39], v[16:19], v[216:219], v[36:39]
  v_mfma_f32_16x16x32_bf16 v[44:47], v[16:19], v[220:223], v[44:47]
  ds_read_b64_tr_b16 v[16:17], v5 offset:8192
  ds_read_b64_tr_b16 v[18:19], v5 offset:10240
  s_waitcnt lgkmcnt(6)
  v_mfma_f32_16x16x32_bf16 v[48:51], v[20:23], v[192:195], v[48:51]
  v_mfma_f32_16x16x32_bf16 v[56:59], v[20:23], v[196:199], v[56:59]
  ds_read_b64_tr_b16 v[20:21], v6 offset:8192
  ds_read_b64_tr_b16 v[22:23], v6 offset:10240
  v_mfma_f32_16x16x32_bf16 v[52:55], v[24:27], v[192:195], v[52:55]
  v_mfma_f32_16x16x32_bf16 v[60:63], v[24:27], v[196:199], v[60:63]
  ds_read_b64_tr_b16 v[24:25], v5 offset:12288
  ds_read_b64_tr_b16 v[26:27], v5 offset:14336
  s_waitcnt lgkmcnt(6)
  v_mfma_f32_16x16x32_bf16 v[48:51], v[28:31], v[200:203], v[48:51]
  v_mfma_f32_16x16x32_bf16 v[56:59], v[28:31], v[204:207], v[56:59]
  ds_read_b64_tr_b16 v[28:29], v6 offset:12288
  ds_read_b64_tr_b16 v[30:31], v6 offset:14336
  v_mfma_f32_16x16x32_bf16 v[52:55], v[12:15], v[200:203], v[52:55]
  v_mfma_f32_16x16x32_bf16 v[60:63], v[12:15], v[204:207], v[60:63]
  s_cmp_eq_u32 s45, 65536
  s_cselect_b32 s11, s61, s62
  s_add_u32 s45, s45, s11
  v_add_u32 v3, s11, v3
  v_add_u32 v4, s11, v4
  v_add_u32 v5, s11, v5
  v_add_u32 v6, s11, v6
  ds_read_b64_tr_b16 v[12:13], v3 offset:0
  ds_read_b64_tr_b16 v[14:15], v3 offset:2048
  s_waitcnt lgkmcnt(6)
  v_mfma_f32_16x16x32_bf16 v[48:51], v[16:19], v[208:211], v[48:51]
  v_mfma_f32_16x16x32_bf16 v[56:59], v[16:19], v[212:215], v[56:59]
  ds_read_b64_tr_b16 v[16:17], v4 offset:0
  ds_read_b64_tr_b16 v[18:19], v4 offset:2048
  v_mfma_f32_16x16x32_bf16 v[52:55], v[20:23], v[208:211], v[52:55]
  v_mfma_f32_16x16x32_bf16 v[60:63], v[20:23], v[212:215], v[60:63]
  ds_read_b64_tr_b16 v[20:21], v3 offset:4096
  ds_read_b64_tr_b16 v[22:23], v3 offset:6144
  s_waitcnt lgkmcnt(6)
  v_mfma_f32_16x16x32_bf16 v[48:51], v[24:27], v[216:219], v[48:51]
  v_mfma_f32_16x16x32_bf16 v[56:59], v[24:27], v[220:223], v[56:59]
  ds_read_b64_tr_b16 v[24:25], v4 offset:4096
  ds_read_b64_tr_b16 v[26:27], v4 offset:6144
  v_mfma_f32_16x16x32_bf16 v[52:55], v[28:31], v[216:219], v[52:55]
  v_mfma_f32_16x16x32_bf16 v[60:63], v[28:31], v[220:223], v[60:63]
  ds_read_b64_tr_b16 v[28:29], v3 offset:8192
  ds_read_b64_tr_b16 v[30:31], v3 offset:10240
  s_barrier
  s_waitcnt lgkmcnt(6)
  v_mfma_f32_16x16x32_bf16 v[32:35], v[12:15], v[224:227], v[32:35]
  v_add_u32 v0, s55, v7
  ds_read_b128 v[112:115], v0 offset:12288
  ds_read_b128 v[116:119], v0 offset:13312
  v_mfma_f32_16x16x32_bf16 v[40:43], v[12:15], v[228:231], v[40:43]
  ds_read_b64_tr_b16 v[12:13], v4 offset:8192
  ds_read_b64_tr_b16 v[14:15], v4 offset:10240
  ds_read_b128 v[120:123], v0 offset:14336
  ds_read_b128 v[124:127], v0 offset:15360
  v_mfma_f32_16x16x32_bf16 v[36:39], v[16:19], v[224:227], v[36:39]
  v_mov_b32 v176, v64
  v_mov_b32 v177, v65
  v_mfma_f32_16x16x32_bf16 v[44:47], v[16:19], v[228:231], v[44:47]
  ds_read_b64_tr_b16 v[16:17], v3 offset:12288
  ds_read_b64_tr_b16 v[18:19], v3 offset:14336
  v_mov_b32 v178, v66
  v_mov_b32 v179, v67
  s_waitcnt lgkmcnt(10)
  v_mfma_f32_16x16x32_bf16 v[32:35], v[20:23], v[232:235], v[32:35]
  v_mov_b32 v180, v68
  v_mov_b32 v181, v69
  v_mfma_f32_16x16x32_bf16 v[40:43], v[20:23], v[236:239], v[40:43]
  ds_read_b64_tr_b16 v[20:21], v4 offset:12288
  ds_read_b64_tr_b16 v[22:23], v4 offset:14336
  v_mov_b32 v182, v70
  v_mov_b32 v183, v71
  ds_read_b128 v[64:67], v0 offset:0
  ds_read_b128 v[68:71], v0 offset:1024
  v_mfma_f32_16x16x32_bf16 v[36:39], v[24:27], v[232:235], v[36:39]
  v_mov_b32 v184, v72
  v_mov_b32 v185, v73
  v_mfma_f32_16x16x32_bf16 v[44:47], v[24:27], v[236:239], v[44:47]
  ds_read_b64_tr_b16 v[24:25], v5 offset:0
  s_waitcnt lgkmcnt(13)
  ds_read_b64_tr_b16 v[26:27], v5 offset:2048
  v_mov_b32 v186, v74
  v_mov_b32 v187, v75
  s_waitcnt lgkmcnt(10)
  v_mfma_f32_16x16x32_bf16 v[32:35], v[28:31], v[240:243], v[32:35]
  v_mov_b32 v188, v76
  v_mov_b32 v189, v77
  v_mfma_f32_16x16x32_bf16 v[40:43], v[28:31], v[244:247], v[40:43]
  ds_read_b64_tr_b16 v[28:29], v6 offset:0
  ds_read_b64_tr_b16 v[30:31], v6 offset:2048
  v_mov_b32 v190, v78
  v_mov_b32 v191, v79
  ds_read_b128 v[72:75], v0 offset:2048
  ds_read_b128 v[76:79], v0 offset:3072
  v_mfma_f32_16x16x32_bf16 v[36:39], v[12:15], v[240:243], v[36:39]
  v_mov_b32 v208, v80
  v_mov_b32 v209, v81
  v_mfma_f32_16x16x32_bf16 v[44:47], v[12:15], v[244:247], v[44:47]
  ds_read_b64_tr_b16 v[12:13], v5 offset:4096
  s_waitcnt lgkmcnt(13)
  ds_read_b64_tr_b16 v[14:15], v5 offset:6144
  v_mov_b32 v210, v82
  v_mov_b32 v211, v83
  s_waitcnt lgkmcnt(10)
  v_mfma_f32_16x16x32_bf16 v[32:35], v[16:19], v[248:251], v[32:35]
  v_mov_b32 v212, v84
  v_mov_b32 v213, v85
  v_mfma_f32_16x16x32_bf16 v[40:43], v[16:19], v[252:255], v[40:43]
  ds_read_b64_tr_b16 v[16:17], v6 offset:4096
  ds_read_b64_tr_b16 v[18:19], v6 offset:6144
  v_mov_b32 v214, v86
  v_mov_b32 v215, v87
  ds_read_b128 v[80:83], v0 offset:4096
  ds_read_b128 v[84:87], v0 offset:5120
  v_mfma_f32_16x16x32_bf16 v[36:39], v[20:23], v[248:251], v[36:39]
  v_mov_b32 v216, v88
  v_mov_b32 v217, v89
  v_mfma_f32_16x16x32_bf16 v[44:47], v[20:23], v[252:255], v[44:47]
  ds_read_b64_tr_b16 v[20:21], v5 offset:8192
  s_waitcnt lgkmcnt(13)
  ds_read_b64_tr_b16 v[22:23], v5 offset:10240
  v_mov_b32 v218, v90
  v_mov_b32 v219, v91
  s_waitcnt lgkmcnt(10)
  v_mfma_f32_16x16x32_bf16 v[48:51], v[24:27], v[224:227], v[48:51]
  v_mov_b32 v220, v92
  v_mov_b32 v221, v93
  v_mfma_f32_16x16x32_bf16 v[56:59], v[24:27], v[228:231], v[56:59]
  ds_read_b64_tr_b16 v[24:25], v6 offset:8192
  ds_read_b64_tr_b16 v[26:27], v6 offset:10240
  v_mov_b32 v222, v94
  v_mov_b32 v223, v95
  ds_read_b128 v[88:91], v0 offset:6144
  ds_read_b128 v[92:95], v0 offset:7168
  v_mfma_f32_16x16x32_bf16 v[52:55], v[28:31], v[224:227], v[52:55]
  v_mfma_f32_16x16x32_bf16 v[60:63], v[28:31], v[228:231], v[60:63]
  ds_read_b64_tr_b16 v[28:29], v5 offset:12288
  s_waitcnt lgkmcnt(13)
  ds_read_b64_tr_b16 v[30:31], v5 offset:14336
  v_mul_f32 v32, v32, v10
  v_mul_f32 v33, v33, v10
  v_mul_f32 v34, v34, v10
  s_waitcnt lgkmcnt(10)
  v_mfma_f32_16x16x32_bf16 v[48:51], v[12:15], v[232:235], v[48:51]
  v_mul_f32 v35, v35, v10
  v_mul_f32 v36, v36, v10
  v_mfma_f32_16x16x32_bf16 v[56:59], v[12:15], v[236:239], v[56:59]
  ds_read_b64_tr_b16 v[12:13], v6 offset:12288
  ds_read_b64_tr_b16 v[14:15], v6 offset:14336
  v_mul_f32 v37, v37, v10
  v_mul_f32 v38, v38, v10
  v_mul_f32 v39, v39, v10
  v_mfma_f32_16x16x32_bf16 v[52:55], v[16:19], v[232:235], v[52:55]
  v_cvt_pk_bf16_f32 v32, v32, v33
  v_cvt_pk_bf16_f32 v33, v34, v35
  v_mfma_f32_16x16x32_bf16 v[60:63], v[16:19], v[236:239], v[60:63]
  s_mov_b32 s47, s45
  s_add_u32 s45, s45, 16384
  s_cmp_eq_u32 s45, 81920
  s_cselect_b32 s45, 0, s45
  s_sub_u32 s11, s45, s46
  v_add_u32 v1, s11, v1
  v_add_u32 v2, s11, v2
  ds_read_b128 v[16:19], v2 offset:0
  v_cvt_pk_bf16_f32 v34, v36, v37
  v_cvt_pk_bf16_f32 v35, v38, v39
  v_mov_b32 v232, v96
  v_mov_b32 v233, v97
  v_mov_b32 v234, v98
  v_mov_b32 v235, v99
  v_mov_b32 v236, v100
  v_mov_b32 v237, v101
  v_mov_b32 v238, v102
  v_mov_b32 v239, v103
  ds_read_b128 v[96:99], v0 offset:8192
  ds_read_b128 v[100:103], v0 offset:9216
  s_waitcnt lgkmcnt(9)
  v_mfma_f32_16x16x32_bf16 v[48:51], v[20:23], v[240:243], v[48:51]
  ds_write_b128 v7, v[32:35] offset:0
  v_mul_f32 v40, v40, v11
  v_mul_f32 v41, v41, v11
  v_mfma_f32_16x16x32_bf16 v[56:59], v[20:23], v[244:247], v[56:59]
  ds_read_b128 v[20:23], v1 offset:1024
  v_mul_f32 v42, v42, v11
  v_mul_f32 v43, v43, v11
  v_mfma_f32_16x16x32_bf16 v[52:55], v[24:27], v[240:243], v[52:55]
  v_mul_f32 v44, v44, v11
  v_mul_f32 v45, v45, v11
  v_mfma_f32_16x16x32_bf16 v[60:63], v[24:27], v[244:247], v[60:63]
  ds_read_b128 v[24:27], v2 offset:1024
  v_mul_f32 v46, v46, v11
  v_mul_f32 v47, v47, v11
  v_cvt_pk_bf16_f32 v40, v40, v41
  v_mov_b32 v240, v104
  v_mov_b32 v241, v105
  v_mov_b32 v242, v106
  v_mov_b32 v243, v107
  v_mov_b32 v244, v108
  v_mov_b32 v245, v109
  v_mov_b32 v246, v110
  v_mov_b32 v247, v111
  ds_read_b128 v[104:107], v0 offset:10240
  ds_read_b128 v[108:111], v0 offset:11264
  s_waitcnt lgkmcnt(8)
  v_mfma_f32_16x16x32_bf16 v[48:51], v[28:31], v[248:251], v[48:51]
  v_cvt_pk_bf16_f32 v41, v42, v43
  v_cvt_pk_bf16_f32 v42, v44, v45
  v_mfma_f32_16x16x32_bf16 v[56:59], v[28:31], v[252:255], v[56:59]
  ds_read_b128 v[28:31], v1 offset:2048
  v_cvt_pk_bf16_f32 v43, v46, v47
  ds_write_b128 v7, v[40:43] offset:1024
  v_mfma_f32_16x16x32_bf16 v[52:55], v[12:15], v[248:251], v[52:55]
  v_mfma_f32_16x16x32_bf16 v[60:63], v[12:15], v[252:255], v[60:63]
  ds_read_b128 v[12:15], v1 offset:0
  s_waitcnt lgkmcnt(1)
  s_waitcnt vmcnt(0)
  s_mov_b64 s[48:49], -1
  s_add_u32 s8, s8, 1
  s_cmp_lt_u32 s8, 2
  s_cbranch_scc1 L_head
  s_barrier
  v_mul_f32 v48, v48, v10
  v_mul_f32 v49, v49, v10
  v_mul_f32 v50, v50, v10
  v_mul_f32 v51, v51, v10
  v_mul_f32 v52, v52, v10
  v_mul_f32 v53, v53, v10
  v_mul_f32 v54, v54, v10
  v_mul_f32 v55, v55, v10
  v_cvt_pk_bf16_f32 v48, v48, v49
  v_cvt_pk_bf16_f32 v49, v50, v51
  v_cvt_pk_bf16_f32 v50, v52, v53
  v_cvt_pk_bf16_f32 v51, v54, v55
  s_mov_b64 exec, s[48:49]
  ds_write_b128 v7, v[48:51] offset:8192
  s_mov_b64 exec, -1
  v_mul_f32 v56, v56, v11
  v_mul_f32 v57, v57, v11
  v_mul_f32 v58, v58, v11
  v_mul_f32 v59, v59, v11
  v_mul_f32 v60, v60, v11
  v_mul_f32 v61, v61, v11
  v_mul_f32 v62, v62, v11
  v_mul_f32 v63, v63, v11
  v_cvt_pk_bf16_f32 v56, v56, v57
  v_cvt_pk_bf16_f32 v57, v58, v59
  v_cvt_pk_bf16_f32 v58, v60, v61
  v_cvt_pk_bf16_f32 v59, v62, v63
  s_mov_b64 exec, s[48:49]
  ds_write_b128 v7, v[56:59] offset:9216
  s_mov_b64 exec, -1
  v_mov_b32 v1, 140000
  v_mov_b32 v2, 0
  ds_write_b32 v1, v2
  s_waitcnt lgkmcnt(0)
  s_barrier
L_tail:
  v_mbcnt_lo_u32_b32 v0, -1, 0
  v_mbcnt_hi_u32_b32 v0, -1, v0
  s_lshl_b32 s10, s5, 4
  s_add_u32 s10, s10, s7
  s_lshl_b32 s10, s10, 3
  v_mov_b32 v4, s10
  v_mov_b32 v7, 140000
  s_mov_b32 s60, 0
  s_mov_b32 s13, s6
  s_lshl_b32 s12, 1, s6
  s_mov_b32 s15, 0
  s_lshr_b32 s56, s3, 1
  s_and_b32 s57, s3, 1
  s_mul_i32 s58, s56, 3712
  s_lshl_b32 s10, s57, 11
  s_add_u32 s10, s10, s58
  v_lshl_add_u32 v1, v0, 4, s10
  s_sub_u32 s11, 4, s57
  v_lshlrev_b32 v12, s11, v0
  s_add_u32 s10, s10, 1024
  v_add_u32 v12, s10, v12
  v_and_b32 v10, 15, v0
  v_mul_u32_u24 v10, 1792, v10
  v_lshrrev_b32 v3, 4, v0
  v_lshl_add_u32 v10, v3, 3, v10
  s_mul_i32 s10, s56, 224
  s_lshl_b32 s11, s57, 7
  s_add_u32 s10, s10, s11
  s_add_u32 s17, s17, s10
  v_lshlrev_b32 v11, 4, v0
  s_lshl_b32 s16, s6, 8
  s_lshl_b32 s10, s56, 2
  s_add_u32 s16, s16, s10
  s_waitcnt lgkmcnt(0)
  s_barrier
  s_cmp_lg_u32 s6, 7
  s_cbranch_scc1 L_own
  s_cmp_lg_u32 s3, 0
  s_cbranch_scc1 L_noarr7
  s_cmp_lg_u32 s60, 0
  s_cbranch_scc1 L_noarr7
  s_mov_b64 exec, 1
  v_mov_b32 v5, 1
  global_atomic_add v14, v4, v5, s[66:67] sc0 sc1
  s_mov_b64 exec, -1
  s_mov_b32 s60, 1
L_noarr7:
  s_waitcnt vmcnt(0) lgkmcnt(0)
  s_branch L_fin
L_own:
  s_mul_i32 s14, s13, 118784
  s_add_u32 s14, s14, 128
  s_mul_i32 s19, s13, 28672
  s_add_u32 s19, s19, s17
  s_mov_b32 s61, 2000
  s_mov_b32 s59, s12
L_poll:
  s_mov_b64 exec, 0xff
  buffer_load_dword v13, v11, s[24:27], s16 offen sc1
  s_waitcnt vmcnt(0)
  v_cmp_ne_u32 vcc, 0, v13
  s_mov_b64 exec, -1
  s_nop 0
  s_or_b32 s10, vcc_lo, s15
  s_andn2_b32 s11, s10, s12
  s_cbranch_scc0 L_none
  s_or_b32 s12, s12, s11
  s_bitcmp1_b32 s11, 0
  s_cbranch_scc0 L_nl0
  s_add_u32 s10, s14, 0
  buffer_load_dwordx4 v[16:19], v1, s[40:43], s10 offen sc1
  buffer_load_dwordx4 v[48:51], v12, s[40:43], s10 offen sc1
L_nl0:
  s_bitcmp1_b32 s11, 1
  s_cbranch_scc0 L_nl1
  s_add_u32 s10, s14, 14848
  buffer_load_dwordx4 v[20:23], v1, s[40:43], s10 offen sc1
  buffer_load_dwordx4 v[52:55], v12, s[40:43], s10 offen sc1
L_nl1:
  s_bitcmp1_b32 s11, 2
  s_cbranch_scc0 L_nl2
  s_add_u32 s10, s14, 29696
  buffer_load_dwordx4 v[24:27], v1, s[40:43], s10 offen sc1
  buffer_load_dwordx4 v[56:59], v12, s[40:43], s10 offen sc1
L_nl2:
  s_bitcmp1_b32 s11, 3
  s_cbranch_scc0 L_nl3
  s_add_u32 s10, s14, 44544
  buffer_load_dwordx4 v[28:31], v1, s[40:43], s10 offen sc1
  buffer_load_dwordx4 v[60:63], v12, s[40:43], s10 offen sc1
L_nl3:
  s_bitcmp1_b32 s11, 4
  s_cbranch_scc0 L_nl4
  s_add_u32 s10, s14, 59392
  buffer_load_dwordx4 v[32:35], v1, s[40:43], s10 offen sc1
  buffer_load_dwordx4 v[64:67], v12, s[40:43], s10 offen sc1
L_nl4:
  s_bitcmp1_b32 s11, 5
  s_cbranch_scc0 L_nl5
  s_add_u32 s10, s14, 74240
  buffer_load_dwordx4 v[36:39], v1, s[40:43], s10 offen sc1
  buffer_load_dwordx4 v[68:71], v12, s[40:43], s10 offen sc1
L_nl5:
  s_bitcmp1_b32 s11, 6
  s_cbranch_scc0 L_nl6
  s_add_u32 s10, s14, 89088
  buffer_load_dwordx4 v[40:43], v1, s[40:43], s10 offen sc1
  buffer_load_dwordx4 v[72:75], v12, s[40:43], s10 offen sc1
L_nl6:
  s_bitcmp1_b32 s11, 7
  s_cbranch_scc0 L_nl7
  s_add_u32 s10, s14, 103936
  buffer_load_dwordx4 v[44:47], v1, s[40:43], s10 offen sc1
  buffer_load_dwordx4 v[76:79], v12, s[40:43], s10 offen sc1
L_nl7:
  s_cmp_eq_u32 s12, 0xff
  s_cbranch_scc1 L_all
L_none:
  s_sleep 2
  s_sub_u32 s61, s61, 1
  s_cmp_lg_u32 s61, 0
  s_cbranch_scc1 L_poll
  v_mov_b32 v5, 1
  ds_write_b32 v7, v5
  s_branch L_fin
L_all:
  s_bitcmp1_b32 s59, 0
  s_cbranch_scc0 L_lo0
  ds_read_b128 v[16:19], v1 offset:16384
  ds_read_b64 v[48:49], v12 offset:16384
  ds_read_b64 v[50:51], v12 offset:16392
L_lo0:
  s_bitcmp1_b32 s59, 1
  s_cbranch_scc0 L_lo1
  ds_read_b128 v[20:23], v1 offset:16384
  ds_read_b64 v[52:53], v12 offset:16384
  ds_read_b64 v[54:55], v12 offset:16392
L_lo1:
  s_bitcmp1_b32 s59, 2
  s_cbranch_scc0 L_lo2
  ds_read_b128 v[24:27], v1 offset:16384
  ds_read_b64 v[56:57], v12 offset:16384
  ds_read_b64 v[58:59], v12 offset:16392
L_lo2:
  s_bitcmp1_b32 s59, 3
  s_cbranch_scc0 L_lo3
  ds_read_b128 v[28:31], v1 offset:16384
  ds_read_b64 v[60:61], v12 offset:16384
  ds_read_b64 v[62:63], v12 offset:16392
L_lo3:
  s_bitcmp1_b32 s59, 4
  s_cbranch_scc0 L_lo4
  ds_read_b128 v[32:35], v1 offset:16384
  ds_read_b64 v[64:65], v12 offset:16384
  ds_read_b64 v[66:67], v12 offset:16392
L_lo4:
  s_bitcmp1_b32 s59, 5
  s_cbranch_scc0 L_lo5
  ds_read_b128 v[36:39], v1 offset:16384
  ds_read_b64 v[68:69], v12 offset:16384
  ds_read_b64 v[70:71], v12 offset:16392
L_lo5:
  s_bitcmp1_b32 s59, 6
  s_cbranch_scc0 L_lo6
  ds_read_b128 v[40:43], v1 offset:16384
  ds_read_b64 v[72:73], v12 offset:16384
  ds_read_b64 v[74:75], v12 offset:16392
L_lo6:
  s_cmp_lg_u32 s3, 0
  s_cbranch_scc1 L_noarr0
  s_cmp_lg_u32 s60, 0
  s_cbranch_scc1 L_noarr0
  s_mov_b64 exec, 1
  v_mov_b32 v5, 1
  global_atomic_add v14, v4, v5, s[66:67] sc0 sc1
  s_mov_b64 exec, -1
  s_mov_b32 s60, 1
L_noarr0:
  s_waitcnt vmcnt(0) lgkmcnt(0)
  v_lshlrev_b32 v80, 16, v16
  v_and_b32 v81, 0xffff0000, v16
  v_lshlrev_b32 v82, 16, v17
  v_and_b32 v83, 0xffff0000, v17
  v_lshlrev_b32 v2, 16, v20
  v_and_b32 v3, 0xffff0000, v20
  v_add_f32 v80, v80, v2
  v_add_f32 v81, v81, v3
  v_lshlrev_b32 v2, 16, v21
  v_and_b32 v3, 0xffff0000, v21
  v_add_f32 v82, v82, v2
  v_add_f32 v83, v83, v3
  v_lshlrev_b32 v2, 16, v24
  v_and_b32 v3, 0xffff0000, v24
  v_add_f32 v80, v80, v2
  v_add_f32 v81, v81, v3
  v_lshlrev_b32 v2, 16, v25
  v_and_b32 v3, 0xffff0000, v25
  v_add_f32 v82, v82, v2
  v_add_f32 v83, v83, v3
  v_lshlrev_b32 v2, 16, v28
  v_and_b32 v3, 0xffff0000, v28
  v_add_f32 v80, v80, v2
  v_add_f32 v81, v81, v3
  v_lshlrev_b32 v2, 16, v29
  v_and_b32 v3, 0xffff0000, v29
  v_add_f32 v82, v82, v2
  v_add_f32 v83, v83, v3
  v_lshlrev_b32 v2, 16, v32
  v_and_b32 v3, 0xffff0000, v32
  v_add_f32 v80, v80, v2
  v_add_f32 v81, v81, v3
  v_lshlrev_b32 v2, 16, v33
  v_and_b32 v3, 0xffff0000, v33
  v_add_f32 v82, v82, v2
  v_add_f32 v83, v83, v3
  v_lshlrev_b32 v2, 16, v36
  v_and_b32 v3, 0xffff0000, v36
  v_add_f32 v80, v80, v2
  v_add_f32 v81, v81, v3
  v_lshlrev_b32 v2, 16, v37
  v_and_b32 v3, 0xffff0000, v37
  v_add_f32 v82, v82, v2
  v_add_f32 v83, v83, v3
  v_lshlrev_b32 v2, 16, v40
  v_and_b32 v3, 0xffff0000, v40
  v_add_f32 v80, v80, v2
  v_add_f32 v81, v81, v3
  v_lshlrev_b32 v2, 16, v41
  v_and_b32 v3, 0xffff0000, v41
  v_add_f32 v82, v82, v2
  v_add_f32 v83, v83, v3
  v_lshlrev_b32 v2, 16, v44
  v_and_b32 v3, 0xffff0000, v44
  v_add_f32 v80, v80, v2
  v_add_f32 v81, v81, v3
  v_lshlrev_b32 v2, 16, v45
  v_and_b32 v3, 0xffff0000, v45
  v_add_f32 v82, v82, v2
  v_add_f32 v83, v83, v3
  v_cvt_pk_bf16_f32 v88, v80, v81
  v_cvt_pk_bf16_f32 v89, v82, v83
  buffer_store_dwordx2 v[88:89], v10, s[28:31], s19 offen offset:0
  v_lshlrev_b32 v80, 16, v18
  v_and_b32 v81, 0xffff0000, v18
  v_lshlrev_b32 v82, 16, v19
  v_and_b32 v83, 0xffff0000, v19
  v_lshlrev_b32 v2, 16, v22
  v_and_b32 v3, 0xffff0000, v22
  v_add_f32 v80, v80, v2
  v_add_f32 v81, v81, v3
  v_lshlrev_b32 v2, 16, v23
  v_and_b32 v3, 0xffff0000, v23
  v_add_f32 v82, v82, v2
  v_add_f32 v83, v83, v3
  v_lshlrev_b32 v2, 16, v26
  v_and_b32 v3, 0xffff0000, v26
  v_add_f32 v80, v80, v2
  v_add_f32 v81, v81, v3
  v_lshlrev_b32 v2, 16, v27
  v_and_b32 v3, 0xffff0000, v27
  v_add_f32 v82, v82, v2
  v_add_f32 v83, v83, v3
  v_lshlrev_b32 v2, 16, v30
  v_and_b32 v3, 0xffff0000, v30
  v_add_f32 v80, v80, v2
  v_add_f32 v81, v81, v3
  v_lshlrev_b32 v2, 16, v31
  v_and_b32 v3, 0xffff0000, v31
  v_add_f32 v82, v82, v2
  v_add_f32 v83, v83, v3
  v_lshlrev_b32 v2, 16, v34
  v_and_b32 v3, 0xffff0000, v34
  v_add_f32 v80, v80, v2
  v_add_f32 v81, v81, v3
  v_lshlrev_b32 v2, 16, v35
  v_and_b32 v3, 0xffff0000, v35
  v_add_f32 v82, v82, v2
  v_add_f32 v83, v83, v3
  v_lshlrev_b32 v2, 16, v38
  v_and_b32 v3, 0xffff0000, v38
  v_add_f32 v80, v80, v2
  v_add_f32 v81, v81, v3
  v_lshlrev_b32 v2, 16, v39
  v_and_b32 v3, 0xffff0000, v39
  v_add_f32 v82, v82, v2
  v_add_f32 v83, v83, v3
  v_lshlrev_b32 v2, 16, v42
  v_and_b32 v3, 0xffff0000, v42
  v_add_f32 v80, v80, v2
  v_add_f32 v81, v81, v3
  v_lshlrev_b32 v2, 16, v43
  v_and_b32 v3, 0xffff0000, v43
  v_add_f32 v82, v82, v2
  v_add_f32 v83, v83, v3
  v_lshlrev_b32 v2, 16, v46
  v_and_b32 v3, 0xffff0000, v46
  v_add_f32 v80, v80, v2
  v_add_f32 v81, v81, v3
  v_lshlrev_b32 v2, 16, v47
  v_and_b32 v3, 0xffff0000, v47
  v_add_f32 v82, v82, v2
  v_add_f32 v83, v83, v3
  v_cvt_pk_bf16_f32 v90, v80, v81
  v_cvt_pk_bf16_f32 v91, v82, v83
  buffer_store_dwordx2 v[90:91], v10, s[28:31], s19 offen offset:32
  v_lshlrev_b32 v80, 16, v48
  v_and_b32 v81, 0xffff0000, v48
  v_lshlrev_b32 v82, 16, v49
  v_and_b32 v83, 0xffff0000, v49
  v_lshlrev_b32 v2, 16, v52
  v_and_b32 v3, 0xffff0000, v52
  v_add_f32 v80, v80, v2
  v_add_f32 v81, v81, v3
  v_lshlrev_b32 v2, 16, v53
  v_and_b32 v3, 0xffff0000, v53
  v_add_f32 v82, v82, v2
  v_add_f32 v83, v83, v3
  v_lshlrev_b32 v2, 16, v56
  v_and_b32 v3, 0xffff0000, v56
  v_add_f32 v80, v80, v2
  v_add_f32 v81, v81, v3
  v_lshlrev_b32 v2, 16, v57
  v_and_b32 v3, 0xffff0000, v57
  v_add_f32 v82, v82, v2
  v_add_f32 v83, v83, v3
  v_lshlrev_b32 v2, 16, v60
  v_and_b32 v3, 0xffff0000, v60
  v_add_f32 v80, v80, v2
  v_add_f32 v81, v81, v3
  v_lshlrev_b32 v2, 16, v61
  v_and_b32 v3, 0xffff0000, v61
  v_add_f32 v82, v82, v2
  v_add_f32 v83, v83, v3
  v_lshlrev_b32 v2, 16, v64
  v_and_b32 v3, 0xffff0000, v64
  v_add_f32 v80, v80, v2
  v_add_f32 v81, v81, v3
  v_lshlrev_b32 v2, 16, v65
  v_and_b32 v3, 0xffff0000, v65
  v_add_f32 v82, v82, v2
  v_add_f32 v83, v83, v3
  v_lshlrev_b32 v2, 16, v68
  v_and_b32 v3, 0xffff0000, v68
  v_add_f32 v80, v80, v2
  v_add_f32 v81, v81, v3
  v_lshlrev_b32 v2, 16, v69
  v_and_b32 v3, 0xffff0000, v69
  v_add_f32 v82, v82, v2
  v_add_f32 v83, v83, v3
  v_lshlrev_b32 v2, 16, v72
  v_and_b32 v3, 0xffff0000, v72
  v_add_f32 v80, v80, v2
  v_add_f32 v81, v81, v3
  v_lshlrev_b32 v2, 16, v73
  v_and_b32 v3, 0xffff0000, v73
  v_add_f32 v82, v82, v2
  v_add_f32 v83, v83, v3
  v_lshlrev_b32 v2, 16, v76
  v_and_b32 v3, 0xffff0000, v76
  v_add_f32 v80, v80, v2
  v_add_f32 v81, v81, v3
  v_lshlrev_b32 v2, 16, v77
  v_and_b32 v3, 0xffff0000, v77
  v_add_f32 v82, v82, v2
  v_add_f32 v83, v83, v3
  v_cvt_pk_bf16_f32 v92, v80, v81
  v_cvt_pk_bf16_f32 v93, v82, v83
  buffer_store_dwordx2 v[92:93], v10, s[28:31], s19 offen offset:64
  s_cmp_lg_u32 s57, 0
  s_cbranch_scc1 L_fin
  v_lshlrev_b32 v80, 16, v50
  v_and_b32 v81, 0xffff0000, v50
  v_lshlrev_b32 v82, 16, v51
  v_and_b32 v83, 0xffff0000, v51
  v_lshlrev_b32 v2, 16, v54
  v_and_b32 v3, 0xffff0000, v54
  v_add_f32 v80, v80, v2
  v_add_f32 v81, v81, v3
  v_lshlrev_b32 v2, 16, v55
  v_and_b32 v3, 0xffff0000, v55
  v_add_f32 v82, v82, v2
  v_add_f32 v83, v83, v3
  v_lshlrev_b32 v2, 16, v58
  v_and_b32 v3, 0xffff0000, v58
  v_add_f32 v80, v80, v2
  v_add_f32 v81, v81, v3
  v_lshlrev_b32 v2, 16, v59
  v_and_b32 v3, 0xffff0000, v59
  v_add_f32 v82, v82, v2
  v_add_f32 v83, v83, v3
  v_lshlrev_b32 v2, 16, v62
  v_and_b32 v3, 0xffff0000, v62
  v_add_f32 v80, v80, v2
  v_add_f32 v81, v81, v3
  v_lshlrev_b32 v2, 16, v63
  v_and_b32 v3, 0xffff0000, v63
  v_add_f32 v82, v82, v2
  v_add_f32 v83, v83, v3
  v_lshlrev_b32 v2, 16, v66
  v_and_b32 v3, 0xffff0000, v66
  v_add_f32 v80, v80, v2
  v_add_f32 v81, v81, v3
  v_lshlrev_b32 v2, 16, v67
  v_and_b32 v3, 0xffff0000, v67
  v_add_f32 v82, v82, v2
  v_add_f32 v83, v83, v3
  v_lshlrev_b32 v2, 16, v70
  v_and_b32 v3, 0xffff0000, v70
  v_add_f32 v80, v80, v2
  v_add_f32 v81, v81, v3
  v_lshlrev_b32 v2, 16, v71
  v_and_b32 v3, 0xffff0000, v71
  v_add_f32 v82, v82, v2
  v_add_f32 v83, v83, v3
  v_lshlrev_b32 v2, 16, v74
  v_and_b32 v3, 0xffff0000, v74
  v_add_f32 v80, v80, v2
  v_add_f32 v81, v81, v3
  v_lshlrev_b32 v2, 16, v75
  v_and_b32 v3, 0xffff0000, v75
  v_add_f32 v82, v82, v2
  v_add_f32 v83, v83, v3
  v_lshlrev_b32 v2, 16, v78
  v_and_b32 v3, 0xffff0000, v78
  v_add_f32 v80, v80, v2
  v_add_f32 v81, v81, v3
  v_lshlrev_b32 v2, 16, v79
  v_and_b32 v3, 0xffff0000, v79
  v_add_f32 v82, v82, v2
  v_add_f32 v83, v83, v3
  v_cvt_pk_bf16_f32 v94, v80, v81
  v_cvt_pk_bf16_f32 v95, v82, v83
  buffer_store_dwordx2 v[94:95], v10, s[28:31], s19 offen offset:96
L_fin:
  s_cmp_lg_u32 s15, 0
  s_cbranch_scc1 L_next
  s_waitcnt lgkmcnt(0)
  s_barrier
  s_cmp_lg_u32 s3, 0
  s_cbranch_scc1 L_f2
  ds_read_b32 v5, v7
  s_waitcnt lgkmcnt(0)
  v_readfirstlane_b32 s10, v5
  s_cmp_lg_u32 s10, 0
  s_cbranch_scc1 L_giveup
  v_readfirstlane_b32 s14, v14
  s_nop 0
  s_and_b32 s10, s14, 255
  s_lshr_b32 s14, s14, 8
  s_cmp_eq_u32 s10, 7
  s_cselect_b32 s62, s14, 0
L_f1:
  s_mov_b32 s60, 1
  v_mov_b32 v5, s62
  ds_write_b32 v7, v5 offset:4
  s_waitcnt lgkmcnt(0)
L_f2:
  s_barrier
  ds_read_b32 v5, v7 offset:4
  s_mov_b32 s15, 0xff
  s_waitcnt lgkmcnt(0)
  v_readfirstlane_b32 s62, v5
L_next:
  s_cmp_eq_u32 s62, 0
  s_cbranch_scc1 L_done
  s_ff1_i32_b32 s13, s62
  s_bitset0_b32 s62, s13
  s_mov_b32 s12, 0
  s_waitcnt vmcnt(0)
  s_branch L_own
L_done:
L_end:
  s_endpgm
L_giveup:
  s_waitcnt vmcnt(0)
  s_mul_i32 s10, s6, 133632
  s_add_u32 s10, s10, 128
  ds_read_b128 v[16:19], v11 offset:16384
  ds_read_b128 v[20:23], v11 offset:17408
  ds_read_b128 v[24:27], v11 offset:18432
  ds_read_b128 v[28:31], v11 offset:19456
  ds_read_b128 v[32:35], v11 offset:20480
  ds_read_b128 v[36:39], v11 offset:21504
  ds_read_b128 v[40:43], v11 offset:22528
  ds_read_b128 v[44:47], v11 offset:23552
  ds_read_b128 v[48:51], v11 offset:24576
  ds_read_b128 v[52:55], v11 offset:25600
  ds_read_b128 v[56:59], v11 offset:26624
  ds_read_b128 v[60:63], v11 offset:27648
  ds_read_b128 v[64:67], v11 offset:28672
  ds_read_b128 v[68:71], v11 offset:29696
  ds_read_b128 v[72:75], v11 offset:30720
  s_waitcnt lgkmcnt(0)
  buffer_store_dwordx4 v[16:19], v11, s[40:43], s10 offen offset:0 sc1
  buffer_store_dwordx4 v[20:23], v11, s[40:43], s10 offen offset:1024 sc1
  buffer_store_dwordx4 v[24:27], v11, s[40:43], s10 offen offset:2048 sc1
  buffer_store_dwordx4 v[28:31], v11, s[40:43], s10 offen offset:3072 sc1
  s_add_u32 s10, s10, 4096
  buffer_store_dwordx4 v[32:35], v11, s[40:43], s10 offen offset:0 sc1
  buffer_store_dwordx4 v[36:39], v11, s[40:43], s10 offen offset:1024 sc1
  buffer_store_dwordx4 v[40:43], v11, s[40:43], s10 offen offset:2048 sc1
  buffer_store_dwordx4 v[44:47], v11, s[40:43], s10 offen offset:3072 sc1
  s_add_u32 s10, s10, 4096
  buffer_store_dwordx4 v[48:51], v11, s[40:43], s10 offen offset:0 sc1
  buffer_store_dwordx4 v[52:55], v11, s[40:43], s10 offen offset:1024 sc1
  buffer_store_dwordx4 v[56:59], v11, s[40:43], s10 offen offset:2048 sc1
  buffer_store_dwordx4 v[60:63], v11, s[40:43], s10 offen offset:3072 sc1
  s_add_u32 s10, s10, 4096
  buffer_store_dwordx4 v[64:67], v11, s[40:43], s10 offen offset:0 sc1
  buffer_store_dwordx4 v[68:71], v11, s[40:43], s10 offen offset:1024 sc1
  s_mov_b32 exec_hi, 0
  buffer_store_dwordx4 v[72:75], v11, s[40:43], s10 offen offset:2048 sc1
  s_waitcnt vmcnt(0)
  s_mov_b64 exec, 1
  s_mov_b32 s62, 0
  s_cmp_eq_u32 s60, 0
  s_cbranch_scc1 L_g1
  v_readfirstlane_b32 s14, v14
  s_nop 0
  s_and_b32 s10, s14, 255
  s_lshr_b32 s14, s14, 8
  s_cmp_eq_u32 s10, 7
  s_cselect_b32 s62, s14, 0
L_g1:
  s_lshl_b32 s12, 1, s6
  s_lshl_b32 s14, s12, 8
  s_xor_b32 s60, s60, 1
  s_add_u32 s14, s14, s60
  v_mov_b32 v5, s14
  global_atomic_add v14, v4, v5, s[66:67] sc0 sc1
  s_waitcnt vmcnt(0)
  v_readfirstlane_b32 s14, v14
  s_mov_b64 exec, -1
  s_and_b32 s10, s14, 255
  s_add_u32 s10, s10, s60
  s_lshr_b32 s14, s14, 8
  s_mul_i32 s14, s14, s60
  s_or_b32 s14, s14, s12
  s_cmp_eq_u32 s10, 8
  s_cselect_b32 s14, s14, 0
  s_or_b32 s62, s62, s14
  s_branch L_f1
L_rs0:
  s_mov_b32 s54, 1
  s_call_b64 s[18:19], L_rare40_32
  s_branch L_rb0
L_rs1:
  s_mov_b32 s54, 2
  s_call_b64 s[18:19], L_rare32_40
  s_branch L_rb1
L_rs2:
  s_mov_b32 s54, 3
  s_call_b64 s[18:19], L_rare40_32
  s_branch L_rb2
L_rs3:
  s_mov_b32 s54, 4
  s_call_b64 s[18:19], L_rare32_40
  s_branch L_rb3
L_rs4:
  s_mov_b32 s54, 5
  s_call_b64 s[18:19], L_rare40_32
  s_branch L_rb4
L_rs5:
  s_mov_b32 s54, 6
  s_call_b64 s[18:19], L_rare32_40
  s_branch L_rb5
L_rs6:
  s_mov_b32 s54, 7
  s_call_b64 s[18:19], L_rare40_32
  s_branch L_rb6
L_rs7:
  s_mov_b32 s54, 8
  s_call_b64 s[18:19], L_rare32_40
  s_branch L_rb7
L_rs8:
  s_mov_b32 s54, 9
  s_call_b64 s[18:19], L_rare40_32
  s_branch L_rb8
L_rs9:
  s_mov_b32 s54, 10
  s_call_b64 s[18:19], L_rare32_40
  s_branch L_rb9
L_rs10:
  s_mov_b32 s54, 11
  s_call_b64 s[18:19], L_rare40_32
  s_branch L_rb10
L_rs11:
  s_mov_b32 s54, 12
  s_call_b64 s[18:19], L_rare32_40
  s_branch L_rb11
L_rs12:
  s_mov_b32 s54, 13
  s_call_b64 s[18:19], L_rare40_32
  s_branch L_rb12
L_rs13:
  s_mov_b32 s54, 14
  s_call_b64 s[18:19], L_rare32_40
  s_branch L_rb13
L_rs14:
  s_mov_b32 s54, 15
  s_call_b64 s[18:19], L_rare40_32
  s_branch L_rb14
L_rs15:
  s_mov_b32 s54, 16
  s_call_b64 s[18:19], L_rare32_40
  s_branch L_rb15
L_rs16:
  s_mov_b32 s54, 17
  s_call_b64 s[18:19], L_rare40_32
  s_branch L_rb16
L_rs17:
  s_mov_b32 s54, 18
  s_call_b64 s[18:19], L_rare32_40
  s_branch L_rb17
L_rs18:
  s_mov_b32 s54, 19
  s_call_b64 s[18:19], L_rare40_32
  s_branch L_rb18
L_rs19:
  s_mov_b32 s54, 20
  s_call_b64 s[18:19], L_rare32_40
  s_branch L_rb19
L_rs20:
  s_mov_b32 s54, 21
  s_call_b64 s[18:19], L_rare40_32
  s_branch L_rb20
L_rs21:
  s_mov_b32 s54, 22
  s_call_b64 s[18:19], L_rare32_40
  s_branch L_rb21
L_rs22:
  s_mov_b32 s54, 23
  s_call_b64 s[18:19], L_rare40_32
  s_branch L_rb22
L_rs23:
  s_mov_b32 s54, 24
  s_call_b64 s[18:19], L_rare32_40
  s_branch L_rb23
L_rs24:
  s_mov_b32 s54, 25
  s_call_b64 s[18:19], L_rare40_32
  s_branch L_rb24
L_rs25:
  s_mov_b32 s54, 26
  s_call_b64 s[18:19], L_rare32_40
  s_branch L_rb25
L_rs26:
  s_mov_b32 s54, 27
  s_call_b64 s[18:19], L_rare40_32
  s_branch L_rb26
L_rs27:
  s_mov_b32 s54, 28
  s_call_b64 s[18:19], L_rare32_40
  s_branch L_rb27
L_rs28:
  s_mov_b32 s54, 29
  s_call_b64 s[18:19], L_rare40_32
  s_branch L_rb28
L_rs29:
  s_mov_b32 s54, 30
  s_call_b64 s[18:19], L_rare32_56
  s_branch L_rb29
L_rs30:
  s_mov_b32 s54, 31
  s_call_b64 s[18:19], L_rare56_None
  s_branch L_rb30
L_rare32_40:
  s_nop 7
  v_max3_f32 v50, v32, v33, v34
  v_max_f32 v50, v50, v35
  v_mov_b32 v48, v50
  s_nop 1
  v_permlane32_swap_b32 v50, v48
  v_max_f32 v50, v50, v48
  v_mov_b32 v48, v50
  s_nop 1
  v_permlane16_swap_b32 v50, v48
  v_max_f32 v50, v50, v48
  v_ceil_f32 v50, v50
  v_max_f32 v50, 0, v50
  v_sub_f32 v32, v32, v50
  v_sub_f32 v33, v33, v50
  v_sub_f32 v34, v34, v50
  v_sub_f32 v35, v35, v50
  v_sub_f32 v40, v40, v50
  v_sub_f32 v41, v41, v50
  v_sub_f32 v42, v42, v50
  v_sub_f32 v43, v43, v50
  v_sub_f32 v52, v52, v50
  v_sub_f32 v53, v53, v50
  v_sub_f32 v54, v54, v50
  v_sub_f32 v55, v55, v50
  v_exp_f32 v48, -v50
  s_nop 0
  v_mul_f32 v10, v10, v48
  v_min_f32 v50, 0x437f0000, v50
  v_cvt_u32_f32 v50, v50
  v_mul_u32_u24 v50, 0x800080, v50
  v_max3_f32 v51, v36, v37, v38
  v_max_f32 v51, v51, v39
  v_mov_b32 v48, v51
  s_nop 1
  v_permlane32_swap_b32 v51, v48
  v_max_f32 v51, v51, v48
  v_mov_b32 v48, v51
  s_nop 1
  v_permlane16_swap_b32 v51, v48
  v_max_f32 v51, v51, v48
  v_ceil_f32 v51, v51
  v_max_f32 v51, 0, v51
  v_sub_f32 v36, v36, v51
  v_sub_f32 v37, v37, v51
  v_sub_f32 v38, v38, v51
  v_sub_f32 v39, v39, v51
  v_sub_f32 v44, v44, v51
  v_sub_f32 v45, v45, v51
  v_sub_f32 v46, v46, v51
  v_sub_f32 v47, v47, v51
  v_sub_f32 v60, v60, v51
  v_sub_f32 v61, v61, v51
  v_sub_f32 v62, v62, v51
  v_sub_f32 v63, v63, v51
  v_exp_f32 v48, -v51
  s_nop 0
  v_mul_f32 v11, v11, v48
  v_min_f32 v51, 0x437f0000, v51
  v_cvt_u32_f32 v51, v51
  v_mul_u32_u24 v51, 0x800080, v51
  s_branch L_rarep
L_rare32_56:
  s_nop 7
  v_max3_f32 v50, v32, v33, v34
  v_max_f32 v50, v50, v35
  v_mov_b32 v48, v50
  s_nop 1
  v_permlane32_swap_b32 v50, v48
  v_max_f32 v50, v50, v48
  v_mov_b32 v48, v50
  s_nop 1
  v_permlane16_swap_b32 v50, v48
  v_max_f32 v50, v50, v48
  v_ceil_f32 v50, v50
  v_max_f32 v50, 0, v50
  v_sub_f32 v32, v32, v50
  v_sub_f32 v33, v33, v50
  v_sub_f32 v34, v34, v50
  v_sub_f32 v35, v35, v50
  v_sub_f32 v56, v56, v50
  v_sub_f32 v57, v57, v50
  v_sub_f32 v58, v58, v50
  v_sub_f32 v59, v59, v50
  v_exp_f32 v48, -v50
  s_nop 0
  v_mul_f32 v10, v10, v48
  v_min_f32 v50, 0x437f0000, v50
  v_cvt_u32_f32 v50, v50
  v_mul_u32_u24 v50, 0x800080, v50
  v_max3_f32 v51, v36, v37, v38
  v_max_f32 v51, v51, v39
  v_mov_b32 v48, v51
  s_nop 1
  v_permlane32_swap_b32 v51, v48
  v_max_f32 v51, v51, v48
  v_mov_b32 v48, v51
  s_nop 1
  v_permlane16_swap_b32 v51, v48
  v_max_f32 v51, v51, v48
  v_ceil_f32 v51, v51
  v_max_f32 v51, 0, v51
  v_sub_f32 v36, v36, v51
  v_sub_f32 v37, v37, v51
  v_sub_f32 v38, v38, v51
  v_sub_f32 v39, v39, v51
  v_sub_f32 v60, v60, v51
  v_sub_f32 v61, v61, v51
  v_sub_f32 v62, v62, v51
  v_sub_f32 v63, v63, v51
  v_exp_f32 v48, -v51
  s_nop 0
  v_mul_f32 v11, v11, v48
  v_min_f32 v51, 0x437f0000, v51
  v_cvt_u32_f32 v51, v51
  v_mul_u32_u24 v51, 0x800080, v51
  s_branch L_rarep
L_rare40_32:
  s_nop 7
  v_max3_f32 v50, v40, v41, v42
  v_max_f32 v50, v50, v43
  v_mov_b32 v48, v50
  s_nop 1
  v_permlane32_swap_b32 v50, v48
  v_max_f32 v50, v50, v48
  v_mov_b32 v48, v50
  s_nop 1
  v_permlane16_swap_b32 v50, v48
  v_max_f32 v50, v50, v48
  v_ceil_f32 v50, v50
  v_max_f32 v50, 0, v50
  v_sub_f32 v40, v40, v50
  v_sub_f32 v41, v41, v50
  v_sub_f32 v42, v42, v50
  v_sub_f32 v43, v43, v50
  v_sub_f32 v32, v32, v50
  v_sub_f32 v33, v33, v50
  v_sub_f32 v34, v34, v50
  v_sub_f32 v35, v35, v50
  v_sub_f32 v52, v52, v50
  v_sub_f32 v53, v53, v50
  v_sub_f32 v54, v54, v50
  v_sub_f32 v55, v55, v50
  v_exp_f32 v48, -v50
  s_nop 0
  v_mul_f32 v10, v10, v48
  v_min_f32 v50, 0x437f0000, v50
  v_cvt_u32_f32 v50, v50
  v_mul_u32_u24 v50, 0x800080, v50
  v_max3_f32 v51, v44, v45, v46
  v_max_f32 v51, v51, v47
  v_mov_b32 v48, v51
  s_nop 1
  v_permlane32_swap_b32 v51, v48
  v_max_f32 v51, v51, v48
  v_mov_b32 v48, v51
  s_nop 1
  v_permlane16_swap_b32 v51, v48
  v_max_f32 v51, v51, v48
  v_ceil_f32 v51, v51
  v_max_f32 v51, 0, v51
  v_sub_f32 v44, v44, v51
  v_sub_f32 v45, v45, v51
  v_sub_f32 v46, v46, v51
  v_sub_f32 v47, v47, v51
  v_sub_f32 v36, v36, v51
  v_sub_f32 v37, v37, v51
  v_sub_f32 v38, v38, v51
  v_sub_f32 v39, v39, v51
  v_sub_f32 v60, v60, v51
  v_sub_f32 v61, v61, v51
  v_sub_f32 v62, v62, v51
  v_sub_f32 v63, v63, v51
  v_exp_f32 v48, -v51
  s_nop 0
  v_mul_f32 v11, v11, v48
  v_min_f32 v51, 0x437f0000, v51
  v_cvt_u32_f32 v51, v51
  v_mul_u32_u24 v51, 0x800080, v51
  s_branch L_rarep
L_rare56_None:
  s_nop 7
  v_max3_f32 v50, v56, v57, v58
  v_max_f32 v50, v50, v59
  v_mov_b32 v48, v50
  s_nop 1
  v_permlane32_swap_b32 v50, v48
  v_max_f32 v50, v50, v48
  v_mov_b32 v48, v50
  s_nop 1
  v_permlane16_swap_b32 v50, v48
  v_max_f32 v50, v50, v48
  v_ceil_f32 v50, v50
  v_max_f32 v50, 0, v50
  v_sub_f32 v56, v56, v50
  v_sub_f32 v57, v57, v50
  v_sub_f32 v58, v58, v50
  v_sub_f32 v59, v59, v50
  v_exp_f32 v48, -v50
  s_nop 0
  v_mul_f32 v10, v10, v48
  v_min_f32 v50, 0x437f0000, v50
  v_cvt_u32_f32 v50, v50
  v_mul_u32_u24 v50, 0x800080, v50
  v_max3_f32 v51, v60, v61, v62
  v_max_f32 v51, v51, v63
  v_mov_b32 v48, v51
  s_nop 1
  v_permlane32_swap_b32 v51, v48
  v_max_f32 v51, v51, v48
  v_mov_b32 v48, v51
  s_nop 1
  v_permlane16_swap_b32 v51, v48
  v_max_f32 v51, v51, v48
  v_ceil_f32 v51, v51
  v_max_f32 v51, 0, v51
  v_sub_f32 v60, v60, v51
  v_sub_f32 v61, v61, v51
  v_sub_f32 v62, v62, v51
  v_sub_f32 v63, v63, v51
  v_exp_f32 v48, -v51
  s_nop 0
  v_mul_f32 v11, v11, v48
  v_min_f32 v51, 0x437f0000, v51
  v_cvt_u32_f32 v51, v51
  v_mul_u32_u24 v51, 0x800080, v51
L_rarep:
  v_pk_sub_u16 v128, v128, v50 clamp
  v_pk_sub_u16 v129, v129, v50 clamp
  v_pk_sub_u16 v132, v132, v51 clamp
  v_pk_sub_u16 v133, v133, v51 clamp
  s_cmp_le_u32 s54, 1
  s_cbranch_scc1 L_rarex
  v_pk_sub_u16 v130, v130, v50 clamp
  v_pk_sub_u16 v131, v131, v50 clamp
  v_pk_sub_u16 v134, v134, v51 clamp
  v_pk_sub_u16 v135, v135, v51 clamp
  s_cmp_le_u32 s54, 2
  s_cbranch_scc1 L_rarex
  v_pk_sub_u16 v136, v136, v50 clamp
  v_pk_sub_u16 v137, v137, v50 clamp
  v_pk_sub_u16 v140, v140, v51 clamp
  v_pk_sub_u16 v141, v141, v51 clamp
  s_cmp_le_u32 s54, 3
  s_cbranch_scc1 L_rarex
  v_pk_sub_u16 v138, v138, v50 clamp
  v_pk_sub_u16 v139, v139, v50 clamp
  v_pk_sub_u16 v142, v142, v51 clamp
  v_pk_sub_u16 v143, v143, v51 clamp
  s_cmp_le_u32 s54, 4
  s_cbranch_scc1 L_rarex
  v_pk_sub_u16 v144, v144, v50 clamp
  v_pk_sub_u16 v145, v145, v50 clamp
  v_pk_sub_u16 v148, v148, v51 clamp
  v_pk_sub_u16 v149, v149, v51 clamp
  s_cmp_le_u32 s54, 5
  s_cbranch_scc1 L_rarex
  v_pk_sub_u16 v146, v146, v50 clamp
  v_pk_sub_u16 v147, v147, v50 clamp
  v_pk_sub_u16 v150, v150, v51 clamp
  v_pk_sub_u16 v151, v151, v51 clamp
  s_cmp_le_u32 s54, 6
  s_cbranch_scc1 L_rarex
  v_pk_sub_u16 v152, v152, v50 clamp
  v_pk_sub_u16 v153, v153, v50 clamp
  v_pk_sub_u16 v156, v156, v51 clamp
  v_pk_sub_u16 v157, v157, v51 clamp
  s_cmp_le_u32 s54, 7
  s_cbranch_scc1 L_rarex
  v_pk_sub_u16 v154, v154, v50 clamp
  v_pk_sub_u16 v155, v155, v50 clamp
  v_pk_sub_u16 v158, v158, v51 clamp
  v_pk_sub_u16 v159, v159, v51 clamp
  s_cmp_le_u32 s54, 8
  s_cbranch_scc1 L_rarex
  v_pk_sub_u16 v160, v160, v50 clamp
  v_pk_sub_u16 v161, v161, v50 clamp
  v_pk_sub_u16 v164, v164, v51 clamp
  v_pk_sub_u16 v165, v165, v51 clamp
  s_cmp_le_u32 s54, 9
  s_cbranch_scc1 L_rarex
  v_pk_sub_u16 v162, v162, v50 clamp
  v_pk_sub_u16 v163, v163, v50 clamp
  v_pk_sub_u16 v166, v166, v51 clamp
  v_pk_sub_u16 v167, v167, v51 clamp
  s_cmp_le_u32 s54, 10
  s_cbranch_scc1 L_rarex
  v_pk_sub_u16 v168, v168, v50 clamp
  v_pk_sub_u16 v169, v169, v50 clamp
  v_pk_sub_u16 v172, v172, v51 clamp
  v_pk_sub_u16 v173, v173, v51 clamp
  s_cmp_le_u32 s54, 11
  s_cbranch_scc1 L_rarex
  v_pk_sub_u16 v170, v170, v50 clamp
  v_pk_sub_u16 v171, v171, v50 clamp
  v_pk_sub_u16 v174, v174, v51 clamp
  v_pk_sub_u16 v175, v175, v51 clamp
  s_cmp_le_u32 s54, 12
  s_cbranch_scc1 L_rarex
  v_pk_sub_u16 v176, v176, v50 clamp
  v_pk_sub_u16 v177, v177, v50 clamp
  v_pk_sub_u16 v180, v180, v51 clamp
  v_pk_sub_u16 v181, v181, v51 clamp
  s_cmp_le_u32 s54, 13
  s_cbranch_scc1 L_rarex
  v_pk_sub_u16 v178, v178, v50 clamp
  v_pk_sub_u16 v179, v179, v50 clamp
  v_pk_sub_u16 v182, v182, v51 clamp
  v_pk_sub_u16 v183, v183, v51 clamp
  s_cmp_le_u32 s54, 14
  s_cbranch_scc1 L_rarex
  v_pk_sub_u16 v184, v184, v50 clamp
  v_pk_sub_u16 v185, v185, v50 clamp
  v_pk_sub_u16 v188, v188, v51 clamp
  v_pk_sub_u16 v189, v189, v51 clamp
  s_cmp_le_u32 s54, 15
  s_cbranch_scc1 L_rarex
  v_pk_sub_u16 v186, v186, v50 clamp
  v_pk_sub_u16 v187, v187, v50 clamp
  v_pk_sub_u16 v190, v190, v51 clamp
  v_pk_sub_u16 v191, v191, v51 clamp
  s_cmp_le_u32 s54, 16
  s_cbranch_scc1 L_rarex
  v_pk_sub_u16 v192, v192, v50 clamp
  v_pk_sub_u16 v193, v193, v50 clamp
  v_pk_sub_u16 v196, v196, v51 clamp
  v_pk_sub_u16 v197, v197, v51 clamp
  s_cmp_le_u32 s54, 17
  s_cbranch_scc1 L_rarex
  v_pk_sub_u16 v194, v194, v50 clamp
  v_pk_sub_u16 v195, v195, v50 clamp
  v_pk_sub_u16 v198, v198, v51 clamp
  v_pk_sub_u16 v199, v199, v51 clamp
  s_cmp_le_u32 s54, 18
  s_cbranch_scc1 L_rarex
  v_pk_sub_u16 v200, v200, v50 clamp
  v_pk_sub_u16 v201, v201, v50 clamp
  v_pk_sub_u16 v204, v204, v51 clamp
  v_pk_sub_u16 v205, v205, v51 clamp
  s_cmp_le_u32 s54, 19
  s_cbranch_scc1 L_rarex
  v_pk_sub_u16 v202, v202, v50 clamp
  v_pk_sub_u16 v203, v203, v50 clamp
  v_pk_sub_u16 v206, v206, v51 clamp
  v_pk_sub_u16 v207, v207, v51 clamp
  s_cmp_le_u32 s54, 20
  s_cbranch_scc1 L_rarex
  v_pk_sub_u16 v208, v208, v50 clamp
  v_pk_sub_u16 v209, v209, v50 clamp
  v_pk_sub_u16 v212, v212, v51 clamp
  v_pk_sub_u16 v213, v213, v51 clamp
  s_cmp_le_u32 s54, 21
  s_cbranch_scc1 L_rarex
  v_pk_sub_u16 v210, v210, v50 clamp
  v_pk_sub_u16 v211, v211, v50 clamp
  v_pk_sub_u16 v214, v214, v51 clamp
  v_pk_sub_u16 v215, v215, v51 clamp
  s_cmp_le_u32 s54, 22
  s_cbranch_scc1 L_rarex
  v_pk_sub_u16 v216, v216, v50 clamp
  v_pk_sub_u16 v217, v217, v50 clamp
  v_pk_sub_u16 v220, v220, v51 clamp
  v_pk_sub_u16 v221, v221, v51 clamp
  s_cmp_le_u32 s54, 23
  s_cbranch_scc1 L_rarex
  v_pk_sub_u16 v218, v218, v50 clamp
  v_pk_sub_u16 v219, v219, v50 clamp
  v_pk_sub_u16 v222, v222, v51 clamp
  v_pk_sub_u16 v223, v223, v51 clamp
  s_cmp_le_u32 s54, 24
  s_cbranch_scc1 L_rarex
  v_pk_sub_u16 v224, v224, v50 clamp
  v_pk_sub_u16 v225, v225, v50 clamp
  v_pk_sub_u16 v228, v228, v51 clamp
  v_pk_sub_u16 v229, v229, v51 clamp
  s_cmp_le_u32 s54, 25
  s_cbranch_scc1 L_rarex
  v_pk_sub_u16 v226, v226, v50 clamp
  v_pk_sub_u16 v227, v227, v50 clamp
  v_pk_sub_u16 v230, v230, v51 clamp
  v_pk_sub_u16 v231, v231, v51 clamp
  s_cmp_le_u32 s54, 26
  s_cbranch_scc1 L_rarex
  v_pk_sub_u16 v232, v232, v50 clamp
  v_pk_sub_u16 v233, v233, v50 clamp
  v_pk_sub_u16 v236, v236, v51 clamp
  v_pk_sub_u16 v237, v237, v51 clamp
  s_cmp_le_u32 s54, 27
  s_cbranch_scc1 L_rarex
  v_pk_sub_u16 v234, v234, v50 clamp
  v_pk_sub_u16 v235, v235, v50 clamp
  v_pk_sub_u16 v238, v238, v51 clamp
  v_pk_sub_u16 v239, v239, v51 clamp
  s_cmp_le_u32 s54, 28
  s_cbranch_scc1 L_rarex
  v_pk_sub_u16 v240, v240, v50 clamp
  v_pk_sub_u16 v241, v241, v50 clamp
  v_pk_sub_u16 v244, v244, v51 clamp
  v_pk_sub_u16 v245, v245, v51 clamp
  s_cmp_le_u32 s54, 29
  s_cbranch_scc1 L_rarex
  v_pk_sub_u16 v242, v242, v50 clamp
  v_pk_sub_u16 v243, v243, v50 clamp
  v_pk_sub_u16 v246, v246, v51 clamp
  v_pk_sub_u16 v247, v247, v51 clamp
  s_cmp_le_u32 s54, 30
  s_cbranch_scc1 L_rarex
  v_pk_sub_u16 v248, v248, v50 clamp
  v_pk_sub_u16 v249, v249, v50 clamp
  v_pk_sub_u16 v252, v252, v51 clamp
  v_pk_sub_u16 v253, v253, v51 clamp
L_rarex:
  s_nop 1
  s_setpc_b64 s[18:19]
L_proj:
  s_cmp_lg_u32 s4, 1
  s_cbranch_scc1 L_nocpf
  s_getpc_b64 s[40:41]
L_pc0:
  s_sub_u32 s40, s40, L_pc0-concat_heads__mha_block_cached__gqa_block_cached__near_ridge_kernel
  s_subb_u32 s41, s41, 0
  s_lshr_b32 s10, s2, 3
  s_mul_i32 s10, s10, 2304
  v_lshlrev_b32 v120, 7, v0
  v_add_u32 v120, s10, v120
  v_min_u32 v120, L_codeend-concat_heads__mha_block_cached__gqa_block_cached__near_ridge_kernel-4, v120
  s_mov_b64 exec, 0x3ffff
  global_load_dword v122, v120, s[40:41]
  s_mov_b64 exec, -1
L_nocpf:
  s_waitcnt lgkmcnt(0)
  s_cmp_eq_u32 s5, 0
  s_cselect_b64 s[28:29], s[44:45], s[56:57]
  s_cselect_b64 s[32:33], s[50:51], s[62:63]
  s_cselect_b64 s[20:21], s[46:47], s[58:59]
  s_cselect_b64 s[24:25], s[48:49], s[60:61]
  s_cselect_b64 s[36:37], s[52:53], s[64:65]
  s_add_u32 s28, s28, s12
  s_addc_u32 s29, s29, 0
  s_add_u32 s32, s32, s13
  s_addc_u32 s33, s33, 0
  s_add_u32 s36, s36, s17
  s_addc_u32 s37, s37, 0
  s_load_dwordx2 s[40:41], s[0:1], 96
  s_lshl_b32 s10, s5, 4
  s_add_u32 s10, s10, s7
  s_lshl_b32 s10, s10, 3
  s_add_u32 s10, s10, s6
  s_lshl_b32 s10, s10, 8
  s_add_u32 s10, s10, 33554432
  s_movk_i32 s42, 128
  s_mov_b32 s43, 0x20000
  v_lshlrev_b32 v1, 2, v0
  v_mov_b32 v2, 0
  s_waitcnt lgkmcnt(0)
  s_add_u32 s40, s40, s10
  s_addc_u32 s41, s41, 0
  s_cmp_lg_u32 s4, 0
  s_cbranch_scc1 L_noinit
  buffer_store_dword v2, v1, s[40:43], 0 offen sc1
L_noinit:
  s_mul_i32 s48, s4, 12288
  s_add_u32 s48, s48, 81920
  v_lshrrev_b32 v1, 5, v0
  v_lshlrev_b32 v1, 11, v1
  v_bfe_u32 v2, v0, 2, 3
  v_lshl_add_u32 v1, v2, 7, v1
  v_bfe_u32 v2, v0, 3, 2
  v_lshl_add_u32 v1, v2, 5, v1
  v_and_b32 v2, 3, v0
  v_lshl_add_u32 v1, v2, 3, v1
  v_add_u32 v1, s48, v1
  v_xor_b32 v2, 32, v1
  v_xor_b32 v3, 64, v1
  v_xor_b32 v4, 96, v1
  v_and_b32 v8, 15, v0
  v_lshrrev_b32 v9, 1, v8
  v_lshrrev_b32 v108, 4, v0
  v_xor_b32 v108, v108, v9
  v_lshlrev_b32 v108, 4, v108
  v_lshl_add_u32 v108, v8, 7, v108
  v_add_u32 v108, 131072, v108
  v_xor_b32 v109, 64, v108
  v_lshrrev_b32 v9, 5, v0
  v_lshl_add_u32 v8, v9, 4, v8
  v_lshlrev_b32 v8, 4, v8
  v_bfe_u32 v9, v0, 4, 1
  v_lshl_add_u32 v8, v9, 3, v8
  s_lshl_b32 s10, s4, 12
  s_add_u32 s10, s10, 81920
  v_add_u32 v110, s10, v8
  v_mov_b32 v112, 0
  v_mov_b32 v113, 0
  v_lshlrev_b32 v12, 4, v0
  v_lshrrev_b32 v8, 3, v0
  v_and_b32 v5, 3, v8
  v_lshrrev_b32 v9, 2, v8
  v_lshl_add_u32 v5, v9, 3, v5
  v_lshlrev_b32 v5, 13, v5
  v_and_b32 v9, 7, v0
  v_and_b32 v8, 6, v8
  v_xor_b32 v9, v9, v8
  v_lshl_add_u32 v5, v9, 4, v5
  v_lshrrev_b32 v104, 3, v0
  s_lshl_b32 s10, s4, 5
  v_add_u32 v104, s10, v104
  v_mul_u32_u24 v104, 896, v104
  v_lshrrev_b32 v8, 4, v0
  v_and_b32 v9, 7, v0
  v_xor_b32 v8, v8, v9
  v_lshl_add_u32 v104, v8, 4, v104
  v_xor_b32 v105, 64, v104
  v_add_u32 v105, 6144, v105
  v_add_u32 v106, 12288, v104
  v_add_u32 v107, 12288, v105
  s_mul_i32 s48, s4, 12288
  s_add_u32 s48, s48, 81920
  s_lshl_b32 s49, s4, 12
  s_add_u32 s49, s49, 131072
  s_and_b32 s10, s6, 1
  s_mul_i32 s10, s10, 3
  s_add_u32 s10, s10, s7
  s_mul_i32 s11, s10, 37
  s_lshr_b32 s11, s11, 8
  s_mul_i32 s11, s11, 7
  s_sub_u32 s10, s10, s11
  s_mul_i32 s10, s10, 1
  s_lshl_b32 s64, s10, 7
  s_lshl_b32 s50, s10, 19
  s_lshl_b32 s10, s4, 7
  s_add_u32 s50, s50, s10
  s_cmp_ge_u32 s7, 7
  s_cselect_b32 s44, 1, 0
  s_lshl_b32 s10, s44, 18
  s_add_u32 s63, s50, 262144
  s_sub_u32 s63, s63, s10
  s_add_u32 s50, s50, s10
  s_lshl_b32 s10, s44, 6
  v_xor_b32 v108, s10, v108
  v_xor_b32 v109, s10, v109
  s_lshl_b32 s10, s7, 3
  s_add_u32 s10, s10, s6
  s_lshl_b32 s11, s10, 19
  s_add_u32 s24, s24, s11
  s_addc_u32 s25, s25, 0
  s_add_u32 s20, s20, s11
  s_addc_u32 s21, s21, 0
  s_sub_u32 s20, s20, 4096
  s_subb_u32 s21, s21, 0
  s_mov_b32 s22, 528384
  s_mov_b32 s23, 0x20000
  s_mov_b32 s26, 524288
  s_mov_b32 s27, 0x20000
  s_lshl_b32 s14, s4, 12
  v_lshrrev_b32 v8, 3, v0
  v_and_b32 v13, 7, v0
  v_lshrrev_b32 v9, 4, v0
  v_xor_b32 v10, v13, v9
  s_and_b32 s10, s4, 1
  s_lshl_b32 s10, s10, 2
  v_xor_b32 v10, s10, v10
  v_lshlrev_b32 v10, 4, v10
  v_lshl_add_u32 v10, v8, 9, v10
  v_lshlrev_b32 v9, 1, v9
  v_xor_b32 v13, v13, v9
  v_lshlrev_b32 v13, 4, v13
  v_lshl_add_u32 v13, v8, 9, v13
  s_lshl_b32 s16, s4, 14
  s_mul_i32 s65, s7, 1
  s_mul_i32 s51, s4, 14336
  s_add_u32 s51, s51, 81920
  s_mul_i32 s13, s4, 224
  s_bfe_u32 s45, s65, 0x10002
  s_lshl_b32 s46, s65, 1
  s_mov_b32 s18, 1035512379
  s_mov_b32 s19, s18
  s_add_u32 s10, s65, 0
  s_and_b32 s10, s10, 3
  s_lshl_b32 s10, s10, 7
  s_add_u32 s56, s10, s16
  s_add_u32 s10, s65, 1
  s_and_b32 s10, s10, 3
  s_lshl_b32 s10, s10, 7
  s_add_u32 s57, s10, s16
  s_add_u32 s10, s65, 2
  s_and_b32 s10, s10, 3
  s_lshl_b32 s10, s10, 7
  s_add_u32 s58, s10, s16
  s_add_u32 s10, s65, 3
  s_and_b32 s10, s10, 3
  s_lshl_b32 s10, s10, 7
  s_add_u32 s59, s10, s16
  s_barrier
  ds_read_b128 v[48:51], v108 offset:0
  ds_read_b128 v[52:55], v108 offset:2048
  ds_read_b128 v[56:59], v108 offset:4096
  ds_read_b128 v[60:63], v108 offset:6144
  ds_read_b128 v[64:67], v108 offset:8192
  ds_read_b128 v[68:71], v108 offset:10240
  ds_read_b128 v[72:75], v108 offset:12288
  ds_read_b64_tr_b16 v[16:17], v1 offset:0
  ds_read_b64_tr_b16 v[18:19], v1 offset:1024
  ds_read_b64_tr_b16 v[20:21], v2 offset:0
  ds_read_b64_tr_b16 v[22:23], v2 offset:1024
  ds_read_b64_tr_b16 v[24:25], v3 offset:0
  ds_read_b64_tr_b16 v[26:27], v3 offset:1024
  ds_read_b64_tr_b16 v[28:29], v4 offset:0
  ds_read_b64_tr_b16 v[30:31], v4 offset:1024
  s_waitcnt lgkmcnt(0)
  s_barrier
  v_mfma_f32_16x16x32_bf16 v[144:147], v[16:19], v[48:51], 0
  ds_read_b128 v[76:79], v109 offset:0
  v_mfma_f32_16x16x32_bf16 v[148:151], v[16:19], v[52:55], 0
  ds_read_b128 v[80:83], v109 offset:2048
  v_mfma_f32_16x16x32_bf16 v[152:155], v[16:19], v[56:59], 0
  ds_read_b128 v[84:87], v109 offset:4096
  v_mfma_f32_16x16x32_bf16 v[156:159], v[16:19], v[60:63], 0
  ds_read_b128 v[88:91], v109 offset:6144
  v_mfma_f32_16x16x32_bf16 v[160:163], v[16:19], v[64:67], 0
  ds_read_b128 v[92:95], v109 offset:8192
  v_mfma_f32_16x16x32_bf16 v[164:167], v[16:19], v[68:71], 0
  ds_read_b128 v[96:99], v109 offset:10240
  v_mfma_f32_16x16x32_bf16 v[168:171], v[16:19], v[72:75], 0
  ds_read_b128 v[100:103], v109 offset:12288
  v_mfma_f32_16x16x32_bf16 v[172:175], v[20:23], v[48:51], 0
  ds_read_b64_tr_b16 v[32:33], v1 offset:4096
  v_mfma_f32_16x16x32_bf16 v[176:179], v[20:23], v[52:55], 0
  ds_read_b64_tr_b16 v[34:35], v1 offset:5120
  v_mfma_f32_16x16x32_bf16 v[180:183], v[20:23], v[56:59], 0
  ds_read_b64_tr_b16 v[36:37], v2 offset:4096
  v_mfma_f32_16x16x32_bf16 v[184:187], v[20:23], v[60:63], 0
  ds_read_b64_tr_b16 v[38:39], v2 offset:5120
  v_mfma_f32_16x16x32_bf16 v[188:191], v[20:23], v[64:67], 0
  ds_read_b64_tr_b16 v[40:41], v3 offset:4096
  v_mfma_f32_16x16x32_bf16 v[192:195], v[20:23], v[68:71], 0
  ds_read_b64_tr_b16 v[42:43], v3 offset:5120
  v_mfma_f32_16x16x32_bf16 v[196:199], v[20:23], v[72:75], 0
  ds_read_b64_tr_b16 v[44:45], v4 offset:4096
  v_mfma_f32_16x16x32_bf16 v[200:203], v[24:27], v[48:51], 0
  ds_read_b64_tr_b16 v[46:47], v4 offset:5120
  v_mfma_f32_16x16x32_bf16 v[204:207], v[24:27], v[52:55], 0
  v_mfma_f32_16x16x32_bf16 v[208:211], v[24:27], v[56:59], 0
  v_mfma_f32_16x16x32_bf16 v[212:215], v[24:27], v[60:63], 0
  v_mfma_f32_16x16x32_bf16 v[216:219], v[24:27], v[64:67], 0
  v_mfma_f32_16x16x32_bf16 v[220:223], v[24:27], v[68:71], 0
  v_mfma_f32_16x16x32_bf16 v[224:227], v[24:27], v[72:75], 0
  v_mfma_f32_16x16x32_bf16 v[228:231], v[28:31], v[48:51], 0
  v_mfma_f32_16x16x32_bf16 v[232:235], v[28:31], v[52:55], 0
  v_mfma_f32_16x16x32_bf16 v[236:239], v[28:31], v[56:59], 0
  v_mfma_f32_16x16x32_bf16 v[240:243], v[28:31], v[60:63], 0
  v_mfma_f32_16x16x32_bf16 v[244:247], v[28:31], v[64:67], 0
  v_mfma_f32_16x16x32_bf16 v[248:251], v[28:31], v[68:71], 0
  v_mfma_f32_16x16x32_bf16 v[252:255], v[28:31], v[72:75], 0
  s_waitcnt lgkmcnt(0)
  s_barrier
  v_mfma_f32_16x16x32_bf16 v[144:147], v[32:35], v[76:79], v[144:147]
  ds_read_b128 v[48:51], v108 offset:16384
  v_mfma_f32_16x16x32_bf16 v[148:151], v[32:35], v[80:83], v[148:151]
  ds_read_b128 v[52:55], v108 offset:18432
  v_mfma_f32_16x16x32_bf16 v[152:155], v[32:35], v[84:87], v[152:155]
  ds_read_b128 v[56:59], v108 offset:20480
  v_mfma_f32_16x16x32_bf16 v[156:159], v[32:35], v[88:91], v[156:159]
  ds_read_b128 v[60:63], v108 offset:22528
  v_mfma_f32_16x16x32_bf16 v[160:163], v[32:35], v[92:95], v[160:163]
  ds_read_b128 v[64:67], v108 offset:24576
  v_mfma_f32_16x16x32_bf16 v[164:167], v[32:35], v[96:99], v[164:167]
  ds_read_b128 v[68:71], v108 offset:26624
  v_mfma_f32_16x16x32_bf16 v[168:171], v[32:35], v[100:103], v[168:171]
  ds_read_b128 v[72:75], v108 offset:28672
  v_mfma_f32_16x16x32_bf16 v[172:175], v[36:39], v[76:79], v[172:175]
  ds_read_b64_tr_b16 v[16:17], v1 offset:8192
  v_mfma_f32_16x16x32_bf16 v[176:179], v[36:39], v[80:83], v[176:179]
  ds_read_b64_tr_b16 v[18:19], v1 offset:9216
  v_mfma_f32_16x16x32_bf16 v[180:183], v[36:39], v[84:87], v[180:183]
  ds_read_b64_tr_b16 v[20:21], v2 offset:8192
  v_mfma_f32_16x16x32_bf16 v[184:187], v[36:39], v[88:91], v[184:187]
  ds_read_b64_tr_b16 v[22:23], v2 offset:9216
  v_mfma_f32_16x16x32_bf16 v[188:191], v[36:39], v[92:95], v[188:191]
  ds_read_b64_tr_b16 v[24:25], v3 offset:8192
  v_mfma_f32_16x16x32_bf16 v[192:195], v[36:39], v[96:99], v[192:195]
  ds_read_b64_tr_b16 v[26:27], v3 offset:9216
  v_mfma_f32_16x16x32_bf16 v[196:199], v[36:39], v[100:103], v[196:199]
  ds_read_b64_tr_b16 v[28:29], v4 offset:8192
  v_mfma_f32_16x16x32_bf16 v[200:203], v[40:43], v[76:79], v[200:203]
  ds_read_b64_tr_b16 v[30:31], v4 offset:9216
  v_mfma_f32_16x16x32_bf16 v[204:207], v[40:43], v[80:83], v[204:207]
  v_mfma_f32_16x16x32_bf16 v[208:211], v[40:43], v[84:87], v[208:211]
  v_mfma_f32_16x16x32_bf16 v[212:215], v[40:43], v[88:91], v[212:215]
  v_mfma_f32_16x16x32_bf16 v[216:219], v[40:43], v[92:95], v[216:219]
  v_mfma_f32_16x16x32_bf16 v[220:223], v[40:43], v[96:99], v[220:223]
  v_mfma_f32_16x16x32_bf16 v[224:227], v[40:43], v[100:103], v[224:227]
  v_mfma_f32_16x16x32_bf16 v[228:231], v[44:47], v[76:79], v[228:231]
  v_mfma_f32_16x16x32_bf16 v[232:235], v[44:47], v[80:83], v[232:235]
  v_mfma_f32_16x16x32_bf16 v[236:239], v[44:47], v[84:87], v[236:239]
  v_mfma_f32_16x16x32_bf16 v[240:243], v[44:47], v[88:91], v[240:243]
  v_mfma_f32_16x16x32_bf16 v[244:247], v[44:47], v[92:95], v[244:247]
  v_mfma_f32_16x16x32_bf16 v[248:251], v[44:47], v[96:99], v[248:251]
  v_mfma_f32_16x16x32_bf16 v[252:255], v[44:47], v[100:103], v[252:255]
  s_waitcnt lgkmcnt(0)
  s_barrier
  v_mfma_f32_16x16x32_bf16 v[144:147], v[16:19], v[48:51], v[144:147]
  ds_read_b128 v[76:79], v109 offset:16384
  v_mfma_f32_16x16x32_bf16 v[148:151], v[16:19], v[52:55], v[148:151]
  ds_read_b128 v[80:83], v109 offset:18432
  v_mfma_f32_16x16x32_bf16 v[152:155], v[16:19], v[56:59], v[152:155]
  ds_read_b128 v[84:87], v109 offset:20480
  v_mfma_f32_16x16x32_bf16 v[156:159], v[16:19], v[60:63], v[156:159]
  ds_read_b128 v[88:91], v109 offset:22528
  v_mfma_f32_16x16x32_bf16 v[160:163], v[16:19], v[64:67], v[160:163]
  ds_read_b128 v[92:95], v109 offset:24576
  v_mfma_f32_16x16x32_bf16 v[164:167], v[16:19], v[68:71], v[164:167]
  ds_read_b128 v[96:99], v109 offset:26624
  v_mfma_f32_16x16x32_bf16 v[168:171], v[16:19], v[72:75], v[168:171]
  ds_read_b128 v[100:103], v109 offset:28672
  v_mfma_f32_16x16x32_bf16 v[172:175], v[20:23], v[48:51], v[172:175]
  ds_read_b64_tr_b16 v[32:33], v1 offset:0
  v_mfma_f32_16x16x32_bf16 v[176:179], v[20:23], v[52:55], v[176:179]
  ds_read_b64_tr_b16 v[34:35], v1 offset:1024
  v_mfma_f32_16x16x32_bf16 v[180:183], v[20:23], v[56:59], v[180:183]
  ds_read_b64_tr_b16 v[36:37], v2 offset:0
  v_mfma_f32_16x16x32_bf16 v[184:187], v[20:23], v[60:63], v[184:187]
  ds_read_b64_tr_b16 v[38:39], v2 offset:1024
  v_mfma_f32_16x16x32_bf16 v[188:191], v[20:23], v[64:67], v[188:191]
  ds_read_b64_tr_b16 v[40:41], v3 offset:0
  v_mfma_f32_16x16x32_bf16 v[192:195], v[20:23], v[68:71], v[192:195]
  ds_read_b64_tr_b16 v[42:43], v3 offset:1024
  v_mfma_f32_16x16x32_bf16 v[196:199], v[20:23], v[72:75], v[196:199]
  ds_read_b64_tr_b16 v[44:45], v4 offset:0
  v_mfma_f32_16x16x32_bf16 v[200:203], v[24:27], v[48:51], v[200:203]
  ds_read_b64_tr_b16 v[46:47], v4 offset:1024
  v_mfma_f32_16x16x32_bf16 v[204:207], v[24:27], v[52:55], v[204:207]
  v_mfma_f32_16x16x32_bf16 v[208:211], v[24:27], v[56:59], v[208:211]
  v_mfma_f32_16x16x32_bf16 v[212:215], v[24:27], v[60:63], v[212:215]
  v_mfma_f32_16x16x32_bf16 v[216:219], v[24:27], v[64:67], v[216:219]
  v_mfma_f32_16x16x32_bf16 v[220:223], v[24:27], v[68:71], v[220:223]
  v_mfma_f32_16x16x32_bf16 v[224:227], v[24:27], v[72:75], v[224:227]
  v_mfma_f32_16x16x32_bf16 v[228:231], v[28:31], v[48:51], v[228:231]
  v_mfma_f32_16x16x32_bf16 v[232:235], v[28:31], v[52:55], v[232:235]
  v_mfma_f32_16x16x32_bf16 v[236:239], v[28:31], v[56:59], v[236:239]
  v_mfma_f32_16x16x32_bf16 v[240:243], v[28:31], v[60:63], v[240:243]
  v_mfma_f32_16x16x32_bf16 v[244:247], v[28:31], v[64:67], v[244:247]
  v_mfma_f32_16x16x32_bf16 v[248:251], v[28:31], v[68:71], v[248:251]
  v_mfma_f32_16x16x32_bf16 v[252:255], v[28:31], v[72:75], v[252:255]
  s_waitcnt lgkmcnt(0)
  s_barrier
  v_mfma_f32_16x16x32_bf16 v[144:147], v[32:35], v[76:79], v[144:147]
  ds_read_b128 v[48:51], v108 offset:0
  v_mfma_f32_16x16x32_bf16 v[148:151], v[32:35], v[80:83], v[148:151]
  ds_read_b128 v[52:55], v108 offset:2048
  v_mfma_f32_16x16x32_bf16 v[152:155], v[32:35], v[84:87], v[152:155]
  ds_read_b128 v[56:59], v108 offset:4096
  v_mfma_f32_16x16x32_bf16 v[156:159], v[32:35], v[88:91], v[156:159]
  ds_read_b128 v[60:63], v108 offset:6144
  v_mfma_f32_16x16x32_bf16 v[160:163], v[32:35], v[92:95], v[160:163]
  ds_read_b128 v[64:67], v108 offset:8192
  v_mfma_f32_16x16x32_bf16 v[164:167], v[32:35], v[96:99], v[164:167]
  ds_read_b128 v[68:71], v108 offset:10240
  v_mfma_f32_16x16x32_bf16 v[168:171], v[32:35], v[100:103], v[168:171]
  ds_read_b128 v[72:75], v108 offset:12288
  v_mfma_f32_16x16x32_bf16 v[172:175], v[36:39], v[76:79], v[172:175]
  ds_read_b64_tr_b16 v[16:17], v1 offset:4096
  v_mfma_f32_16x16x32_bf16 v[176:179], v[36:39], v[80:83], v[176:179]
  ds_read_b64_tr_b16 v[18:19], v1 offset:5120
  v_mfma_f32_16x16x32_bf16 v[180:183], v[36:39], v[84:87], v[180:183]
  ds_read_b64_tr_b16 v[20:21], v2 offset:4096
  v_mfma_f32_16x16x32_bf16 v[184:187], v[36:39], v[88:91], v[184:187]
  ds_read_b64_tr_b16 v[22:23], v2 offset:5120
  v_mfma_f32_16x16x32_bf16 v[188:191], v[36:39], v[92:95], v[188:191]
  ds_read_b64_tr_b16 v[24:25], v3 offset:4096
  v_mfma_f32_16x16x32_bf16 v[192:195], v[36:39], v[96:99], v[192:195]
  ds_read_b64_tr_b16 v[26:27], v3 offset:5120
  v_mfma_f32_16x16x32_bf16 v[196:199], v[36:39], v[100:103], v[196:199]
  ds_read_b64_tr_b16 v[28:29], v4 offset:4096
  v_mfma_f32_16x16x32_bf16 v[200:203], v[40:43], v[76:79], v[200:203]
  ds_read_b64_tr_b16 v[30:31], v4 offset:5120
  v_mfma_f32_16x16x32_bf16 v[204:207], v[40:43], v[80:83], v[204:207]
  v_mfma_f32_16x16x32_bf16 v[208:211], v[40:43], v[84:87], v[208:211]
  v_mfma_f32_16x16x32_bf16 v[212:215], v[40:43], v[88:91], v[212:215]
  v_mfma_f32_16x16x32_bf16 v[216:219], v[40:43], v[92:95], v[216:219]
  v_mfma_f32_16x16x32_bf16 v[220:223], v[40:43], v[96:99], v[220:223]
  v_mfma_f32_16x16x32_bf16 v[224:227], v[40:43], v[100:103], v[224:227]
  v_mfma_f32_16x16x32_bf16 v[228:231], v[44:47], v[76:79], v[228:231]
  v_mfma_f32_16x16x32_bf16 v[232:235], v[44:47], v[80:83], v[232:235]
  v_mfma_f32_16x16x32_bf16 v[236:239], v[44:47], v[84:87], v[236:239]
  v_mfma_f32_16x16x32_bf16 v[240:243], v[44:47], v[88:91], v[240:243]
  v_mfma_f32_16x16x32_bf16 v[244:247], v[44:47], v[92:95], v[244:247]
  v_mfma_f32_16x16x32_bf16 v[248:251], v[44:47], v[96:99], v[248:251]
  v_mfma_f32_16x16x32_bf16 v[252:255], v[44:47], v[100:103], v[252:255]
  s_waitcnt lgkmcnt(0)
  s_barrier
  v_mfma_f32_16x16x32_bf16 v[144:147], v[16:19], v[48:51], v[144:147]
  ds_read_b128 v[76:79], v109 offset:0
  v_mfma_f32_16x16x32_bf16 v[148:151], v[16:19], v[52:55], v[148:151]
  ds_read_b128 v[80:83], v109 offset:2048
  v_mfma_f32_16x16x32_bf16 v[152:155], v[16:19], v[56:59], v[152:155]
  ds_read_b128 v[84:87], v109 offset:4096
  v_mfma_f32_16x16x32_bf16 v[156:159], v[16:19], v[60:63], v[156:159]
  ds_read_b128 v[88:91], v109 offset:6144
  v_mfma_f32_16x16x32_bf16 v[160:163], v[16:19], v[64:67], v[160:163]
  ds_read_b128 v[92:95], v109 offset:8192
  v_mfma_f32_16x16x32_bf16 v[164:167], v[16:19], v[68:71], v[164:167]
  ds_read_b128 v[96:99], v109 offset:10240
  v_mfma_f32_16x16x32_bf16 v[168:171], v[16:19], v[72:75], v[168:171]
  ds_read_b128 v[100:103], v109 offset:12288
  v_mfma_f32_16x16x32_bf16 v[172:175], v[20:23], v[48:51], v[172:175]
  ds_read_b64_tr_b16 v[32:33], v1 offset:8192
  v_mfma_f32_16x16x32_bf16 v[176:179], v[20:23], v[52:55], v[176:179]
  ds_read_b64_tr_b16 v[34:35], v1 offset:9216
  v_mfma_f32_16x16x32_bf16 v[180:183], v[20:23], v[56:59], v[180:183]
  ds_read_b64_tr_b16 v[36:37], v2 offset:8192
  v_mfma_f32_16x16x32_bf16 v[184:187], v[20:23], v[60:63], v[184:187]
  ds_read_b64_tr_b16 v[38:39], v2 offset:9216
  v_mfma_f32_16x16x32_bf16 v[188:191], v[20:23], v[64:67], v[188:191]
  ds_read_b64_tr_b16 v[40:41], v3 offset:8192
  v_mfma_f32_16x16x32_bf16 v[192:195], v[20:23], v[68:71], v[192:195]
  ds_read_b64_tr_b16 v[42:43], v3 offset:9216
  v_mfma_f32_16x16x32_bf16 v[196:199], v[20:23], v[72:75], v[196:199]
  ds_read_b64_tr_b16 v[44:45], v4 offset:8192
  v_mfma_f32_16x16x32_bf16 v[200:203], v[24:27], v[48:51], v[200:203]
  ds_read_b64_tr_b16 v[46:47], v4 offset:9216
  v_mfma_f32_16x16x32_bf16 v[204:207], v[24:27], v[52:55], v[204:207]
  v_mfma_f32_16x16x32_bf16 v[208:211], v[24:27], v[56:59], v[208:211]
  v_mfma_f32_16x16x32_bf16 v[212:215], v[24:27], v[60:63], v[212:215]
  v_mfma_f32_16x16x32_bf16 v[216:219], v[24:27], v[64:67], v[216:219]
  v_mfma_f32_16x16x32_bf16 v[220:223], v[24:27], v[68:71], v[220:223]
  v_mfma_f32_16x16x32_bf16 v[224:227], v[24:27], v[72:75], v[224:227]
  v_mfma_f32_16x16x32_bf16 v[228:231], v[28:31], v[48:51], v[228:231]
  v_mfma_f32_16x16x32_bf16 v[232:235], v[28:31], v[52:55], v[232:235]
  v_mfma_f32_16x16x32_bf16 v[236:239], v[28:31], v[56:59], v[236:239]
  v_mfma_f32_16x16x32_bf16 v[240:243], v[28:31], v[60:63], v[240:243]
  v_mfma_f32_16x16x32_bf16 v[244:247], v[28:31], v[64:67], v[244:247]
  v_mfma_f32_16x16x32_bf16 v[248:251], v[28:31], v[68:71], v[248:251]
  v_mfma_f32_16x16x32_bf16 v[252:255], v[28:31], v[72:75], v[252:255]
  s_waitcnt lgkmcnt(0)
  s_barrier
  v_mfma_f32_16x16x32_bf16 v[144:147], v[32:35], v[76:79], v[144:147]
  ds_read_b128 v[48:51], v108 offset:16384
  v_mfma_f32_16x16x32_bf16 v[148:151], v[32:35], v[80:83], v[148:151]
  ds_read_b128 v[52:55], v108 offset:18432
  v_mfma_f32_16x16x32_bf16 v[152:155], v[32:35], v[84:87], v[152:155]
  ds_read_b128 v[56:59], v108 offset:20480
  v_mfma_f32_16x16x32_bf16 v[156:159], v[32:35], v[88:91], v[156:159]
  ds_read_b128 v[60:63], v108 offset:22528
  v_mfma_f32_16x16x32_bf16 v[160:163], v[32:35], v[92:95], v[160:163]
  ds_read_b128 v[64:67], v108 offset:24576
  v_mfma_f32_16x16x32_bf16 v[164:167], v[32:35], v[96:99], v[164:167]
  ds_read_b128 v[68:71], v108 offset:26624
  v_mfma_f32_16x16x32_bf16 v[168:171], v[32:35], v[100:103], v[168:171]
  ds_read_b128 v[72:75], v108 offset:28672
  v_mfma_f32_16x16x32_bf16 v[172:175], v[36:39], v[76:79], v[172:175]
  ds_read_b64_tr_b16 v[16:17], v1 offset:0
  v_mfma_f32_16x16x32_bf16 v[176:179], v[36:39], v[80:83], v[176:179]
  ds_read_b64_tr_b16 v[18:19], v1 offset:1024
  v_mfma_f32_16x16x32_bf16 v[180:183], v[36:39], v[84:87], v[180:183]
  ds_read_b64_tr_b16 v[20:21], v2 offset:0
  v_mfma_f32_16x16x32_bf16 v[184:187], v[36:39], v[88:91], v[184:187]
  ds_read_b64_tr_b16 v[22:23], v2 offset:1024
  v_mfma_f32_16x16x32_bf16 v[188:191], v[36:39], v[92:95], v[188:191]
  ds_read_b64_tr_b16 v[24:25], v3 offset:0
  v_mfma_f32_16x16x32_bf16 v[192:195], v[36:39], v[96:99], v[192:195]
  ds_read_b64_tr_b16 v[26:27], v3 offset:1024
  v_mfma_f32_16x16x32_bf16 v[196:199], v[36:39], v[100:103], v[196:199]
  ds_read_b64_tr_b16 v[28:29], v4 offset:0
  v_mfma_f32_16x16x32_bf16 v[200:203], v[40:43], v[76:79], v[200:203]
  ds_read_b64_tr_b16 v[30:31], v4 offset:1024
  v_mfma_f32_16x16x32_bf16 v[204:207], v[40:43], v[80:83], v[204:207]
  v_mfma_f32_16x16x32_bf16 v[208:211], v[40:43], v[84:87], v[208:211]
  v_mfma_f32_16x16x32_bf16 v[212:215], v[40:43], v[88:91], v[212:215]
  v_mfma_f32_16x16x32_bf16 v[216:219], v[40:43], v[92:95], v[216:219]
  v_mfma_f32_16x16x32_bf16 v[220:223], v[40:43], v[96:99], v[220:223]
  v_mfma_f32_16x16x32_bf16 v[224:227], v[40:43], v[100:103], v[224:227]
  v_mfma_f32_16x16x32_bf16 v[228:231], v[44:47], v[76:79], v[228:231]
  v_mfma_f32_16x16x32_bf16 v[232:235], v[44:47], v[80:83], v[232:235]
  v_mfma_f32_16x16x32_bf16 v[236:239], v[44:47], v[84:87], v[236:239]
  v_mfma_f32_16x16x32_bf16 v[240:243], v[44:47], v[88:91], v[240:243]
  v_mfma_f32_16x16x32_bf16 v[244:247], v[44:47], v[92:95], v[244:247]
  v_mfma_f32_16x16x32_bf16 v[248:251], v[44:47], v[96:99], v[248:251]
  v_mfma_f32_16x16x32_bf16 v[252:255], v[44:47], v[100:103], v[252:255]
  s_waitcnt lgkmcnt(0)
  s_barrier
  v_mfma_f32_16x16x32_bf16 v[144:147], v[16:19], v[48:51], v[144:147]
  ds_read_b128 v[76:79], v109 offset:16384
  v_mfma_f32_16x16x32_bf16 v[148:151], v[16:19], v[52:55], v[148:151]
  ds_read_b128 v[80:83], v109 offset:18432
  v_mfma_f32_16x16x32_bf16 v[152:155], v[16:19], v[56:59], v[152:155]
  ds_read_b128 v[84:87], v109 offset:20480
  v_mfma_f32_16x16x32_bf16 v[156:159], v[16:19], v[60:63], v[156:159]
  ds_read_b128 v[88:91], v109 offset:22528
  v_mfma_f32_16x16x32_bf16 v[160:163], v[16:19], v[64:67], v[160:163]
  ds_read_b128 v[92:95], v109 offset:24576
  v_mfma_f32_16x16x32_bf16 v[164:167], v[16:19], v[68:71], v[164:167]
  ds_read_b128 v[96:99], v109 offset:26624
  v_mfma_f32_16x16x32_bf16 v[168:171], v[16:19], v[72:75], v[168:171]
  ds_read_b128 v[100:103], v109 offset:28672
  v_mfma_f32_16x16x32_bf16 v[172:175], v[20:23], v[48:51], v[172:175]
  ds_read_b64_tr_b16 v[32:33], v1 offset:4096
  v_mfma_f32_16x16x32_bf16 v[176:179], v[20:23], v[52:55], v[176:179]
  ds_read_b64_tr_b16 v[34:35], v1 offset:5120
  v_mfma_f32_16x16x32_bf16 v[180:183], v[20:23], v[56:59], v[180:183]
  ds_read_b64_tr_b16 v[36:37], v2 offset:4096
  v_mfma_f32_16x16x32_bf16 v[184:187], v[20:23], v[60:63], v[184:187]
  ds_read_b64_tr_b16 v[38:39], v2 offset:5120
  v_mfma_f32_16x16x32_bf16 v[188:191], v[20:23], v[64:67], v[188:191]
  ds_read_b64_tr_b16 v[40:41], v3 offset:4096
  v_mfma_f32_16x16x32_bf16 v[192:195], v[20:23], v[68:71], v[192:195]
  ds_read_b64_tr_b16 v[42:43], v3 offset:5120
  v_mfma_f32_16x16x32_bf16 v[196:199], v[20:23], v[72:75], v[196:199]
  ds_read_b64_tr_b16 v[44:45], v4 offset:4096
  v_mfma_f32_16x16x32_bf16 v[200:203], v[24:27], v[48:51], v[200:203]
  ds_read_b64_tr_b16 v[46:47], v4 offset:5120
  v_mfma_f32_16x16x32_bf16 v[204:207], v[24:27], v[52:55], v[204:207]
  v_mfma_f32_16x16x32_bf16 v[208:211], v[24:27], v[56:59], v[208:211]
  v_mfma_f32_16x16x32_bf16 v[212:215], v[24:27], v[60:63], v[212:215]
  v_mfma_f32_16x16x32_bf16 v[216:219], v[24:27], v[64:67], v[216:219]
  v_mfma_f32_16x16x32_bf16 v[220:223], v[24:27], v[68:71], v[220:223]
  v_mfma_f32_16x16x32_bf16 v[224:227], v[24:27], v[72:75], v[224:227]
  v_mfma_f32_16x16x32_bf16 v[228:231], v[28:31], v[48:51], v[228:231]
  v_mfma_f32_16x16x32_bf16 v[232:235], v[28:31], v[52:55], v[232:235]
  v_mfma_f32_16x16x32_bf16 v[236:239], v[28:31], v[56:59], v[236:239]
  v_mfma_f32_16x16x32_bf16 v[240:243], v[28:31], v[60:63], v[240:243]
  v_mfma_f32_16x16x32_bf16 v[244:247], v[28:31], v[64:67], v[244:247]
  v_mfma_f32_16x16x32_bf16 v[248:251], v[28:31], v[68:71], v[248:251]
  v_mfma_f32_16x16x32_bf16 v[252:255], v[28:31], v[72:75], v[252:255]
  s_waitcnt lgkmcnt(0)
  s_barrier
  v_mfma_f32_16x16x32_bf16 v[144:147], v[32:35], v[76:79], v[144:147]
  ds_read_b128 v[48:51], v108 offset:0
  v_mfma_f32_16x16x32_bf16 v[148:151], v[32:35], v[80:83], v[148:151]
  ds_read_b128 v[52:55], v108 offset:2048
  v_mfma_f32_16x16x32_bf16 v[152:155], v[32:35], v[84:87], v[152:155]
  ds_read_b128 v[56:59], v108 offset:4096
  v_mfma_f32_16x16x32_bf16 v[156:159], v[32:35], v[88:91], v[156:159]
  ds_read_b128 v[60:63], v108 offset:6144
  v_mfma_f32_16x16x32_bf16 v[160:163], v[32:35], v[92:95], v[160:163]
  ds_read_b128 v[64:67], v108 offset:8192
  v_mfma_f32_16x16x32_bf16 v[164:167], v[32:35], v[96:99], v[164:167]
  ds_read_b128 v[68:71], v108 offset:10240
  v_mfma_f32_16x16x32_bf16 v[168:171], v[32:35], v[100:103], v[168:171]
  ds_read_b128 v[72:75], v108 offset:12288
  v_mfma_f32_16x16x32_bf16 v[172:175], v[36:39], v[76:79], v[172:175]
  ds_read_b64_tr_b16 v[16:17], v1 offset:8192
  v_mfma_f32_16x16x32_bf16 v[176:179], v[36:39], v[80:83], v[176:179]
  ds_read_b64_tr_b16 v[18:19], v1 offset:9216
  v_mfma_f32_16x16x32_bf16 v[180:183], v[36:39], v[84:87], v[180:183]
  ds_read_b64_tr_b16 v[20:21], v2 offset:8192
  v_mfma_f32_16x16x32_bf16 v[184:187], v[36:39], v[88:91], v[184:187]
  ds_read_b64_tr_b16 v[22:23], v2 offset:9216
  v_mfma_f32_16x16x32_bf16 v[188:191], v[36:39], v[92:95], v[188:191]
  ds_read_b64_tr_b16 v[24:25], v3 offset:8192
  v_mfma_f32_16x16x32_bf16 v[192:195], v[36:39], v[96:99], v[192:195]
  ds_read_b64_tr_b16 v[26:27], v3 offset:9216
  v_mfma_f32_16x16x32_bf16 v[196:199], v[36:39], v[100:103], v[196:199]
  ds_read_b64_tr_b16 v[28:29], v4 offset:8192
  v_mfma_f32_16x16x32_bf16 v[200:203], v[40:43], v[76:79], v[200:203]
  ds_read_b64_tr_b16 v[30:31], v4 offset:9216
  v_mfma_f32_16x16x32_bf16 v[204:207], v[40:43], v[80:83], v[204:207]
  v_mfma_f32_16x16x32_bf16 v[208:211], v[40:43], v[84:87], v[208:211]
  v_mfma_f32_16x16x32_bf16 v[212:215], v[40:43], v[88:91], v[212:215]
  v_mfma_f32_16x16x32_bf16 v[216:219], v[40:43], v[92:95], v[216:219]
  v_mfma_f32_16x16x32_bf16 v[220:223], v[40:43], v[96:99], v[220:223]
  v_mfma_f32_16x16x32_bf16 v[224:227], v[40:43], v[100:103], v[224:227]
  v_mfma_f32_16x16x32_bf16 v[228:231], v[44:47], v[76:79], v[228:231]
  v_mfma_f32_16x16x32_bf16 v[232:235], v[44:47], v[80:83], v[232:235]
  v_mfma_f32_16x16x32_bf16 v[236:239], v[44:47], v[84:87], v[236:239]
  v_mfma_f32_16x16x32_bf16 v[240:243], v[44:47], v[88:91], v[240:243]
  v_mfma_f32_16x16x32_bf16 v[244:247], v[44:47], v[92:95], v[244:247]
  v_mfma_f32_16x16x32_bf16 v[248:251], v[44:47], v[96:99], v[248:251]
  v_mfma_f32_16x16x32_bf16 v[252:255], v[44:47], v[100:103], v[252:255]
  s_waitcnt lgkmcnt(0)
  s_barrier
  v_mfma_f32_16x16x32_bf16 v[144:147], v[16:19], v[48:51], v[144:147]
  ds_read_b128 v[76:79], v109 offset:0
  v_mfma_f32_16x16x32_bf16 v[148:151], v[16:19], v[52:55], v[148:151]
  ds_read_b128 v[80:83], v109 offset:2048
  v_mfma_f32_16x16x32_bf16 v[152:155], v[16:19], v[56:59], v[152:155]
  ds_read_b128 v[84:87], v109 offset:4096
  v_mfma_f32_16x16x32_bf16 v[156:159], v[16:19], v[60:63], v[156:159]
  ds_read_b128 v[88:91], v109 offset:6144
  v_mfma_f32_16x16x32_bf16 v[160:163], v[16:19], v[64:67], v[160:163]
  ds_read_b128 v[92:95], v109 offset:8192
  v_mfma_f32_16x16x32_bf16 v[164:167], v[16:19], v[68:71], v[164:167]
  ds_read_b128 v[96:99], v109 offset:10240
  v_mfma_f32_16x16x32_bf16 v[168:171], v[16:19], v[72:75], v[168:171]
  ds_read_b128 v[100:103], v109 offset:12288
  v_mfma_f32_16x16x32_bf16 v[172:175], v[20:23], v[48:51], v[172:175]
  ds_read_b64_tr_b16 v[32:33], v1 offset:0
  v_mfma_f32_16x16x32_bf16 v[176:179], v[20:23], v[52:55], v[176:179]
  ds_read_b64_tr_b16 v[34:35], v1 offset:1024
  v_mfma_f32_16x16x32_bf16 v[180:183], v[20:23], v[56:59], v[180:183]
  ds_read_b64_tr_b16 v[36:37], v2 offset:0
  v_mfma_f32_16x16x32_bf16 v[184:187], v[20:23], v[60:63], v[184:187]
  ds_read_b64_tr_b16 v[38:39], v2 offset:1024
  v_mfma_f32_16x16x32_bf16 v[188:191], v[20:23], v[64:67], v[188:191]
  ds_read_b64_tr_b16 v[40:41], v3 offset:0
  v_mfma_f32_16x16x32_bf16 v[192:195], v[20:23], v[68:71], v[192:195]
  ds_read_b64_tr_b16 v[42:43], v3 offset:1024
  v_mfma_f32_16x16x32_bf16 v[196:199], v[20:23], v[72:75], v[196:199]
  ds_read_b64_tr_b16 v[44:45], v4 offset:0
  v_mfma_f32_16x16x32_bf16 v[200:203], v[24:27], v[48:51], v[200:203]
  ds_read_b64_tr_b16 v[46:47], v4 offset:1024
  v_mfma_f32_16x16x32_bf16 v[204:207], v[24:27], v[52:55], v[204:207]
  v_mfma_f32_16x16x32_bf16 v[208:211], v[24:27], v[56:59], v[208:211]
  v_mfma_f32_16x16x32_bf16 v[212:215], v[24:27], v[60:63], v[212:215]
  v_mfma_f32_16x16x32_bf16 v[216:219], v[24:27], v[64:67], v[216:219]
  v_mfma_f32_16x16x32_bf16 v[220:223], v[24:27], v[68:71], v[220:223]
  v_mfma_f32_16x16x32_bf16 v[224:227], v[24:27], v[72:75], v[224:227]
  v_mfma_f32_16x16x32_bf16 v[228:231], v[28:31], v[48:51], v[228:231]
  v_mfma_f32_16x16x32_bf16 v[232:235], v[28:31], v[52:55], v[232:235]
  v_mfma_f32_16x16x32_bf16 v[236:239], v[28:31], v[56:59], v[236:239]
  v_mfma_f32_16x16x32_bf16 v[240:243], v[28:31], v[60:63], v[240:243]
  v_mfma_f32_16x16x32_bf16 v[244:247], v[28:31], v[64:67], v[244:247]
  v_mfma_f32_16x16x32_bf16 v[248:251], v[28:31], v[68:71], v[248:251]
  v_mfma_f32_16x16x32_bf16 v[252:255], v[28:31], v[72:75], v[252:255]
  s_waitcnt lgkmcnt(0)
  s_barrier
  v_mfma_f32_16x16x32_bf16 v[144:147], v[32:35], v[76:79], v[144:147]
  ds_read_b128 v[48:51], v108 offset:16384
  v_mfma_f32_16x16x32_bf16 v[148:151], v[32:35], v[80:83], v[148:151]
  ds_read_b128 v[52:55], v108 offset:18432
  v_mfma_f32_16x16x32_bf16 v[152:155], v[32:35], v[84:87], v[152:155]
  ds_read_b128 v[56:59], v108 offset:20480
  v_mfma_f32_16x16x32_bf16 v[156:159], v[32:35], v[88:91], v[156:159]
  ds_read_b128 v[60:63], v108 offset:22528
  v_mfma_f32_16x16x32_bf16 v[160:163], v[32:35], v[92:95], v[160:163]
  ds_read_b128 v[64:67], v108 offset:24576
  v_mfma_f32_16x16x32_bf16 v[164:167], v[32:35], v[96:99], v[164:167]
  ds_read_b128 v[68:71], v108 offset:26624
  v_mfma_f32_16x16x32_bf16 v[168:171], v[32:35], v[100:103], v[168:171]
  ds_read_b128 v[72:75], v108 offset:28672
  v_mfma_f32_16x16x32_bf16 v[172:175], v[36:39], v[76:79], v[172:175]
  ds_read_b64_tr_b16 v[16:17], v1 offset:4096
  v_mfma_f32_16x16x32_bf16 v[176:179], v[36:39], v[80:83], v[176:179]
  ds_read_b64_tr_b16 v[18:19], v1 offset:5120
  v_mfma_f32_16x16x32_bf16 v[180:183], v[36:39], v[84:87], v[180:183]
  ds_read_b64_tr_b16 v[20:21], v2 offset:4096
  v_mfma_f32_16x16x32_bf16 v[184:187], v[36:39], v[88:91], v[184:187]
  ds_read_b64_tr_b16 v[22:23], v2 offset:5120
  v_mfma_f32_16x16x32_bf16 v[188:191], v[36:39], v[92:95], v[188:191]
  ds_read_b64_tr_b16 v[24:25], v3 offset:4096
  v_mfma_f32_16x16x32_bf16 v[192:195], v[36:39], v[96:99], v[192:195]
  ds_read_b64_tr_b16 v[26:27], v3 offset:5120
  v_mfma_f32_16x16x32_bf16 v[196:199], v[36:39], v[100:103], v[196:199]
  ds_read_b64_tr_b16 v[28:29], v4 offset:4096
  v_mfma_f32_16x16x32_bf16 v[200:203], v[40:43], v[76:79], v[200:203]
  ds_read_b64_tr_b16 v[30:31], v4 offset:5120
  v_mfma_f32_16x16x32_bf16 v[204:207], v[40:43], v[80:83], v[204:207]
  v_mfma_f32_16x16x32_bf16 v[208:211], v[40:43], v[84:87], v[208:211]
  v_mfma_f32_16x16x32_bf16 v[212:215], v[40:43], v[88:91], v[212:215]
  v_mfma_f32_16x16x32_bf16 v[216:219], v[40:43], v[92:95], v[216:219]
  v_mfma_f32_16x16x32_bf16 v[220:223], v[40:43], v[96:99], v[220:223]
  v_mfma_f32_16x16x32_bf16 v[224:227], v[40:43], v[100:103], v[224:227]
  v_mfma_f32_16x16x32_bf16 v[228:231], v[44:47], v[76:79], v[228:231]
  v_mfma_f32_16x16x32_bf16 v[232:235], v[44:47], v[80:83], v[232:235]
  v_mfma_f32_16x16x32_bf16 v[236:239], v[44:47], v[84:87], v[236:239]
  v_mfma_f32_16x16x32_bf16 v[240:243], v[44:47], v[88:91], v[240:243]
  v_mfma_f32_16x16x32_bf16 v[244:247], v[44:47], v[92:95], v[244:247]
  v_mfma_f32_16x16x32_bf16 v[248:251], v[44:47], v[96:99], v[248:251]
  v_mfma_f32_16x16x32_bf16 v[252:255], v[44:47], v[100:103], v[252:255]
  s_waitcnt lgkmcnt(0)
  s_barrier
  v_mfma_f32_16x16x32_bf16 v[144:147], v[16:19], v[48:51], v[144:147]
  ds_read_b128 v[76:79], v109 offset:16384
  v_mfma_f32_16x16x32_bf16 v[148:151], v[16:19], v[52:55], v[148:151]
  ds_read_b128 v[80:83], v109 offset:18432
  v_mfma_f32_16x16x32_bf16 v[152:155], v[16:19], v[56:59], v[152:155]
  ds_read_b128 v[84:87], v109 offset:20480
  v_mfma_f32_16x16x32_bf16 v[156:159], v[16:19], v[60:63], v[156:159]
  ds_read_b128 v[88:91], v109 offset:22528
  v_mfma_f32_16x16x32_bf16 v[160:163], v[16:19], v[64:67], v[160:163]
  ds_read_b128 v[92:95], v109 offset:24576
  v_mfma_f32_16x16x32_bf16 v[164:167], v[16:19], v[68:71], v[164:167]
  ds_read_b128 v[96:99], v109 offset:26624
  v_mfma_f32_16x16x32_bf16 v[168:171], v[16:19], v[72:75], v[168:171]
  ds_read_b128 v[100:103], v109 offset:28672
  v_mfma_f32_16x16x32_bf16 v[172:175], v[20:23], v[48:51], v[172:175]
  ds_read_b64_tr_b16 v[32:33], v1 offset:8192
  v_mfma_f32_16x16x32_bf16 v[176:179], v[20:23], v[52:55], v[176:179]
  ds_read_b64_tr_b16 v[34:35], v1 offset:9216
  v_mfma_f32_16x16x32_bf16 v[180:183], v[20:23], v[56:59], v[180:183]
  ds_read_b64_tr_b16 v[36:37], v2 offset:8192
  v_mfma_f32_16x16x32_bf16 v[184:187], v[20:23], v[60:63], v[184:187]
  ds_read_b64_tr_b16 v[38:39], v2 offset:9216
  v_mfma_f32_16x16x32_bf16 v[188:191], v[20:23], v[64:67], v[188:191]
  ds_read_b64_tr_b16 v[40:41], v3 offset:8192
  v_mfma_f32_16x16x32_bf16 v[192:195], v[20:23], v[68:71], v[192:195]
  ds_read_b64_tr_b16 v[42:43], v3 offset:9216
  v_mfma_f32_16x16x32_bf16 v[196:199], v[20:23], v[72:75], v[196:199]
  ds_read_b64_tr_b16 v[44:45], v4 offset:8192
  v_mfma_f32_16x16x32_bf16 v[200:203], v[24:27], v[48:51], v[200:203]
  ds_read_b64_tr_b16 v[46:47], v4 offset:9216
  v_mfma_f32_16x16x32_bf16 v[204:207], v[24:27], v[52:55], v[204:207]
  v_mfma_f32_16x16x32_bf16 v[208:211], v[24:27], v[56:59], v[208:211]
  v_mfma_f32_16x16x32_bf16 v[212:215], v[24:27], v[60:63], v[212:215]
  v_mfma_f32_16x16x32_bf16 v[216:219], v[24:27], v[64:67], v[216:219]
  v_mfma_f32_16x16x32_bf16 v[220:223], v[24:27], v[68:71], v[220:223]
  v_mfma_f32_16x16x32_bf16 v[224:227], v[24:27], v[72:75], v[224:227]
  v_mfma_f32_16x16x32_bf16 v[228:231], v[28:31], v[48:51], v[228:231]
  v_mfma_f32_16x16x32_bf16 v[232:235], v[28:31], v[52:55], v[232:235]
  v_mfma_f32_16x16x32_bf16 v[236:239], v[28:31], v[56:59], v[236:239]
  v_mfma_f32_16x16x32_bf16 v[240:243], v[28:31], v[60:63], v[240:243]
  v_mfma_f32_16x16x32_bf16 v[244:247], v[28:31], v[64:67], v[244:247]
  v_mfma_f32_16x16x32_bf16 v[248:251], v[28:31], v[68:71], v[248:251]
  v_mfma_f32_16x16x32_bf16 v[252:255], v[28:31], v[72:75], v[252:255]
  s_waitcnt lgkmcnt(0)
  s_barrier
  v_mfma_f32_16x16x32_bf16 v[144:147], v[32:35], v[76:79], v[144:147]
  ds_read_b128 v[48:51], v108 offset:0
  v_mfma_f32_16x16x32_bf16 v[148:151], v[32:35], v[80:83], v[148:151]
  ds_read_b128 v[52:55], v108 offset:2048
  v_mfma_f32_16x16x32_bf16 v[152:155], v[32:35], v[84:87], v[152:155]
  ds_read_b128 v[56:59], v108 offset:4096
  v_mfma_f32_16x16x32_bf16 v[156:159], v[32:35], v[88:91], v[156:159]
  ds_read_b128 v[60:63], v108 offset:6144
  v_mfma_f32_16x16x32_bf16 v[160:163], v[32:35], v[92:95], v[160:163]
  ds_read_b128 v[64:67], v108 offset:8192
  v_mfma_f32_16x16x32_bf16 v[164:167], v[32:35], v[96:99], v[164:167]
  ds_read_b128 v[68:71], v108 offset:10240
  v_mfma_f32_16x16x32_bf16 v[168:171], v[32:35], v[100:103], v[168:171]
  ds_read_b128 v[72:75], v108 offset:12288
  v_mfma_f32_16x16x32_bf16 v[172:175], v[36:39], v[76:79], v[172:175]
  ds_read_b64_tr_b16 v[16:17], v1 offset:0
  v_mfma_f32_16x16x32_bf16 v[176:179], v[36:39], v[80:83], v[176:179]
  ds_read_b64_tr_b16 v[18:19], v1 offset:1024
  v_mfma_f32_16x16x32_bf16 v[180:183], v[36:39], v[84:87], v[180:183]
  ds_read_b64_tr_b16 v[20:21], v2 offset:0
  v_mfma_f32_16x16x32_bf16 v[184:187], v[36:39], v[88:91], v[184:187]
  ds_read_b64_tr_b16 v[22:23], v2 offset:1024
  v_mfma_f32_16x16x32_bf16 v[188:191], v[36:39], v[92:95], v[188:191]
  ds_read_b64_tr_b16 v[24:25], v3 offset:0
  v_mfma_f32_16x16x32_bf16 v[192:195], v[36:39], v[96:99], v[192:195]
  ds_read_b64_tr_b16 v[26:27], v3 offset:1024
  v_mfma_f32_16x16x32_bf16 v[196:199], v[36:39], v[100:103], v[196:199]
  ds_read_b64_tr_b16 v[28:29], v4 offset:0
  v_mfma_f32_16x16x32_bf16 v[200:203], v[40:43], v[76:79], v[200:203]
  ds_read_b64_tr_b16 v[30:31], v4 offset:1024
  v_mfma_f32_16x16x32_bf16 v[204:207], v[40:43], v[80:83], v[204:207]
  v_mfma_f32_16x16x32_bf16 v[208:211], v[40:43], v[84:87], v[208:211]
  v_mfma_f32_16x16x32_bf16 v[212:215], v[40:43], v[88:91], v[212:215]
  v_mfma_f32_16x16x32_bf16 v[216:219], v[40:43], v[92:95], v[216:219]
  v_mfma_f32_16x16x32_bf16 v[220:223], v[40:43], v[96:99], v[220:223]
  v_mfma_f32_16x16x32_bf16 v[224:227], v[40:43], v[100:103], v[224:227]
  v_mfma_f32_16x16x32_bf16 v[228:231], v[44:47], v[76:79], v[228:231]
  v_mfma_f32_16x16x32_bf16 v[232:235], v[44:47], v[80:83], v[232:235]
  v_mfma_f32_16x16x32_bf16 v[236:239], v[44:47], v[84:87], v[236:239]
  v_mfma_f32_16x16x32_bf16 v[240:243], v[44:47], v[88:91], v[240:243]
  v_mfma_f32_16x16x32_bf16 v[244:247], v[44:47], v[92:95], v[244:247]
  v_mfma_f32_16x16x32_bf16 v[248:251], v[44:47], v[96:99], v[248:251]
  v_mfma_f32_16x16x32_bf16 v[252:255], v[44:47], v[100:103], v[252:255]
  s_waitcnt lgkmcnt(0)
  s_barrier
  ds_read_b128 v[76:79], v109 offset:0
  ds_read_b128 v[80:83], v109 offset:2048
  ds_read_b128 v[84:87], v109 offset:4096
  ds_read_b128 v[88:91], v109 offset:6144
  ds_read_b128 v[92:95], v109 offset:8192
  ds_read_b128 v[96:99], v109 offset:10240
  ds_read_b128 v[100:103], v109 offset:12288
  v_mfma_f32_16x16x32_bf16 v[144:147], v[16:19], v[48:51], v[144:147]
  ds_read_b64_tr_b16 v[32:33], v1 offset:4096
  v_mfma_f32_16x16x32_bf16 v[148:151], v[16:19], v[52:55], v[148:151]
  ds_read_b64_tr_b16 v[34:35], v1 offset:5120
  v_mfma_f32_16x16x32_bf16 v[152:155], v[16:19], v[56:59], v[152:155]
  ds_read_b64_tr_b16 v[36:37], v2 offset:4096
  v_mfma_f32_16x16x32_bf16 v[156:159], v[16:19], v[60:63], v[156:159]
  ds_read_b64_tr_b16 v[38:39], v2 offset:5120
  v_mfma_f32_16x16x32_bf16 v[160:163], v[16:19], v[64:67], v[160:163]
  ds_read_b64_tr_b16 v[40:41], v3 offset:4096
  v_mfma_f32_16x16x32_bf16 v[164:167], v[16:19], v[68:71], v[164:167]
  ds_read_b64_tr_b16 v[42:43], v3 offset:5120
  v_mfma_f32_16x16x32_bf16 v[168:171], v[16:19], v[72:75], v[168:171]
  ds_read_b64_tr_b16 v[44:45], v4 offset:4096
  v_mfma_f32_16x16x32_bf16 v[172:175], v[20:23], v[48:51], v[172:175]
  ds_read_b64_tr_b16 v[46:47], v4 offset:5120
  v_mfma_f32_16x16x32_bf16 v[176:179], v[20:23], v[52:55], v[176:179]
  v_mfma_f32_16x16x32_bf16 v[180:183], v[20:23], v[56:59], v[180:183]
  v_mfma_f32_16x16x32_bf16 v[184:187], v[20:23], v[60:63], v[184:187]
  v_mfma_f32_16x16x32_bf16 v[188:191], v[20:23], v[64:67], v[188:191]
  s_waitcnt lgkmcnt(0)
  s_barrier
  ds_write_b64 v110, v[112:113] offset:50176
  ds_write_b64 v110, v[112:113] offset:50688
  ds_write_b64 v110, v[112:113] offset:52224
  ds_write_b64 v110, v[112:113] offset:52736
  v_mfma_f32_16x16x32_bf16 v[192:195], v[20:23], v[68:71], v[192:195]
  v_mfma_f32_16x16x32_bf16 v[144:147], v[32:35], v[76:79], v[144:147]
  v_mfma_f32_16x16x32_bf16 v[196:199], v[20:23], v[72:75], v[196:199]
  v_mfma_f32_16x16x32_bf16 v[148:151], v[32:35], v[80:83], v[148:151]
  v_mfma_f32_16x16x32_bf16 v[200:203], v[24:27], v[48:51], v[200:203]
  v_mfma_f32_16x16x32_bf16 v[152:155], v[32:35], v[84:87], v[152:155]
  s_nop 3
  v_mul_f32 v144, s18, v144
  v_mul_f32 v145, s18, v145
  v_mul_f32 v146, s18, v146
  v_mul_f32 v147, s18, v147
  v_cvt_pk_bf16_f32 v144, v144, v145
  v_cvt_pk_bf16_f32 v145, v146, v147
  ds_write_b64 v110, v[144:145] offset:0
  v_mfma_f32_16x16x32_bf16 v[204:207], v[24:27], v[52:55], v[204:207]
  v_mfma_f32_16x16x32_bf16 v[156:159], v[32:35], v[88:91], v[156:159]
  v_mul_f32 v148, s18, v148
  v_mul_f32 v149, s18, v149
  v_mul_f32 v150, s18, v150
  v_mul_f32 v151, s18, v151
  v_cvt_pk_bf16_f32 v148, v148, v149
  v_cvt_pk_bf16_f32 v149, v150, v151
  ds_write_b64 v110, v[148:149] offset:1024
  v_mfma_f32_16x16x32_bf16 v[208:211], v[24:27], v[56:59], v[208:211]
  v_mfma_f32_16x16x32_bf16 v[160:163], v[32:35], v[92:95], v[160:163]
  v_mul_f32 v152, s18, v152
  v_mul_f32 v153, s18, v153
  v_mul_f32 v154, s18, v154
  v_mul_f32 v155, s18, v155
  v_cvt_pk_bf16_f32 v152, v152, v153
  v_cvt_pk_bf16_f32 v153, v154, v155
  ds_write_b64 v110, v[152:153] offset:16384
  v_mfma_f32_16x16x32_bf16 v[212:215], v[24:27], v[60:63], v[212:215]
  v_mfma_f32_16x16x32_bf16 v[164:167], v[32:35], v[96:99], v[164:167]
  v_mul_f32 v156, s18, v156
  v_mul_f32 v157, s18, v157
  v_mul_f32 v158, s18, v158
  v_mul_f32 v159, s18, v159
  v_cvt_pk_bf16_f32 v156, v156, v157
  v_cvt_pk_bf16_f32 v157, v158, v159
  ds_write_b64 v110, v[156:157] offset:17408
  v_mfma_f32_16x16x32_bf16 v[216:219], v[24:27], v[64:67], v[216:219]
  v_mfma_f32_16x16x32_bf16 v[168:171], v[32:35], v[100:103], v[168:171]
  v_mul_f32 v160, s18, v160
  v_mul_f32 v161, s18, v161
  v_mul_f32 v162, s18, v162
  v_mul_f32 v163, s18, v163
  v_cvt_pk_bf16_f32 v160, v160, v161
  v_cvt_pk_bf16_f32 v161, v162, v163
  ds_write_b64 v110, v[160:161] offset:32768
  v_mfma_f32_16x16x32_bf16 v[220:223], v[24:27], v[68:71], v[220:223]
  v_mfma_f32_16x16x32_bf16 v[172:175], v[36:39], v[76:79], v[172:175]
  v_mul_f32 v164, s18, v164
  v_mul_f32 v165, s18, v165
  v_mul_f32 v166, s18, v166
  v_mul_f32 v167, s18, v167
  v_cvt_pk_bf16_f32 v164, v164, v165
  v_cvt_pk_bf16_f32 v165, v166, v167
  ds_write_b64 v110, v[164:165] offset:33792
  v_mfma_f32_16x16x32_bf16 v[224:227], v[24:27], v[72:75], v[224:227]
  v_mfma_f32_16x16x32_bf16 v[176:179], v[36:39], v[80:83], v[176:179]
  v_mul_f32 v168, s18, v168
  v_mul_f32 v169, s18, v169
  v_mul_f32 v170, s18, v170
  v_mul_f32 v171, s18, v171
  v_cvt_pk_bf16_f32 v168, v168, v169
  v_cvt_pk_bf16_f32 v169, v170, v171
  ds_write_b64 v110, v[168:169] offset:49152
  v_mfma_f32_16x16x32_bf16 v[228:231], v[28:31], v[48:51], v[228:231]
  v_mfma_f32_16x16x32_bf16 v[180:183], v[36:39], v[84:87], v[180:183]
  v_mul_f32 v172, s18, v172
  v_mul_f32 v173, s18, v173
  v_mul_f32 v174, s18, v174
  v_mul_f32 v175, s18, v175
  v_cvt_pk_bf16_f32 v172, v172, v173
  v_cvt_pk_bf16_f32 v173, v174, v175
  ds_write_b64 v110, v[172:173] offset:512
  v_mfma_f32_16x16x32_bf16 v[232:235], v[28:31], v[52:55], v[232:235]
  v_mfma_f32_16x16x32_bf16 v[184:187], v[36:39], v[88:91], v[184:187]
  v_mul_f32 v176, s18, v176
  v_mul_f32 v177, s18, v177
  v_mul_f32 v178, s18, v178
  v_mul_f32 v179, s18, v179
  v_cvt_pk_bf16_f32 v176, v176, v177
  v_cvt_pk_bf16_f32 v177, v178, v179
  ds_write_b64 v110, v[176:177] offset:1536
  v_mfma_f32_16x16x32_bf16 v[236:239], v[28:31], v[56:59], v[236:239]
  v_mfma_f32_16x16x32_bf16 v[188:191], v[36:39], v[92:95], v[188:191]
  s_waitcnt lgkmcnt(7)
  v_mul_f32 v180, s18, v180
  v_mul_f32 v181, s18, v181
  v_mul_f32 v182, s18, v182
  v_mul_f32 v183, s18, v183
  v_cvt_pk_bf16_f32 v180, v180, v181
  v_cvt_pk_bf16_f32 v181, v182, v183
  ds_write_b64 v110, v[180:181] offset:16896
  v_mfma_f32_16x16x32_bf16 v[240:243], v[28:31], v[60:63], v[240:243]
  v_mfma_f32_16x16x32_bf16 v[192:195], v[36:39], v[96:99], v[192:195]
  v_mul_f32 v184, s18, v184
  v_mul_f32 v185, s18, v185
  v_mul_f32 v186, s18, v186
  v_mul_f32 v187, s18, v187
  v_cvt_pk_bf16_f32 v184, v184, v185
  v_cvt_pk_bf16_f32 v185, v186, v187
  ds_write_b64 v110, v[184:185] offset:17920
  v_mfma_f32_16x16x32_bf16 v[244:247], v[28:31], v[64:67], v[244:247]
  v_mfma_f32_16x16x32_bf16 v[196:199], v[36:39], v[100:103], v[196:199]
  v_mul_f32 v188, s18, v188
  v_mul_f32 v189, s18, v189
  v_mul_f32 v190, s18, v190
  v_mul_f32 v191, s18, v191
  v_cvt_pk_bf16_f32 v188, v188, v189
  v_cvt_pk_bf16_f32 v189, v190, v191
  ds_write_b64 v110, v[188:189] offset:33280
  v_mfma_f32_16x16x32_bf16 v[248:251], v[28:31], v[68:71], v[248:251]
  v_mfma_f32_16x16x32_bf16 v[200:203], v[40:43], v[76:79], v[200:203]
  v_mul_f32 v192, s18, v192
  v_mul_f32 v193, s18, v193
  v_mul_f32 v194, s18, v194
  v_mul_f32 v195, s18, v195
  v_cvt_pk_bf16_f32 v192, v192, v193
  v_cvt_pk_bf16_f32 v193, v194, v195
  ds_write_b64 v110, v[192:193] offset:34304
  v_mfma_f32_16x16x32_bf16 v[252:255], v[28:31], v[72:75], v[252:255]
  v_mfma_f32_16x16x32_bf16 v[204:207], v[40:43], v[80:83], v[204:207]
  v_mul_f32 v196, s18, v196
  v_mul_f32 v197, s18, v197
  v_mul_f32 v198, s18, v198
  v_mul_f32 v199, s18, v199
  v_cvt_pk_bf16_f32 v196, v196, v197
  v_cvt_pk_bf16_f32 v197, v198, v199
  ds_write_b64 v110, v[196:197] offset:49664
  v_mfma_f32_16x16x32_bf16 v[208:211], v[40:43], v[84:87], v[208:211]
  v_mfma_f32_16x16x32_bf16 v[212:215], v[40:43], v[88:91], v[212:215]
  v_mul_f32 v200, s18, v200
  v_mul_f32 v201, s18, v201
  v_mul_f32 v202, s18, v202
  v_mul_f32 v203, s18, v203
  v_cvt_pk_bf16_f32 v200, v200, v201
  v_cvt_pk_bf16_f32 v201, v202, v203
  ds_write_b64 v110, v[200:201] offset:2048
  v_mfma_f32_16x16x32_bf16 v[216:219], v[40:43], v[92:95], v[216:219]
  v_mfma_f32_16x16x32_bf16 v[220:223], v[40:43], v[96:99], v[220:223]
  s_waitcnt lgkmcnt(7)
  v_mul_f32 v204, s18, v204
  v_mul_f32 v205, s18, v205
  v_mul_f32 v206, s18, v206
  v_mul_f32 v207, s18, v207
  v_cvt_pk_bf16_f32 v204, v204, v205
  v_cvt_pk_bf16_f32 v205, v206, v207
  ds_write_b64 v110, v[204:205] offset:3072
  v_mfma_f32_16x16x32_bf16 v[224:227], v[40:43], v[100:103], v[224:227]
  v_mul_f32 v208, s18, v208
  v_mul_f32 v209, s18, v209
  v_mul_f32 v210, s18, v210
  v_mul_f32 v211, s18, v211
  v_cvt_pk_bf16_f32 v208, v208, v209
  v_cvt_pk_bf16_f32 v209, v210, v211
  ds_write_b64 v110, v[208:209] offset:18432
  v_mfma_f32_16x16x32_bf16 v[228:231], v[44:47], v[76:79], v[228:231]
  v_mul_f32 v212, s18, v212
  v_mul_f32 v213, s18, v213
  v_mul_f32 v214, s18, v214
  v_mul_f32 v215, s18, v215
  v_cvt_pk_bf16_f32 v212, v212, v213
  v_cvt_pk_bf16_f32 v213, v214, v215
  ds_write_b64 v110, v[212:213] offset:19456
  v_mfma_f32_16x16x32_bf16 v[232:235], v[44:47], v[80:83], v[232:235]
  v_mul_f32 v216, s18, v216
  v_mul_f32 v217, s18, v217
  v_mul_f32 v218, s18, v218
  v_mul_f32 v219, s18, v219
  v_cvt_pk_bf16_f32 v216, v216, v217
  v_cvt_pk_bf16_f32 v217, v218, v219
  ds_write_b64 v110, v[216:217] offset:34816
  v_mfma_f32_16x16x32_bf16 v[236:239], v[44:47], v[84:87], v[236:239]
  v_mul_f32 v220, s18, v220
  v_mul_f32 v221, s18, v221
  v_mul_f32 v222, s18, v222
  v_mul_f32 v223, s18, v223
  v_cvt_pk_bf16_f32 v220, v220, v221
  v_cvt_pk_bf16_f32 v221, v222, v223
  ds_write_b64 v110, v[220:221] offset:35840
  v_mfma_f32_16x16x32_bf16 v[240:243], v[44:47], v[88:91], v[240:243]
  v_mul_f32 v224, s18, v224
  v_mul_f32 v225, s18, v225
  v_mul_f32 v226, s18, v226
  v_mul_f32 v227, s18, v227
  v_cvt_pk_bf16_f32 v224, v224, v225
  v_cvt_pk_bf16_f32 v225, v226, v227
  ds_write_b64 v110, v[224:225] offset:51200
  v_mfma_f32_16x16x32_bf16 v[244:247], v[44:47], v[92:95], v[244:247]
  s_waitcnt lgkmcnt(7)
  v_mul_f32 v228, s18, v228
  v_mul_f32 v229, s18, v229
  v_mul_f32 v230, s18, v230
  v_mul_f32 v231, s18, v231
  v_cvt_pk_bf16_f32 v228, v228, v229
  v_cvt_pk_bf16_f32 v229, v230, v231
  ds_write_b64 v110, v[228:229] offset:2560
  v_mfma_f32_16x16x32_bf16 v[248:251], v[44:47], v[96:99], v[248:251]
  v_mul_f32 v232, s18, v232
  v_mul_f32 v233, s18, v233
  v_mul_f32 v234, s18, v234
  v_mul_f32 v235, s18, v235
  v_cvt_pk_bf16_f32 v232, v232, v233
  v_cvt_pk_bf16_f32 v233, v234, v235
  ds_write_b64 v110, v[232:233] offset:3584
  v_mfma_f32_16x16x32_bf16 v[252:255], v[44:47], v[100:103], v[252:255]
  v_mul_f32 v236, s18, v236
  v_mul_f32 v237, s18, v237
  v_mul_f32 v238, s18, v238
  v_mul_f32 v239, s18, v239
  v_cvt_pk_bf16_f32 v236, v236, v237
  v_cvt_pk_bf16_f32 v237, v238, v239
  ds_write_b64 v110, v[236:237] offset:18944
  v_mul_f32 v240, s18, v240
  v_mul_f32 v241, s18, v241
  v_mul_f32 v242, s18, v242
  v_mul_f32 v243, s18, v243
  v_cvt_pk_bf16_f32 v240, v240, v241
  v_cvt_pk_bf16_f32 v241, v242, v243
  ds_write_b64 v110, v[240:241] offset:19968
  v_mul_f32 v244, s18, v244
  v_mul_f32 v245, s18, v245
  v_mul_f32 v246, s18, v246
  v_mul_f32 v247, s18, v247
  v_cvt_pk_bf16_f32 v244, v244, v245
  v_cvt_pk_bf16_f32 v245, v246, v247
  ds_write_b64 v110, v[244:245] offset:35328
  v_mul_f32 v248, s18, v248
  v_mul_f32 v249, s18, v249
  v_mul_f32 v250, s18, v250
  v_mul_f32 v251, s18, v251
  v_cvt_pk_bf16_f32 v248, v248, v249
  v_cvt_pk_bf16_f32 v249, v250, v251
  ds_write_b64 v110, v[248:249] offset:36352
  s_waitcnt lgkmcnt(7)
  v_mul_f32 v252, s18, v252
  v_mul_f32 v253, s18, v253
  v_mul_f32 v254, s18, v254
  v_mul_f32 v255, s18, v255
  v_cvt_pk_bf16_f32 v252, v252, v253
  v_cvt_pk_bf16_f32 v253, v254, v255
  ds_write_b64 v110, v[252:253] offset:51712
  s_waitcnt lgkmcnt(0)
  s_barrier
  s_barrier
  s_add_u32 m0, s48, 0
  s_add_u32 s10, s50, 512
  buffer_load_dwordx4 v5, s[32:35], s10 offen offset:0 lds
  s_add_u32 m0, s48, 0
  s_add_u32 s10, s50, 32256
  buffer_load_dwordx4 v5, s[32:35], s10 offen offset:1024 lds
  s_add_u32 m0, s48, 0
  s_add_u32 s10, s50, 129536
  buffer_load_dwordx4 v5, s[32:35], s10 offen offset:2048 lds
  s_add_u32 m0, s48, 0
  s_add_u32 s10, s50, 161280
  buffer_load_dwordx4 v5, s[32:35], s10 offen offset:3072 lds
  s_add_u32 m0, s49, 0
  s_nop 0
  buffer_load_dwordx4 v104, s[28:31], s64 offen offset:0 lds
  s_add_u32 m0, s49, 0
  s_nop 0
  buffer_load_dwordx4 v105, s[28:31], s64 offen offset:1024 lds
  s_add_u32 m0, s49, 0
  s_nop 0
  buffer_load_dwordx4 v106, s[28:31], s64 offen offset:2048 lds
  s_add_u32 m0, s49, 0
  s_nop 0
  buffer_load_dwordx4 v107, s[28:31], s64 offen offset:3072 lds
  s_add_u32 s64, s64, 128
  s_cmp_eq_u32 s64, 896
  s_cselect_b32 s64, 0, s64
  s_add_u32 m0, s48, 4096
  s_add_u32 s10, s63, 512
  buffer_load_dwordx4 v5, s[32:35], s10 offen offset:0 lds
  s_add_u32 m0, s48, 4096
  s_add_u32 s10, s63, 32256
  buffer_load_dwordx4 v5, s[32:35], s10 offen offset:1024 lds
  s_add_u32 m0, s48, 4096
  s_add_u32 s10, s63, 129536
  buffer_load_dwordx4 v5, s[32:35], s10 offen offset:2048 lds
  s_add_u32 m0, s48, 4096
  s_add_u32 s10, s63, 161280
  buffer_load_dwordx4 v5, s[32:35], s10 offen offset:3072 lds
  s_add_u32 s50, s50, 524288
  s_cmp_ge_u32 s50, 3670016
  s_cselect_b32 s10, 3670016, 0
  s_sub_u32 s50, s50, s10
  s_add_u32 s63, s63, 524288
  s_sub_u32 s63, s63, s10
  s_mul_i32 s10, s7, 112
  s_mul_i32 s11, s4, 28
  s_add_u32 s10, s10, s11
  s_lshl_b32 s10, s10, 7
  s_add_u32 s10, s10, 0
  v_lshlrev_b32 v115, 7, v0
  s_mov_b64 exec, 0xfffffff
  buffer_load_dword v115, v115, s[36:39], s10 offen
  s_mov_b64 exec, -1
  s_waitcnt lgkmcnt(0)
  s_barrier
  s_add_u32 m0, s48, 8192
  s_add_u32 s10, s50, 512
  buffer_load_dwordx4 v5, s[32:35], s10 offen offset:0 lds
  s_add_u32 m0, s48, 8192
  s_add_u32 s10, s50, 32256
  buffer_load_dwordx4 v5, s[32:35], s10 offen offset:1024 lds
  s_add_u32 m0, s48, 8192
  s_add_u32 s10, s50, 129536
  buffer_load_dwordx4 v5, s[32:35], s10 offen offset:2048 lds
  s_add_u32 m0, s48, 8192
  s_add_u32 s10, s50, 161280
  buffer_load_dwordx4 v5, s[32:35], s10 offen offset:3072 lds
  s_add_u32 m0, s49, 16384
  s_nop 0
  buffer_load_dwordx4 v104, s[28:31], s64 offen offset:0 lds
  s_add_u32 m0, s49, 16384
  s_nop 0
  buffer_load_dwordx4 v105, s[28:31], s64 offen offset:1024 lds
  s_add_u32 m0, s49, 16384
  s_nop 0
  buffer_load_dwordx4 v106, s[28:31], s64 offen offset:2048 lds
  s_add_u32 m0, s49, 16384
  s_nop 0
  buffer_load_dwordx4 v107, s[28:31], s64 offen offset:3072 lds
  s_add_u32 s64, s64, 128
  s_cmp_eq_u32 s64, 896
  s_cselect_b32 s64, 0, s64
  s_mul_i32 s10, s7, 112
  s_mul_i32 s11, s4, 28
  s_add_u32 s10, s10, s11
  s_lshl_b32 s10, s10, 7
  s_add_u32 s10, s10, 229376
  v_lshlrev_b32 v117, 7, v0
  s_mov_b64 exec, 0xfffffff
  buffer_load_dword v117, v117, s[36:39], s10 offen
  s_mov_b64 exec, -1
  s_waitcnt lgkmcnt(0) vmcnt(10)
  s_barrier
  ds_read_b128 v[48:51], v108 offset:0
  ds_read_b128 v[52:55], v108 offset:2048
  ds_read_b128 v[56:59], v108 offset:4096
  ds_read_b128 v[60:63], v108 offset:6144
  ds_read_b128 v[64:67], v108 offset:8192
  ds_read_b128 v[68:71], v108 offset:10240
  ds_read_b128 v[72:75], v108 offset:12288
  ds_read_b64_tr_b16 v[16:17], v1 offset:0
  ds_read_b64_tr_b16 v[18:19], v1 offset:1024
  ds_read_b64_tr_b16 v[20:21], v2 offset:0
  ds_read_b64_tr_b16 v[22:23], v2 offset:1024
  ds_read_b64_tr_b16 v[24:25], v3 offset:0
  ds_read_b64_tr_b16 v[26:27], v3 offset:1024
  ds_read_b64_tr_b16 v[28:29], v4 offset:0
  ds_read_b64_tr_b16 v[30:31], v4 offset:1024
  s_waitcnt lgkmcnt(0)
  v_mfma_f32_16x16x32_bf16 v[144:147], v[16:19], v[48:51], 0
  v_mfma_f32_16x16x32_bf16 v[148:151], v[16:19], v[52:55], 0
  v_mfma_f32_16x16x32_bf16 v[152:155], v[16:19], v[56:59], 0
  v_mfma_f32_16x16x32_bf16 v[156:159], v[16:19], v[60:63], 0
  v_mfma_f32_16x16x32_bf16 v[160:163], v[16:19], v[64:67], 0
  v_mfma_f32_16x16x32_bf16 v[164:167], v[16:19], v[68:71], 0
  ds_read_b128 v[76:79], v109 offset:0
  v_mfma_f32_16x16x32_bf16 v[168:171], v[16:19], v[72:75], 0
  ds_read_b128 v[80:83], v109 offset:2048
  v_mfma_f32_16x16x32_bf16 v[172:175], v[20:23], v[48:51], 0
  ds_read_b128 v[84:87], v109 offset:4096
  v_mfma_f32_16x16x32_bf16 v[176:179], v[20:23], v[52:55], 0
  ds_read_b128 v[88:91], v109 offset:6144
  v_mfma_f32_16x16x32_bf16 v[180:183], v[20:23], v[56:59], 0
  ds_read_b128 v[92:95], v109 offset:8192
  v_mfma_f32_16x16x32_bf16 v[184:187], v[20:23], v[60:63], 0
  ds_read_b128 v[96:99], v109 offset:10240
  v_mfma_f32_16x16x32_bf16 v[188:191], v[20:23], v[64:67], 0
  ds_read_b128 v[100:103], v109 offset:12288
  v_mfma_f32_16x16x32_bf16 v[192:195], v[20:23], v[68:71], 0
  ds_read_b64_tr_b16 v[32:33], v1 offset:4096
  v_mfma_f32_16x16x32_bf16 v[196:199], v[20:23], v[72:75], 0
  s_add_u32 m0, s14, 0
  s_add_u32 s10, s14, 86016
  buffer_load_dwordx4 v10, s[20:23], s10 offen offset:0 nt lds
  s_add_u32 s10, s14, 85120
  buffer_load_dwordx4 v10, s[20:23], s10 offen offset:1024 nt lds
  s_add_u32 s10, s14, 84224
  buffer_load_dwordx4 v10, s[20:23], s10 offen offset:2048 nt lds
  s_add_u32 s10, s14, 83328
  buffer_load_dwordx4 v10, s[20:23], s10 offen offset:3072 nt lds
  ds_read_b64_tr_b16 v[34:35], v1 offset:5120
  s_waitcnt lgkmcnt(0)
  s_barrier
  v_mfma_f32_16x16x32_bf16 v[200:203], v[24:27], v[48:51], 0
  ds_read_b64_tr_b16 v[36:37], v2 offset:4096
  v_mfma_f32_16x16x32_bf16 v[204:207], v[24:27], v[52:55], 0
  ds_read_b64_tr_b16 v[38:39], v2 offset:5120
  v_mfma_f32_16x16x32_bf16 v[208:211], v[24:27], v[56:59], 0
  ds_read_b64_tr_b16 v[40:41], v3 offset:4096
  v_mfma_f32_16x16x32_bf16 v[212:215], v[24:27], v[60:63], 0
  ds_read_b64_tr_b16 v[42:43], v3 offset:5120
  v_mfma_f32_16x16x32_bf16 v[216:219], v[24:27], v[64:67], 0
  ds_read_b64_tr_b16 v[44:45], v4 offset:4096
  v_mfma_f32_16x16x32_bf16 v[220:223], v[24:27], v[68:71], 0
  ds_read_b64_tr_b16 v[46:47], v4 offset:5120
  v_mfma_f32_16x16x32_bf16 v[224:227], v[24:27], v[72:75], 0
  s_add_u32 m0, s48, 0
  s_add_u32 s10, s63, 512
  buffer_load_dwordx4 v5, s[32:35], s10 offen offset:0 lds
  v_mfma_f32_16x16x32_bf16 v[228:231], v[28:31], v[48:51], 0
  s_add_u32 m0, s48, 0
  s_add_u32 s10, s63, 32256
  buffer_load_dwordx4 v5, s[32:35], s10 offen offset:1024 lds
  v_mfma_f32_16x16x32_bf16 v[232:235], v[28:31], v[52:55], 0
  s_add_u32 m0, s48, 0
  s_add_u32 s10, s63, 129536
  buffer_load_dwordx4 v5, s[32:35], s10 offen offset:2048 lds
  v_mfma_f32_16x16x32_bf16 v[236:239], v[28:31], v[56:59], 0
  s_add_u32 m0, s48, 0
  s_add_u32 s10, s63, 161280
  buffer_load_dwordx4 v5, s[32:35], s10 offen offset:3072 lds
  s_add_u32 s50, s50, 524288
  s_cmp_ge_u32 s50, 3670016
  s_cselect_b32 s10, 3670016, 0
  s_sub_u32 s50, s50, s10
  s_add_u32 s63, s63, 524288
  s_sub_u32 s63, s63, s10
  v_mfma_f32_16x16x32_bf16 v[240:243], v[28:31], v[60:63], 0
  v_mfma_f32_16x16x32_bf16 v[244:247], v[28:31], v[64:67], 0
  v_mfma_f32_16x16x32_bf16 v[248:251], v[28:31], v[68:71], 0
  s_add_u32 m0, s14, 16384
  s_add_u32 s10, s14, 102400
  buffer_load_dwordx4 v10, s[20:23], s10 offen offset:0 nt lds
  s_add_u32 s10, s14, 101504
  buffer_load_dwordx4 v10, s[20:23], s10 offen offset:1024 nt lds
  s_add_u32 s10, s14, 100608
  buffer_load_dwordx4 v10, s[20:23], s10 offen offset:2048 nt lds
  s_add_u32 s10, s14, 99712
  buffer_load_dwordx4 v10, s[20:23], s10 offen offset:3072 nt lds
  s_waitcnt lgkmcnt(0) vmcnt(8)
  s_barrier
  v_mfma_f32_16x16x32_bf16 v[252:255], v[28:31], v[72:75], 0
  v_mfma_f32_16x16x32_bf16 v[144:147], v[32:35], v[76:79], v[144:147]
  v_mfma_f32_16x16x32_bf16 v[148:151], v[32:35], v[80:83], v[148:151]
  v_mfma_f32_16x16x32_bf16 v[152:155], v[32:35], v[84:87], v[152:155]
  v_mfma_f32_16x16x32_bf16 v[156:159], v[32:35], v[88:91], v[156:159]
  v_mfma_f32_16x16x32_bf16 v[160:163], v[32:35], v[92:95], v[160:163]
  v_mfma_f32_16x16x32_bf16 v[164:167], v[32:35], v[96:99], v[164:167]
  ds_read_b128 v[48:51], v108 offset:16384
  v_mfma_f32_16x16x32_bf16 v[168:171], v[32:35], v[100:103], v[168:171]
  ds_read_b128 v[52:55], v108 offset:18432
  v_mfma_f32_16x16x32_bf16 v[172:175], v[36:39], v[76:79], v[172:175]
  ds_read_b128 v[56:59], v108 offset:20480
  v_mfma_f32_16x16x32_bf16 v[176:179], v[36:39], v[80:83], v[176:179]
  ds_read_b128 v[60:63], v108 offset:22528
  v_mfma_f32_16x16x32_bf16 v[180:183], v[36:39], v[84:87], v[180:183]
  ds_read_b128 v[64:67], v108 offset:24576
  v_mfma_f32_16x16x32_bf16 v[184:187], v[36:39], v[88:91], v[184:187]
  ds_read_b128 v[68:71], v108 offset:26624
  v_mfma_f32_16x16x32_bf16 v[188:191], v[36:39], v[92:95], v[188:191]
  s_add_u32 m0, s14, 32768
  s_add_u32 s10, s14, 118784
  buffer_load_dwordx4 v10, s[20:23], s10 offen offset:0 nt lds
  s_add_u32 s10, s14, 117888
  buffer_load_dwordx4 v10, s[20:23], s10 offen offset:1024 nt lds
  s_add_u32 s10, s14, 116992
  buffer_load_dwordx4 v10, s[20:23], s10 offen offset:2048 nt lds
  s_add_u32 s10, s14, 116096
  buffer_load_dwordx4 v10, s[20:23], s10 offen offset:3072 nt lds
  ds_read_b128 v[72:75], v108 offset:28672
  s_waitcnt lgkmcnt(0) vmcnt(4)
  s_barrier
  v_mfma_f32_16x16x32_bf16 v[192:195], v[36:39], v[96:99], v[192:195]
  ds_read_b64_tr_b16 v[16:17], v1 offset:8192
  v_mfma_f32_16x16x32_bf16 v[196:199], v[36:39], v[100:103], v[196:199]
  ds_read_b64_tr_b16 v[18:19], v1 offset:9216
  v_mfma_f32_16x16x32_bf16 v[200:203], v[40:43], v[76:79], v[200:203]
  ds_read_b64_tr_b16 v[20:21], v2 offset:8192
  v_mfma_f32_16x16x32_bf16 v[204:207], v[40:43], v[80:83], v[204:207]
  ds_read_b64_tr_b16 v[22:23], v2 offset:9216
  v_mfma_f32_16x16x32_bf16 v[208:211], v[40:43], v[84:87], v[208:211]
  ds_read_b64_tr_b16 v[24:25], v3 offset:8192
  v_mfma_f32_16x16x32_bf16 v[212:215], v[40:43], v[88:91], v[212:215]
  ds_read_b64_tr_b16 v[26:27], v3 offset:9216
  v_mfma_f32_16x16x32_bf16 v[216:219], v[40:43], v[92:95], v[216:219]
  ds_read_b64_tr_b16 v[28:29], v4 offset:8192
  v_mfma_f32_16x16x32_bf16 v[220:223], v[40:43], v[96:99], v[220:223]
  ds_read_b64_tr_b16 v[30:31], v4 offset:9216
  v_mfma_f32_16x16x32_bf16 v[224:227], v[40:43], v[100:103], v[224:227]
  s_add_u32 m0, s48, 4096
  s_add_u32 s10, s50, 512
  buffer_load_dwordx4 v5, s[32:35], s10 offen offset:0 lds
  v_mfma_f32_16x16x32_bf16 v[228:231], v[44:47], v[76:79], v[228:231]
  s_add_u32 m0, s48, 4096
  s_add_u32 s10, s50, 32256
  buffer_load_dwordx4 v5, s[32:35], s10 offen offset:1024 lds
  v_mfma_f32_16x16x32_bf16 v[232:235], v[44:47], v[80:83], v[232:235]
  s_add_u32 m0, s48, 4096
  s_add_u32 s10, s50, 129536
  buffer_load_dwordx4 v5, s[32:35], s10 offen offset:2048 lds
  v_mfma_f32_16x16x32_bf16 v[236:239], v[44:47], v[84:87], v[236:239]
  s_add_u32 m0, s48, 4096
  s_add_u32 s10, s50, 161280
  buffer_load_dwordx4 v5, s[32:35], s10 offen offset:3072 lds
  v_mfma_f32_16x16x32_bf16 v[240:243], v[44:47], v[88:91], v[240:243]
  s_add_u32 m0, s49, 0
  s_nop 0
  buffer_load_dwordx4 v104, s[28:31], s64 offen offset:0 lds
  v_mfma_f32_16x16x32_bf16 v[244:247], v[44:47], v[92:95], v[244:247]
  s_add_u32 m0, s14, 49152
  s_add_u32 s10, s14, 135168
  buffer_load_dwordx4 v10, s[20:23], s10 offen offset:0 nt lds
  s_add_u32 s10, s14, 134272
  buffer_load_dwordx4 v10, s[20:23], s10 offen offset:1024 nt lds
  s_add_u32 s10, s14, 133376
  buffer_load_dwordx4 v10, s[20:23], s10 offen offset:2048 nt lds
  s_add_u32 s10, s14, 132480
  buffer_load_dwordx4 v10, s[20:23], s10 offen offset:3072 nt lds
  s_add_u32 m0, s49, 0
  s_nop 0
  buffer_load_dwordx4 v105, s[28:31], s64 offen offset:1024 lds
  s_waitcnt lgkmcnt(0) vmcnt(10)
  s_barrier
  v_mfma_f32_16x16x32_bf16 v[248:251], v[44:47], v[96:99], v[248:251]
  s_add_u32 m0, s49, 0
  s_nop 0
  buffer_load_dwordx4 v106, s[28:31], s64 offen offset:2048 lds
  v_mfma_f32_16x16x32_bf16 v[252:255], v[44:47], v[100:103], v[252:255]
  s_add_u32 m0, s49, 0
  s_nop 0
  buffer_load_dwordx4 v107, s[28:31], s64 offen offset:3072 lds
  s_add_u32 s64, s64, 128
  s_cmp_eq_u32 s64, 896
  s_cselect_b32 s64, 0, s64
  v_mfma_f32_16x16x32_bf16 v[144:147], v[16:19], v[48:51], v[144:147]
  v_mfma_f32_16x16x32_bf16 v[148:151], v[16:19], v[52:55], v[148:151]
  v_mfma_f32_16x16x32_bf16 v[152:155], v[16:19], v[56:59], v[152:155]
  v_mfma_f32_16x16x32_bf16 v[156:159], v[16:19], v[60:63], v[156:159]
  v_mfma_f32_16x16x32_bf16 v[160:163], v[16:19], v[64:67], v[160:163]
  v_mfma_f32_16x16x32_bf16 v[164:167], v[16:19], v[68:71], v[164:167]
  ds_read_b128 v[76:79], v109 offset:16384
  v_mfma_f32_16x16x32_bf16 v[168:171], v[16:19], v[72:75], v[168:171]
  ds_read_b128 v[80:83], v109 offset:18432
  v_mfma_f32_16x16x32_bf16 v[172:175], v[20:23], v[48:51], v[172:175]
  ds_read_b128 v[84:87], v109 offset:20480
  v_mfma_f32_16x16x32_bf16 v[176:179], v[20:23], v[52:55], v[176:179]
  ds_read_b128 v[88:91], v109 offset:22528
  v_mfma_f32_16x16x32_bf16 v[180:183], v[20:23], v[56:59], v[180:183]
  ds_read_b128 v[92:95], v109 offset:24576
  v_mfma_f32_16x16x32_bf16 v[184:187], v[20:23], v[60:63], v[184:187]
  s_add_u32 m0, s14, 65536
  s_add_u32 s10, s14, 151552
  buffer_load_dwordx4 v10, s[20:23], s10 offen offset:0 nt lds
  s_add_u32 s10, s14, 150656
  buffer_load_dwordx4 v10, s[20:23], s10 offen offset:1024 nt lds
  s_add_u32 s10, s14, 149760
  buffer_load_dwordx4 v10, s[20:23], s10 offen offset:2048 nt lds
  s_add_u32 s10, s14, 148864
  buffer_load_dwordx4 v10, s[20:23], s10 offen offset:3072 nt lds
  ds_read_b128 v[96:99], v109 offset:26624
  s_waitcnt lgkmcnt(0) vmcnt(7)
  s_barrier
  v_mfma_f32_16x16x32_bf16 v[188:191], v[20:23], v[64:67], v[188:191]
  ds_read_b128 v[100:103], v109 offset:28672
  v_mfma_f32_16x16x32_bf16 v[192:195], v[20:23], v[68:71], v[192:195]
  ds_read_b64_tr_b16 v[32:33], v1 offset:0
  v_mfma_f32_16x16x32_bf16 v[196:199], v[20:23], v[72:75], v[196:199]
  ds_read_b64_tr_b16 v[34:35], v1 offset:1024
  v_mfma_f32_16x16x32_bf16 v[200:203], v[24:27], v[48:51], v[200:203]
  ds_read_b64_tr_b16 v[36:37], v2 offset:0
  v_mfma_f32_16x16x32_bf16 v[204:207], v[24:27], v[52:55], v[204:207]
  ds_read_b64_tr_b16 v[38:39], v2 offset:1024
  v_mfma_f32_16x16x32_bf16 v[208:211], v[24:27], v[56:59], v[208:211]
  ds_read_b64_tr_b16 v[40:41], v3 offset:0
  v_mfma_f32_16x16x32_bf16 v[212:215], v[24:27], v[60:63], v[212:215]
  ds_read_b64_tr_b16 v[42:43], v3 offset:1024
  v_mfma_f32_16x16x32_bf16 v[216:219], v[24:27], v[64:67], v[216:219]
  ds_read_b64_tr_b16 v[44:45], v4 offset:0
  v_mfma_f32_16x16x32_bf16 v[220:223], v[24:27], v[68:71], v[220:223]
  ds_read_b64_tr_b16 v[46:47], v4 offset:1024
  v_mfma_f32_16x16x32_bf16 v[224:227], v[24:27], v[72:75], v[224:227]
  s_add_u32 m0, s48, 8192
  s_add_u32 s10, s63, 512
  buffer_load_dwordx4 v5, s[32:35], s10 offen offset:0 lds
  v_mfma_f32_16x16x32_bf16 v[228:231], v[28:31], v[48:51], v[228:231]
  s_add_u32 m0, s48, 8192
  s_add_u32 s10, s63, 32256
  buffer_load_dwordx4 v5, s[32:35], s10 offen offset:1024 lds
  v_mfma_f32_16x16x32_bf16 v[232:235], v[28:31], v[52:55], v[232:235]
  s_add_u32 m0, s48, 8192
  s_add_u32 s10, s63, 129536
  buffer_load_dwordx4 v5, s[32:35], s10 offen offset:2048 lds
  v_mfma_f32_16x16x32_bf16 v[236:239], v[28:31], v[56:59], v[236:239]
  s_add_u32 m0, s14, 0
  s_add_u32 s10, s14, 167936
  buffer_load_dwordx4 v10, s[20:23], s10 offen offset:0 nt lds
  s_add_u32 s10, s14, 167040
  buffer_load_dwordx4 v10, s[20:23], s10 offen offset:1024 nt lds
  s_add_u32 s10, s14, 166144
  buffer_load_dwordx4 v10, s[20:23], s10 offen offset:2048 nt lds
  s_add_u32 s10, s14, 165248
  buffer_load_dwordx4 v10, s[20:23], s10 offen offset:3072 nt lds
  s_add_u32 m0, s48, 8192
  s_add_u32 s10, s63, 161280
  buffer_load_dwordx4 v5, s[32:35], s10 offen offset:3072 lds
  s_add_u32 s50, s50, 524288
  s_cmp_ge_u32 s50, 3670016
  s_cselect_b32 s10, 3670016, 0
  s_sub_u32 s50, s50, s10
  s_add_u32 s63, s63, 524288
  s_sub_u32 s63, s63, s10
  s_waitcnt lgkmcnt(0) vmcnt(8)
  s_barrier
  v_mfma_f32_16x16x32_bf16 v[240:243], v[28:31], v[60:63], v[240:243]
  v_mfma_f32_16x16x32_bf16 v[244:247], v[28:31], v[64:67], v[244:247]
  v_mfma_f32_16x16x32_bf16 v[248:251], v[28:31], v[68:71], v[248:251]
  v_mfma_f32_16x16x32_bf16 v[252:255], v[28:31], v[72:75], v[252:255]
  v_mfma_f32_16x16x32_bf16 v[144:147], v[32:35], v[76:79], v[144:147]
  v_mfma_f32_16x16x32_bf16 v[148:151], v[32:35], v[80:83], v[148:151]
  v_mfma_f32_16x16x32_bf16 v[152:155], v[32:35], v[84:87], v[152:155]
  v_mfma_f32_16x16x32_bf16 v[156:159], v[32:35], v[88:91], v[156:159]
  v_mfma_f32_16x16x32_bf16 v[160:163], v[32:35], v[92:95], v[160:163]
  v_mfma_f32_16x16x32_bf16 v[164:167], v[32:35], v[96:99], v[164:167]
  ds_read_b128 v[48:51], v108 offset:0
  v_mfma_f32_16x16x32_bf16 v[168:171], v[32:35], v[100:103], v[168:171]
  ds_read_b128 v[52:55], v108 offset:2048
  v_mfma_f32_16x16x32_bf16 v[172:175], v[36:39], v[76:79], v[172:175]
  ds_read_b128 v[56:59], v108 offset:4096
  v_mfma_f32_16x16x32_bf16 v[176:179], v[36:39], v[80:83], v[176:179]
  ds_read_b128 v[60:63], v108 offset:6144
  v_mfma_f32_16x16x32_bf16 v[180:183], v[36:39], v[84:87], v[180:183]
  s_add_u32 m0, s14, 16384
  s_add_u32 s10, s14, 184320
  buffer_load_dwordx4 v10, s[20:23], s10 offen offset:0 nt lds
  s_add_u32 s10, s14, 183424
  buffer_load_dwordx4 v10, s[20:23], s10 offen offset:1024 nt lds
  s_add_u32 s10, s14, 182528
  buffer_load_dwordx4 v10, s[20:23], s10 offen offset:2048 nt lds
  s_add_u32 s10, s14, 181632
  buffer_load_dwordx4 v10, s[20:23], s10 offen offset:3072 nt lds
  ds_read_b128 v[64:67], v108 offset:8192
  s_waitcnt lgkmcnt(0) vmcnt(5)
  s_barrier
  v_mfma_f32_16x16x32_bf16 v[184:187], v[36:39], v[88:91], v[184:187]
  ds_read_b128 v[68:71], v108 offset:10240
  v_mfma_f32_16x16x32_bf16 v[188:191], v[36:39], v[92:95], v[188:191]
  ds_read_b128 v[72:75], v108 offset:12288
  v_mfma_f32_16x16x32_bf16 v[192:195], v[36:39], v[96:99], v[192:195]
  ds_read_b64_tr_b16 v[16:17], v1 offset:4096
  v_mfma_f32_16x16x32_bf16 v[196:199], v[36:39], v[100:103], v[196:199]
  ds_read_b64_tr_b16 v[18:19], v1 offset:5120
  v_mfma_f32_16x16x32_bf16 v[200:203], v[40:43], v[76:79], v[200:203]
  ds_read_b64_tr_b16 v[20:21], v2 offset:4096
  v_mfma_f32_16x16x32_bf16 v[204:207], v[40:43], v[80:83], v[204:207]
  ds_read_b64_tr_b16 v[22:23], v2 offset:5120
  v_mfma_f32_16x16x32_bf16 v[208:211], v[40:43], v[84:87], v[208:211]
  ds_read_b64_tr_b16 v[24:25], v3 offset:4096
  v_mfma_f32_16x16x32_bf16 v[212:215], v[40:43], v[88:91], v[212:215]
  ds_read_b64_tr_b16 v[26:27], v3 offset:5120
  v_mfma_f32_16x16x32_bf16 v[216:219], v[40:43], v[92:95], v[216:219]
  ds_read_b64_tr_b16 v[28:29], v4 offset:4096
  v_mfma_f32_16x16x32_bf16 v[220:223], v[40:43], v[96:99], v[220:223]
  ds_read_b64_tr_b16 v[30:31], v4 offset:5120
  v_mfma_f32_16x16x32_bf16 v[224:227], v[40:43], v[100:103], v[224:227]
  s_add_u32 m0, s48, 0
  s_add_u32 s10, s50, 512
  buffer_load_dwordx4 v5, s[32:35], s10 offen offset:0 lds
  v_mfma_f32_16x16x32_bf16 v[228:231], v[44:47], v[76:79], v[228:231]
  s_add_u32 m0, s48, 0
  s_add_u32 s10, s50, 32256
  buffer_load_dwordx4 v5, s[32:35], s10 offen offset:1024 lds
  v_mfma_f32_16x16x32_bf16 v[232:235], v[44:47], v[80:83], v[232:235]
  s_add_u32 m0, s14, 32768
  s_add_u32 s10, s14, 200704
  buffer_load_dwordx4 v10, s[20:23], s10 offen offset:0 nt lds
  s_add_u32 s10, s14, 199808
  buffer_load_dwordx4 v10, s[20:23], s10 offen offset:1024 nt lds
  s_add_u32 s10, s14, 198912
  buffer_load_dwordx4 v10, s[20:23], s10 offen offset:2048 nt lds
  s_add_u32 s10, s14, 198016
  buffer_load_dwordx4 v10, s[20:23], s10 offen offset:3072 nt lds
  s_add_u32 m0, s48, 0
  s_add_u32 s10, s50, 129536
  buffer_load_dwordx4 v5, s[32:35], s10 offen offset:2048 lds
  s_waitcnt lgkmcnt(0) vmcnt(7)
  s_barrier
  v_mfma_f32_16x16x32_bf16 v[236:239], v[44:47], v[84:87], v[236:239]
  s_add_u32 m0, s48, 0
  s_add_u32 s10, s50, 161280
  buffer_load_dwordx4 v5, s[32:35], s10 offen offset:3072 lds
  v_mfma_f32_16x16x32_bf16 v[240:243], v[44:47], v[88:91], v[240:243]
  s_add_u32 m0, s49, 16384
  s_nop 0
  buffer_load_dwordx4 v104, s[28:31], s64 offen offset:0 lds
  v_mfma_f32_16x16x32_bf16 v[244:247], v[44:47], v[92:95], v[244:247]
  s_add_u32 m0, s49, 16384
  s_nop 0
  buffer_load_dwordx4 v105, s[28:31], s64 offen offset:1024 lds
  v_mfma_f32_16x16x32_bf16 v[248:251], v[44:47], v[96:99], v[248:251]
  s_add_u32 m0, s49, 16384
  s_nop 0
  buffer_load_dwordx4 v106, s[28:31], s64 offen offset:2048 lds
  v_mfma_f32_16x16x32_bf16 v[252:255], v[44:47], v[100:103], v[252:255]
  s_add_u32 m0, s49, 16384
  s_nop 0
  buffer_load_dwordx4 v107, s[28:31], s64 offen offset:3072 lds
  s_add_u32 s64, s64, 128
  s_cmp_eq_u32 s64, 896
  s_cselect_b32 s64, 0, s64
  v_mfma_f32_16x16x32_bf16 v[144:147], v[16:19], v[48:51], v[144:147]
  v_mfma_f32_16x16x32_bf16 v[148:151], v[16:19], v[52:55], v[148:151]
  v_mfma_f32_16x16x32_bf16 v[152:155], v[16:19], v[56:59], v[152:155]
  v_mfma_f32_16x16x32_bf16 v[156:159], v[16:19], v[60:63], v[156:159]
  v_mfma_f32_16x16x32_bf16 v[160:163], v[16:19], v[64:67], v[160:163]
  v_mfma_f32_16x16x32_bf16 v[164:167], v[16:19], v[68:71], v[164:167]
  ds_read_b128 v[76:79], v109 offset:0
  v_mfma_f32_16x16x32_bf16 v[168:171], v[16:19], v[72:75], v[168:171]
  ds_read_b128 v[80:83], v109 offset:2048
  v_mfma_f32_16x16x32_bf16 v[172:175], v[20:23], v[48:51], v[172:175]
  s_add_u32 m0, s14, 49152
  s_add_u32 s10, s14, 217088
  buffer_load_dwordx4 v10, s[20:23], s10 offen offset:0 nt lds
  s_add_u32 s10, s14, 216192
  buffer_load_dwordx4 v10, s[20:23], s10 offen offset:1024 nt lds
  s_add_u32 s10, s14, 215296
  buffer_load_dwordx4 v10, s[20:23], s10 offen offset:2048 nt lds
  s_add_u32 s10, s14, 214400
  buffer_load_dwordx4 v10, s[20:23], s10 offen offset:3072 nt lds
  ds_read_b128 v[84:87], v109 offset:4096
  s_waitcnt lgkmcnt(0) vmcnt(10)
  s_barrier
  v_mfma_f32_16x16x32_bf16 v[176:179], v[20:23], v[52:55], v[176:179]
  ds_read_b128 v[88:91], v109 offset:6144
  v_mfma_f32_16x16x32_bf16 v[180:183], v[20:23], v[56:59], v[180:183]
  ds_read_b128 v[92:95], v109 offset:8192
  v_mfma_f32_16x16x32_bf16 v[184:187], v[20:23], v[60:63], v[184:187]
  ds_read_b128 v[96:99], v109 offset:10240
  v_mfma_f32_16x16x32_bf16 v[188:191], v[20:23], v[64:67], v[188:191]
  ds_read_b128 v[100:103], v109 offset:12288
  v_mfma_f32_16x16x32_bf16 v[192:195], v[20:23], v[68:71], v[192:195]
  ds_read_b64_tr_b16 v[32:33], v1 offset:8192
  v_mfma_f32_16x16x32_bf16 v[196:199], v[20:23], v[72:75], v[196:199]
  ds_read_b64_tr_b16 v[34:35], v1 offset:9216
  v_mfma_f32_16x16x32_bf16 v[200:203], v[24:27], v[48:51], v[200:203]
  ds_read_b64_tr_b16 v[36:37], v2 offset:8192
  v_mfma_f32_16x16x32_bf16 v[204:207], v[24:27], v[52:55], v[204:207]
  ds_read_b64_tr_b16 v[38:39], v2 offset:9216
  v_mfma_f32_16x16x32_bf16 v[208:211], v[24:27], v[56:59], v[208:211]
  ds_read_b64_tr_b16 v[40:41], v3 offset:8192
  v_mfma_f32_16x16x32_bf16 v[212:215], v[24:27], v[60:63], v[212:215]
  ds_read_b64_tr_b16 v[42:43], v3 offset:9216
  v_mfma_f32_16x16x32_bf16 v[216:219], v[24:27], v[64:67], v[216:219]
  ds_read_b64_tr_b16 v[44:45], v4 offset:8192
  v_mfma_f32_16x16x32_bf16 v[220:223], v[24:27], v[68:71], v[220:223]
  ds_read_b64_tr_b16 v[46:47], v4 offset:9216
  v_mfma_f32_16x16x32_bf16 v[224:227], v[24:27], v[72:75], v[224:227]
  s_add_u32 m0, s48, 4096
  s_add_u32 s10, s63, 512
  buffer_load_dwordx4 v5, s[32:35], s10 offen offset:0 lds
  v_mfma_f32_16x16x32_bf16 v[228:231], v[28:31], v[48:51], v[228:231]
  s_add_u32 m0, s14, 65536
  s_add_u32 s10, s14, 233472
  buffer_load_dwordx4 v10, s[20:23], s10 offen offset:0 nt lds
  s_add_u32 s10, s14, 232576
  buffer_load_dwordx4 v10, s[20:23], s10 offen offset:1024 nt lds
  s_add_u32 s10, s14, 231680
  buffer_load_dwordx4 v10, s[20:23], s10 offen offset:2048 nt lds
  s_add_u32 s10, s14, 230784
  buffer_load_dwordx4 v10, s[20:23], s10 offen offset:3072 nt lds
  s_add_u32 m0, s48, 4096
  s_add_u32 s10, s63, 32256
  buffer_load_dwordx4 v5, s[32:35], s10 offen offset:1024 lds
  s_waitcnt lgkmcnt(0) vmcnt(6)
  s_barrier
  v_mfma_f32_16x16x32_bf16 v[232:235], v[28:31], v[52:55], v[232:235]
  s_add_u32 m0, s48, 4096
  s_add_u32 s10, s63, 129536
  buffer_load_dwordx4 v5, s[32:35], s10 offen offset:2048 lds
  v_mfma_f32_16x16x32_bf16 v[236:239], v[28:31], v[56:59], v[236:239]
  s_add_u32 m0, s48, 4096
  s_add_u32 s10, s63, 161280
  buffer_load_dwordx4 v5, s[32:35], s10 offen offset:3072 lds
  s_add_u32 s50, s50, 524288
  s_cmp_ge_u32 s50, 3670016
  s_cselect_b32 s10, 3670016, 0
  s_sub_u32 s50, s50, s10
  s_add_u32 s63, s63, 524288
  s_sub_u32 s63, s63, s10
  v_mfma_f32_16x16x32_bf16 v[240:243], v[28:31], v[60:63], v[240:243]
  v_mfma_f32_16x16x32_bf16 v[244:247], v[28:31], v[64:67], v[244:247]
  v_mfma_f32_16x16x32_bf16 v[248:251], v[28:31], v[68:71], v[248:251]
  v_mfma_f32_16x16x32_bf16 v[252:255], v[28:31], v[72:75], v[252:255]
  v_mfma_f32_16x16x32_bf16 v[144:147], v[32:35], v[76:79], v[144:147]
  v_mfma_f32_16x16x32_bf16 v[148:151], v[32:35], v[80:83], v[148:151]
  v_mfma_f32_16x16x32_bf16 v[152:155], v[32:35], v[84:87], v[152:155]
  v_mfma_f32_16x16x32_bf16 v[156:159], v[32:35], v[88:91], v[156:159]
  v_mfma_f32_16x16x32_bf16 v[160:163], v[32:35], v[92:95], v[160:163]
  v_mfma_f32_16x16x32_bf16 v[164:167], v[32:35], v[96:99], v[164:167]
  ds_read_b128 v[48:51], v108 offset:16384
  v_mfma_f32_16x16x32_bf16 v[168:171], v[32:35], v[100:103], v[168:171]
  s_add_u32 m0, s14, 0
  s_add_u32 s10, s14, 249856
  buffer_load_dwordx4 v10, s[20:23], s10 offen offset:0 nt lds
  s_add_u32 s10, s14, 248960
  buffer_load_dwordx4 v10, s[20:23], s10 offen offset:1024 nt lds
  s_add_u32 s10, s14, 248064
  buffer_load_dwordx4 v10, s[20:23], s10 offen offset:2048 nt lds
  s_add_u32 s10, s14, 247168
  buffer_load_dwordx4 v10, s[20:23], s10 offen offset:3072 nt lds
  ds_read_b128 v[52:55], v108 offset:18432
  s_waitcnt lgkmcnt(0) vmcnt(7)
  s_barrier
  v_mfma_f32_16x16x32_bf16 v[172:175], v[36:39], v[76:79], v[172:175]
  ds_read_b128 v[56:59], v108 offset:20480
  v_mfma_f32_16x16x32_bf16 v[176:179], v[36:39], v[80:83], v[176:179]
  ds_read_b128 v[60:63], v108 offset:22528
  v_mfma_f32_16x16x32_bf16 v[180:183], v[36:39], v[84:87], v[180:183]
  ds_read_b128 v[64:67], v108 offset:24576
  v_mfma_f32_16x16x32_bf16 v[184:187], v[36:39], v[88:91], v[184:187]
  ds_read_b128 v[68:71], v108 offset:26624
  v_mfma_f32_16x16x32_bf16 v[188:191], v[36:39], v[92:95], v[188:191]
  ds_read_b128 v[72:75], v108 offset:28672
  v_mfma_f32_16x16x32_bf16 v[192:195], v[36:39], v[96:99], v[192:195]
  ds_read_b64_tr_b16 v[16:17], v1 offset:0
  v_mfma_f32_16x16x32_bf16 v[196:199], v[36:39], v[100:103], v[196:199]
  ds_read_b64_tr_b16 v[18:19], v1 offset:1024
  v_mfma_f32_16x16x32_bf16 v[200:203], v[40:43], v[76:79], v[200:203]
  ds_read_b64_tr_b16 v[20:21], v2 offset:0
  v_mfma_f32_16x16x32_bf16 v[204:207], v[40:43], v[80:83], v[204:207]
  ds_read_b64_tr_b16 v[22:23], v2 offset:1024
  v_mfma_f32_16x16x32_bf16 v[208:211], v[40:43], v[84:87], v[208:211]
  ds_read_b64_tr_b16 v[24:25], v3 offset:0
  v_mfma_f32_16x16x32_bf16 v[212:215], v[40:43], v[88:91], v[212:215]
  ds_read_b64_tr_b16 v[26:27], v3 offset:1024
  v_mfma_f32_16x16x32_bf16 v[216:219], v[40:43], v[92:95], v[216:219]
  ds_read_b64_tr_b16 v[28:29], v4 offset:0
  v_mfma_f32_16x16x32_bf16 v[220:223], v[40:43], v[96:99], v[220:223]
  s_add_u32 m0, s14, 16384
  s_add_u32 s10, s56, 0
  buffer_load_dwordx4 v13, s[24:27], s10 offen offset:0 nt lds
  s_add_u32 s10, s56, 3072
  buffer_load_dwordx4 v13, s[24:27], s10 offen offset:1024 nt lds
  s_add_u32 s10, s56, 6144
  buffer_load_dwordx4 v13, s[24:27], s10 offen offset:2048 nt lds
  s_add_u32 s10, s56, 9216
  buffer_load_dwordx4 v13, s[24:27], s10 offen offset:3072 nt lds
  ds_read_b64_tr_b16 v[30:31], v4 offset:1024
  s_waitcnt lgkmcnt(0) vmcnt(4)
  s_barrier
  v_mfma_f32_16x16x32_bf16 v[224:227], v[40:43], v[100:103], v[224:227]
  s_add_u32 m0, s48, 8192
  s_add_u32 s10, s50, 512
  buffer_load_dwordx4 v5, s[32:35], s10 offen offset:0 lds
  v_mfma_f32_16x16x32_bf16 v[228:231], v[44:47], v[76:79], v[228:231]
  s_add_u32 m0, s48, 8192
  s_add_u32 s10, s50, 32256
  buffer_load_dwordx4 v5, s[32:35], s10 offen offset:1024 lds
  v_mfma_f32_16x16x32_bf16 v[232:235], v[44:47], v[80:83], v[232:235]
  s_add_u32 m0, s48, 8192
  s_add_u32 s10, s50, 129536
  buffer_load_dwordx4 v5, s[32:35], s10 offen offset:2048 lds
  v_mfma_f32_16x16x32_bf16 v[236:239], v[44:47], v[84:87], v[236:239]
  s_add_u32 m0, s48, 8192
  s_add_u32 s10, s50, 161280
  buffer_load_dwordx4 v5, s[32:35], s10 offen offset:3072 lds
  v_mfma_f32_16x16x32_bf16 v[240:243], v[44:47], v[88:91], v[240:243]
  s_add_u32 m0, s49, 0
  s_nop 0
  buffer_load_dwordx4 v104, s[28:31], s64 offen offset:0 lds
  v_mfma_f32_16x16x32_bf16 v[244:247], v[44:47], v[92:95], v[244:247]
  s_add_u32 m0, s49, 0
  s_nop 0
  buffer_load_dwordx4 v105, s[28:31], s64 offen offset:1024 lds
  v_mfma_f32_16x16x32_bf16 v[248:251], v[44:47], v[96:99], v[248:251]
  s_add_u32 m0, s49, 0
  s_nop 0
  buffer_load_dwordx4 v106, s[28:31], s64 offen offset:2048 lds
  v_mfma_f32_16x16x32_bf16 v[252:255], v[44:47], v[100:103], v[252:255]
  s_add_u32 m0, s49, 0
  s_nop 0
  buffer_load_dwordx4 v107, s[28:31], s64 offen offset:3072 lds
  s_add_u32 s64, s64, 128
  s_cmp_eq_u32 s64, 896
  s_cselect_b32 s64, 0, s64
  v_mfma_f32_16x16x32_bf16 v[144:147], v[16:19], v[48:51], v[144:147]
  v_mfma_f32_16x16x32_bf16 v[148:151], v[16:19], v[52:55], v[148:151]
  v_mfma_f32_16x16x32_bf16 v[152:155], v[16:19], v[56:59], v[152:155]
  v_mfma_f32_16x16x32_bf16 v[156:159], v[16:19], v[60:63], v[156:159]
  v_mfma_f32_16x16x32_bf16 v[160:163], v[16:19], v[64:67], v[160:163]
  v_mfma_f32_16x16x32_bf16 v[164:167], v[16:19], v[68:71], v[164:167]
  s_add_u32 m0, s14, 32768
  s_add_u32 s10, s56, 65536
  buffer_load_dwordx4 v13, s[24:27], s10 offen offset:0 nt lds
  s_add_u32 s10, s56, 68608
  buffer_load_dwordx4 v13, s[24:27], s10 offen offset:1024 nt lds
  s_add_u32 s10, s56, 71680
  buffer_load_dwordx4 v13, s[24:27], s10 offen offset:2048 nt lds
  s_add_u32 s10, s56, 74752
  buffer_load_dwordx4 v13, s[24:27], s10 offen offset:3072 nt lds
  ds_read_b128 v[76:79], v109 offset:16384
  s_waitcnt lgkmcnt(0) vmcnt(12)
  s_barrier
  v_mfma_f32_16x16x32_bf16 v[168:171], v[16:19], v[72:75], v[168:171]
  ds_read_b128 v[80:83], v109 offset:18432
  v_mfma_f32_16x16x32_bf16 v[172:175], v[20:23], v[48:51], v[172:175]
  ds_read_b128 v[84:87], v109 offset:20480
  v_mfma_f32_16x16x32_bf16 v[176:179], v[20:23], v[52:55], v[176:179]
  ds_read_b128 v[88:91], v109 offset:22528
  v_mfma_f32_16x16x32_bf16 v[180:183], v[20:23], v[56:59], v[180:183]
  ds_read_b128 v[92:95], v109 offset:24576
  v_mfma_f32_16x16x32_bf16 v[184:187], v[20:23], v[60:63], v[184:187]
  ds_read_b128 v[96:99], v109 offset:26624
  v_mfma_f32_16x16x32_bf16 v[188:191], v[20:23], v[64:67], v[188:191]
  ds_read_b128 v[100:103], v109 offset:28672
  v_mfma_f32_16x16x32_bf16 v[192:195], v[20:23], v[68:71], v[192:195]
  ds_read_b64_tr_b16 v[32:33], v1 offset:4096
  v_mfma_f32_16x16x32_bf16 v[196:199], v[20:23], v[72:75], v[196:199]
  ds_read_b64_tr_b16 v[34:35], v1 offset:5120
  v_mfma_f32_16x16x32_bf16 v[200:203], v[24:27], v[48:51], v[200:203]
  ds_read_b64_tr_b16 v[36:37], v2 offset:4096
  v_mfma_f32_16x16x32_bf16 v[204:207], v[24:27], v[52:55], v[204:207]
  ds_read_b64_tr_b16 v[38:39], v2 offset:5120
  v_mfma_f32_16x16x32_bf16 v[208:211], v[24:27], v[56:59], v[208:211]
  ds_read_b64_tr_b16 v[40:41], v3 offset:4096
  v_mfma_f32_16x16x32_bf16 v[212:215], v[24:27], v[60:63], v[212:215]
  ds_read_b64_tr_b16 v[42:43], v3 offset:5120
  v_mfma_f32_16x16x32_bf16 v[216:219], v[24:27], v[64:67], v[216:219]
  s_add_u32 m0, s14, 49152
  s_add_u32 s10, s56, 131072
  buffer_load_dwordx4 v13, s[24:27], s10 offen offset:0 nt lds
  s_add_u32 s10, s56, 134144
  buffer_load_dwordx4 v13, s[24:27], s10 offen offset:1024 nt lds
  s_add_u32 s10, s56, 137216
  buffer_load_dwordx4 v13, s[24:27], s10 offen offset:2048 nt lds
  s_add_u32 s10, s56, 140288
  buffer_load_dwordx4 v13, s[24:27], s10 offen offset:3072 nt lds
  ds_read_b64_tr_b16 v[44:45], v4 offset:4096
  s_waitcnt lgkmcnt(0) vmcnt(4)
  s_barrier
  v_mfma_f32_16x16x32_bf16 v[220:223], v[24:27], v[68:71], v[220:223]
  ds_read_b64_tr_b16 v[46:47], v4 offset:5120
  v_mfma_f32_16x16x32_bf16 v[224:227], v[24:27], v[72:75], v[224:227]
  s_add_u32 m0, s48, 0
  s_add_u32 s10, s63, 512
  buffer_load_dwordx4 v5, s[32:35], s10 offen offset:0 lds
  v_mfma_f32_16x16x32_bf16 v[228:231], v[28:31], v[48:51], v[228:231]
  s_add_u32 m0, s48, 0
  s_add_u32 s10, s63, 32256
  buffer_load_dwordx4 v5, s[32:35], s10 offen offset:1024 lds
  v_mfma_f32_16x16x32_bf16 v[232:235], v[28:31], v[52:55], v[232:235]
  s_add_u32 m0, s48, 0
  s_add_u32 s10, s63, 129536
  buffer_load_dwordx4 v5, s[32:35], s10 offen offset:2048 lds
  v_mfma_f32_16x16x32_bf16 v[236:239], v[28:31], v[56:59], v[236:239]
  s_add_u32 m0, s48, 0
  s_add_u32 s10, s63, 161280
  buffer_load_dwordx4 v5, s[32:35], s10 offen offset:3072 lds
  s_add_u32 s50, s50, 524288
  s_cmp_ge_u32 s50, 3670016
  s_cselect_b32 s10, 3670016, 0
  s_sub_u32 s50, s50, s10
  s_add_u32 s63, s63, 524288
  s_sub_u32 s63, s63, s10
  v_mfma_f32_16x16x32_bf16 v[240:243], v[28:31], v[60:63], v[240:243]
  v_mfma_f32_16x16x32_bf16 v[244:247], v[28:31], v[64:67], v[244:247]
  v_mfma_f32_16x16x32_bf16 v[248:251], v[28:31], v[68:71], v[248:251]
  v_mfma_f32_16x16x32_bf16 v[252:255], v[28:31], v[72:75], v[252:255]
  s_waitcnt lgkmcnt(0)
  v_mfma_f32_16x16x32_bf16 v[144:147], v[32:35], v[76:79], v[144:147]
  v_mfma_f32_16x16x32_bf16 v[148:151], v[32:35], v[80:83], v[148:151]
  v_mfma_f32_16x16x32_bf16 v[152:155], v[32:35], v[84:87], v[152:155]
  v_mfma_f32_16x16x32_bf16 v[156:159], v[32:35], v[88:91], v[156:159]
  s_add_u32 m0, s14, 65536
  s_add_u32 s10, s56, 196608
  buffer_load_dwordx4 v13, s[24:27], s10 offen offset:0 nt lds
  s_add_u32 s10, s56, 199680
  buffer_load_dwordx4 v13, s[24:27], s10 offen offset:1024 nt lds
  s_add_u32 s10, s56, 202752
  buffer_load_dwordx4 v13, s[24:27], s10 offen offset:2048 nt lds
  s_add_u32 s10, s56, 205824
  buffer_load_dwordx4 v13, s[24:27], s10 offen offset:3072 nt lds
  s_waitcnt lgkmcnt(0) vmcnt(8)
  s_barrier
  v_mfma_f32_16x16x32_bf16 v[160:163], v[32:35], v[92:95], v[160:163]
  v_mfma_f32_16x16x32_bf16 v[164:167], v[32:35], v[96:99], v[164:167]
  ds_read_b128 v[48:51], v108 offset:0
  v_mfma_f32_16x16x32_bf16 v[168:171], v[32:35], v[100:103], v[168:171]
  ds_read_b128 v[52:55], v108 offset:2048
  v_mfma_f32_16x16x32_bf16 v[172:175], v[36:39], v[76:79], v[172:175]
  ds_read_b128 v[56:59], v108 offset:4096
  v_mfma_f32_16x16x32_bf16 v[176:179], v[36:39], v[80:83], v[176:179]
  ds_read_b128 v[60:63], v108 offset:6144
  v_mfma_f32_16x16x32_bf16 v[180:183], v[36:39], v[84:87], v[180:183]
  ds_read_b128 v[64:67], v108 offset:8192
  v_mfma_f32_16x16x32_bf16 v[184:187], v[36:39], v[88:91], v[184:187]
  ds_read_b128 v[68:71], v108 offset:10240
  v_mfma_f32_16x16x32_bf16 v[188:191], v[36:39], v[92:95], v[188:191]
  ds_read_b128 v[72:75], v108 offset:12288
  v_mfma_f32_16x16x32_bf16 v[192:195], v[36:39], v[96:99], v[192:195]
  ds_read_b64_tr_b16 v[16:17], v1 offset:8192
  v_mfma_f32_16x16x32_bf16 v[196:199], v[36:39], v[100:103], v[196:199]
  ds_read_b64_tr_b16 v[18:19], v1 offset:9216
  v_mfma_f32_16x16x32_bf16 v[200:203], v[40:43], v[76:79], v[200:203]
  ds_read_b64_tr_b16 v[20:21], v2 offset:8192
  v_mfma_f32_16x16x32_bf16 v[204:207], v[40:43], v[80:83], v[204:207]
  ds_read_b64_tr_b16 v[22:23], v2 offset:9216
  v_mfma_f32_16x16x32_bf16 v[208:211], v[40:43], v[84:87], v[208:211]
  ds_read_b64_tr_b16 v[24:25], v3 offset:8192
  v_mfma_f32_16x16x32_bf16 v[212:215], v[40:43], v[88:91], v[212:215]
  s_add_u32 m0, s14, 0
  s_add_u32 s10, s57, 0
  buffer_load_dwordx4 v13, s[24:27], s10 offen offset:0 nt lds
  s_add_u32 s10, s57, 3072
  buffer_load_dwordx4 v13, s[24:27], s10 offen offset:1024 nt lds
  s_add_u32 s10, s57, 6144
  buffer_load_dwordx4 v13, s[24:27], s10 offen offset:2048 nt lds
  s_add_u32 s10, s57, 9216
  buffer_load_dwordx4 v13, s[24:27], s10 offen offset:3072 nt lds
  ds_read_b64_tr_b16 v[26:27], v3 offset:9216
  s_waitcnt lgkmcnt(0) vmcnt(4)
  s_barrier
  v_mfma_f32_16x16x32_bf16 v[216:219], v[40:43], v[92:95], v[216:219]
  ds_read_b64_tr_b16 v[28:29], v4 offset:8192
  v_mfma_f32_16x16x32_bf16 v[220:223], v[40:43], v[96:99], v[220:223]
  ds_read_b64_tr_b16 v[30:31], v4 offset:9216
  v_mfma_f32_16x16x32_bf16 v[224:227], v[40:43], v[100:103], v[224:227]
  s_add_u32 m0, s48, 4096
  s_add_u32 s10, s50, 512
  buffer_load_dwordx4 v5, s[32:35], s10 offen offset:0 lds
  v_mfma_f32_16x16x32_bf16 v[228:231], v[44:47], v[76:79], v[228:231]
  s_add_u32 m0, s48, 4096
  s_add_u32 s10, s50, 32256
  buffer_load_dwordx4 v5, s[32:35], s10 offen offset:1024 lds
  v_mfma_f32_16x16x32_bf16 v[232:235], v[44:47], v[80:83], v[232:235]
  s_add_u32 m0, s48, 4096
  s_add_u32 s10, s50, 129536
  buffer_load_dwordx4 v5, s[32:35], s10 offen offset:2048 lds
  v_mfma_f32_16x16x32_bf16 v[236:239], v[44:47], v[84:87], v[236:239]
  s_add_u32 m0, s48, 4096
  s_add_u32 s10, s50, 161280
  buffer_load_dwordx4 v5, s[32:35], s10 offen offset:3072 lds
  v_mfma_f32_16x16x32_bf16 v[240:243], v[44:47], v[88:91], v[240:243]
  s_add_u32 m0, s49, 16384
  s_nop 0
  buffer_load_dwordx4 v104, s[28:31], s64 offen offset:0 lds
  v_mfma_f32_16x16x32_bf16 v[244:247], v[44:47], v[92:95], v[244:247]
  s_add_u32 m0, s49, 16384
  s_nop 0
  buffer_load_dwordx4 v105, s[28:31], s64 offen offset:1024 lds
  v_mfma_f32_16x16x32_bf16 v[248:251], v[44:47], v[96:99], v[248:251]
  s_add_u32 m0, s49, 16384
  s_nop 0
  buffer_load_dwordx4 v106, s[28:31], s64 offen offset:2048 lds
  v_mfma_f32_16x16x32_bf16 v[252:255], v[44:47], v[100:103], v[252:255]
  s_add_u32 m0, s49, 16384
  s_nop 0
  buffer_load_dwordx4 v107, s[28:31], s64 offen offset:3072 lds
  s_add_u32 s64, s64, 128
  s_cmp_eq_u32 s64, 896
  s_cselect_b32 s64, 0, s64
  s_waitcnt lgkmcnt(0)
  v_mfma_f32_16x16x32_bf16 v[144:147], v[16:19], v[48:51], v[144:147]
  v_mfma_f32_16x16x32_bf16 v[148:151], v[16:19], v[52:55], v[148:151]
  v_mfma_f32_16x16x32_bf16 v[152:155], v[16:19], v[56:59], v[152:155]
  s_add_u32 m0, s14, 16384
  s_add_u32 s10, s57, 65536
  buffer_load_dwordx4 v13, s[24:27], s10 offen offset:0 nt lds
  s_add_u32 s10, s57, 68608
  buffer_load_dwordx4 v13, s[24:27], s10 offen offset:1024 nt lds
  s_add_u32 s10, s57, 71680
  buffer_load_dwordx4 v13, s[24:27], s10 offen offset:2048 nt lds
  s_add_u32 s10, s57, 74752
  buffer_load_dwordx4 v13, s[24:27], s10 offen offset:3072 nt lds
  s_waitcnt lgkmcnt(0) vmcnt(12)
  s_barrier
  v_mfma_f32_16x16x32_bf16 v[156:159], v[16:19], v[60:63], v[156:159]
  v_mfma_f32_16x16x32_bf16 v[160:163], v[16:19], v[64:67], v[160:163]
  v_mfma_f32_16x16x32_bf16 v[164:167], v[16:19], v[68:71], v[164:167]
  ds_read_b128 v[76:79], v109 offset:0
  v_mfma_f32_16x16x32_bf16 v[168:171], v[16:19], v[72:75], v[168:171]
  ds_read_b128 v[80:83], v109 offset:2048
  v_mfma_f32_16x16x32_bf16 v[172:175], v[20:23], v[48:51], v[172:175]
  ds_read_b128 v[84:87], v109 offset:4096
  v_mfma_f32_16x16x32_bf16 v[176:179], v[20:23], v[52:55], v[176:179]
  ds_read_b128 v[88:91], v109 offset:6144
  v_mfma_f32_16x16x32_bf16 v[180:183], v[20:23], v[56:59], v[180:183]
  ds_read_b128 v[92:95], v109 offset:8192
  v_mfma_f32_16x16x32_bf16 v[184:187], v[20:23], v[60:63], v[184:187]
  ds_read_b128 v[96:99], v109 offset:10240
  v_mfma_f32_16x16x32_bf16 v[188:191], v[20:23], v[64:67], v[188:191]
  ds_read_b128 v[100:103], v109 offset:12288
  v_mfma_f32_16x16x32_bf16 v[192:195], v[20:23], v[68:71], v[192:195]
  ds_read_b64_tr_b16 v[32:33], v1 offset:0
  v_mfma_f32_16x16x32_bf16 v[196:199], v[20:23], v[72:75], v[196:199]
  ds_read_b64_tr_b16 v[34:35], v1 offset:1024
  v_mfma_f32_16x16x32_bf16 v[200:203], v[24:27], v[48:51], v[200:203]
  ds_read_b64_tr_b16 v[36:37], v2 offset:0
  v_mfma_f32_16x16x32_bf16 v[204:207], v[24:27], v[52:55], v[204:207]
  s_add_u32 m0, s14, 32768
  s_add_u32 s10, s57, 131072
  buffer_load_dwordx4 v13, s[24:27], s10 offen offset:0 nt lds
  s_add_u32 s10, s57, 134144
  buffer_load_dwordx4 v13, s[24:27], s10 offen offset:1024 nt lds
  s_add_u32 s10, s57, 137216
  buffer_load_dwordx4 v13, s[24:27], s10 offen offset:2048 nt lds
  s_add_u32 s10, s57, 140288
  buffer_load_dwordx4 v13, s[24:27], s10 offen offset:3072 nt lds
  ds_read_b64_tr_b16 v[38:39], v2 offset:1024
  s_waitcnt lgkmcnt(0) vmcnt(4)
  s_barrier
  v_mfma_f32_16x16x32_bf16 v[208:211], v[24:27], v[56:59], v[208:211]
  ds_read_b64_tr_b16 v[40:41], v3 offset:0
  v_mfma_f32_16x16x32_bf16 v[212:215], v[24:27], v[60:63], v[212:215]
  ds_read_b64_tr_b16 v[42:43], v3 offset:1024
  v_mfma_f32_16x16x32_bf16 v[216:219], v[24:27], v[64:67], v[216:219]
  ds_read_b64_tr_b16 v[44:45], v4 offset:0
  v_mfma_f32_16x16x32_bf16 v[220:223], v[24:27], v[68:71], v[220:223]
  ds_read_b64_tr_b16 v[46:47], v4 offset:1024
  v_mfma_f32_16x16x32_bf16 v[224:227], v[24:27], v[72:75], v[224:227]
  s_add_u32 m0, s48, 8192
  s_add_u32 s10, s63, 512
  buffer_load_dwordx4 v5, s[32:35], s10 offen offset:0 lds
  v_mfma_f32_16x16x32_bf16 v[228:231], v[28:31], v[48:51], v[228:231]
  s_add_u32 m0, s48, 8192
  s_add_u32 s10, s63, 32256
  buffer_load_dwordx4 v5, s[32:35], s10 offen offset:1024 lds
  v_mfma_f32_16x16x32_bf16 v[232:235], v[28:31], v[52:55], v[232:235]
  s_add_u32 m0, s48, 8192
  s_add_u32 s10, s63, 129536
  buffer_load_dwordx4 v5, s[32:35], s10 offen offset:2048 lds
  v_mfma_f32_16x16x32_bf16 v[236:239], v[28:31], v[56:59], v[236:239]
  s_add_u32 m0, s48, 8192
  s_add_u32 s10, s63, 161280
  buffer_load_dwordx4 v5, s[32:35], s10 offen offset:3072 lds
  s_add_u32 s50, s50, 524288
  s_cmp_ge_u32 s50, 3670016
  s_cselect_b32 s10, 3670016, 0
  s_sub_u32 s50, s50, s10
  s_add_u32 s63, s63, 524288
  s_sub_u32 s63, s63, s10
  v_mfma_f32_16x16x32_bf16 v[240:243], v[28:31], v[60:63], v[240:243]
  v_mfma_f32_16x16x32_bf16 v[244:247], v[28:31], v[64:67], v[244:247]
  v_mfma_f32_16x16x32_bf16 v[248:251], v[28:31], v[68:71], v[248:251]
  v_mfma_f32_16x16x32_bf16 v[252:255], v[28:31], v[72:75], v[252:255]
  s_waitcnt lgkmcnt(0)
  v_mfma_f32_16x16x32_bf16 v[144:147], v[32:35], v[76:79], v[144:147]
  v_mfma_f32_16x16x32_bf16 v[148:151], v[32:35], v[80:83], v[148:151]
  s_add_u32 m0, s14, 49152
  s_add_u32 s10, s57, 196608
  buffer_load_dwordx4 v13, s[24:27], s10 offen offset:0 nt lds
  s_add_u32 s10, s57, 199680
  buffer_load_dwordx4 v13, s[24:27], s10 offen offset:1024 nt lds
  s_add_u32 s10, s57, 202752
  buffer_load_dwordx4 v13, s[24:27], s10 offen offset:2048 nt lds
  s_add_u32 s10, s57, 205824
  buffer_load_dwordx4 v13, s[24:27], s10 offen offset:3072 nt lds
  s_waitcnt lgkmcnt(0) vmcnt(8)
  s_barrier
  v_mfma_f32_16x16x32_bf16 v[152:155], v[32:35], v[84:87], v[152:155]
  v_mfma_f32_16x16x32_bf16 v[156:159], v[32:35], v[88:91], v[156:159]
  v_mfma_f32_16x16x32_bf16 v[160:163], v[32:35], v[92:95], v[160:163]
  v_mfma_f32_16x16x32_bf16 v[164:167], v[32:35], v[96:99], v[164:167]
  ds_read_b128 v[48:51], v108 offset:16384
  v_mfma_f32_16x16x32_bf16 v[168:171], v[32:35], v[100:103], v[168:171]
  ds_read_b128 v[52:55], v108 offset:18432
  v_mfma_f32_16x16x32_bf16 v[172:175], v[36:39], v[76:79], v[172:175]
  ds_read_b128 v[56:59], v108 offset:20480
  v_mfma_f32_16x16x32_bf16 v[176:179], v[36:39], v[80:83], v[176:179]
  ds_read_b128 v[60:63], v108 offset:22528
  v_mfma_f32_16x16x32_bf16 v[180:183], v[36:39], v[84:87], v[180:183]
  ds_read_b128 v[64:67], v108 offset:24576
  v_mfma_f32_16x16x32_bf16 v[184:187], v[36:39], v[88:91], v[184:187]
  ds_read_b128 v[68:71], v108 offset:26624
  v_mfma_f32_16x16x32_bf16 v[188:191], v[36:39], v[92:95], v[188:191]
  ds_read_b128 v[72:75], v108 offset:28672
  v_mfma_f32_16x16x32_bf16 v[192:195], v[36:39], v[96:99], v[192:195]
  ds_read_b64_tr_b16 v[16:17], v1 offset:4096
  v_mfma_f32_16x16x32_bf16 v[196:199], v[36:39], v[100:103], v[196:199]
  ds_read_b64_tr_b16 v[18:19], v1 offset:5120
  v_mfma_f32_16x16x32_bf16 v[200:203], v[40:43], v[76:79], v[200:203]
  s_add_u32 m0, s14, 65536
  s_add_u32 s10, s58, 0
  buffer_load_dwordx4 v13, s[24:27], s10 offen offset:0 nt lds
  s_add_u32 s10, s58, 3072
  buffer_load_dwordx4 v13, s[24:27], s10 offen offset:1024 nt lds
  s_add_u32 s10, s58, 6144
  buffer_load_dwordx4 v13, s[24:27], s10 offen offset:2048 nt lds
  s_add_u32 s10, s58, 9216
  buffer_load_dwordx4 v13, s[24:27], s10 offen offset:3072 nt lds
  ds_read_b64_tr_b16 v[20:21], v2 offset:4096
  s_waitcnt lgkmcnt(0) vmcnt(4)
  s_barrier
  v_mfma_f32_16x16x32_bf16 v[204:207], v[40:43], v[80:83], v[204:207]
  ds_read_b64_tr_b16 v[22:23], v2 offset:5120
  v_mfma_f32_16x16x32_bf16 v[208:211], v[40:43], v[84:87], v[208:211]
  ds_read_b64_tr_b16 v[24:25], v3 offset:4096
  v_mfma_f32_16x16x32_bf16 v[212:215], v[40:43], v[88:91], v[212:215]
  ds_read_b64_tr_b16 v[26:27], v3 offset:5120
  v_mfma_f32_16x16x32_bf16 v[216:219], v[40:43], v[92:95], v[216:219]
  ds_read_b64_tr_b16 v[28:29], v4 offset:4096
  v_mfma_f32_16x16x32_bf16 v[220:223], v[40:43], v[96:99], v[220:223]
  ds_read_b64_tr_b16 v[30:31], v4 offset:5120
  v_mfma_f32_16x16x32_bf16 v[224:227], v[40:43], v[100:103], v[224:227]
  s_add_u32 m0, s48, 0
  s_add_u32 s10, s50, 512
  buffer_load_dwordx4 v5, s[32:35], s10 offen offset:0 lds
  v_mfma_f32_16x16x32_bf16 v[228:231], v[44:47], v[76:79], v[228:231]
  s_add_u32 m0, s48, 0
  s_add_u32 s10, s50, 32256
  buffer_load_dwordx4 v5, s[32:35], s10 offen offset:1024 lds
  v_mfma_f32_16x16x32_bf16 v[232:235], v[44:47], v[80:83], v[232:235]
  s_add_u32 m0, s48, 0
  s_add_u32 s10, s50, 129536
  buffer_load_dwordx4 v5, s[32:35], s10 offen offset:2048 lds
  v_mfma_f32_16x16x32_bf16 v[236:239], v[44:47], v[84:87], v[236:239]
  s_add_u32 m0, s48, 0
  s_add_u32 s10, s50, 161280
  buffer_load_dwordx4 v5, s[32:35], s10 offen offset:3072 lds
  v_mfma_f32_16x16x32_bf16 v[240:243], v[44:47], v[88:91], v[240:243]
  s_add_u32 m0, s49, 0
  s_nop 0
  buffer_load_dwordx4 v104, s[28:31], s64 offen offset:0 lds
  v_mfma_f32_16x16x32_bf16 v[244:247], v[44:47], v[92:95], v[244:247]
  s_add_u32 m0, s49, 0
  s_nop 0
  buffer_load_dwordx4 v105, s[28:31], s64 offen offset:1024 lds
  v_mfma_f32_16x16x32_bf16 v[248:251], v[44:47], v[96:99], v[248:251]
  s_add_u32 m0, s49, 0
  s_nop 0
  buffer_load_dwordx4 v106, s[28:31], s64 offen offset:2048 lds
  v_mfma_f32_16x16x32_bf16 v[252:255], v[44:47], v[100:103], v[252:255]
  s_add_u32 m0, s14, 0
  s_add_u32 s10, s58, 65536
  buffer_load_dwordx4 v13, s[24:27], s10 offen offset:0 nt lds
  s_add_u32 s10, s58, 68608
  buffer_load_dwordx4 v13, s[24:27], s10 offen offset:1024 nt lds
  s_add_u32 s10, s58, 71680
  buffer_load_dwordx4 v13, s[24:27], s10 offen offset:2048 nt lds
  s_add_u32 s10, s58, 74752
  buffer_load_dwordx4 v13, s[24:27], s10 offen offset:3072 nt lds
  s_add_u32 m0, s49, 0
  s_nop 0
  buffer_load_dwordx4 v107, s[28:31], s64 offen offset:3072 lds
  s_add_u32 s64, s64, 128
  s_cmp_eq_u32 s64, 896
  s_cselect_b32 s64, 0, s64
  s_waitcnt lgkmcnt(0) vmcnt(12)
  s_barrier
  v_mfma_f32_16x16x32_bf16 v[144:147], v[16:19], v[48:51], v[144:147]
  v_mfma_f32_16x16x32_bf16 v[148:151], v[16:19], v[52:55], v[148:151]
  v_mfma_f32_16x16x32_bf16 v[152:155], v[16:19], v[56:59], v[152:155]
  v_mfma_f32_16x16x32_bf16 v[156:159], v[16:19], v[60:63], v[156:159]
  v_mfma_f32_16x16x32_bf16 v[160:163], v[16:19], v[64:67], v[160:163]
  v_mfma_f32_16x16x32_bf16 v[164:167], v[16:19], v[68:71], v[164:167]
  ds_read_b128 v[76:79], v109 offset:16384
  v_mfma_f32_16x16x32_bf16 v[168:171], v[16:19], v[72:75], v[168:171]
  ds_read_b128 v[80:83], v109 offset:18432
  v_mfma_f32_16x16x32_bf16 v[172:175], v[20:23], v[48:51], v[172:175]
  ds_read_b128 v[84:87], v109 offset:20480
  v_mfma_f32_16x16x32_bf16 v[176:179], v[20:23], v[52:55], v[176:179]
  ds_read_b128 v[88:91], v109 offset:22528
  v_mfma_f32_16x16x32_bf16 v[180:183], v[20:23], v[56:59], v[180:183]
  ds_read_b128 v[92:95], v109 offset:24576
  v_mfma_f32_16x16x32_bf16 v[184:187], v[20:23], v[60:63], v[184:187]
  ds_read_b128 v[96:99], v109 offset:26624
  v_mfma_f32_16x16x32_bf16 v[188:191], v[20:23], v[64:67], v[188:191]
  ds_read_b128 v[100:103], v109 offset:28672
  v_mfma_f32_16x16x32_bf16 v[192:195], v[20:23], v[68:71], v[192:195]
  ds_read_b64_tr_b16 v[32:33], v1 offset:8192
  v_mfma_f32_16x16x32_bf16 v[196:199], v[20:23], v[72:75], v[196:199]
  s_add_u32 m0, s14, 16384
  s_add_u32 s10, s58, 131072
  buffer_load_dwordx4 v13, s[24:27], s10 offen offset:0 nt lds
  s_add_u32 s10, s58, 134144
  buffer_load_dwordx4 v13, s[24:27], s10 offen offset:1024 nt lds
  s_add_u32 s10, s58, 137216
  buffer_load_dwordx4 v13, s[24:27], s10 offen offset:2048 nt lds
  s_add_u32 s10, s58, 140288
  buffer_load_dwordx4 v13, s[24:27], s10 offen offset:3072 nt lds
  ds_read_b64_tr_b16 v[34:35], v1 offset:9216
  s_waitcnt lgkmcnt(0) vmcnt(5)
  s_barrier
  v_mfma_f32_16x16x32_bf16 v[200:203], v[24:27], v[48:51], v[200:203]
  ds_read_b64_tr_b16 v[36:37], v2 offset:8192
  v_mfma_f32_16x16x32_bf16 v[204:207], v[24:27], v[52:55], v[204:207]
  ds_read_b64_tr_b16 v[38:39], v2 offset:9216
  v_mfma_f32_16x16x32_bf16 v[208:211], v[24:27], v[56:59], v[208:211]
  ds_read_b64_tr_b16 v[40:41], v3 offset:8192
  v_mfma_f32_16x16x32_bf16 v[212:215], v[24:27], v[60:63], v[212:215]
  ds_read_b64_tr_b16 v[42:43], v3 offset:9216
  v_mfma_f32_16x16x32_bf16 v[216:219], v[24:27], v[64:67], v[216:219]
  ds_read_b64_tr_b16 v[44:45], v4 offset:8192
  v_mfma_f32_16x16x32_bf16 v[220:223], v[24:27], v[68:71], v[220:223]
  ds_read_b64_tr_b16 v[46:47], v4 offset:9216
  v_mfma_f32_16x16x32_bf16 v[224:227], v[24:27], v[72:75], v[224:227]
  s_add_u32 m0, s48, 4096
  s_add_u32 s10, s63, 512
  buffer_load_dwordx4 v5, s[32:35], s10 offen offset:0 lds
  v_mfma_f32_16x16x32_bf16 v[228:231], v[28:31], v[48:51], v[228:231]
  s_add_u32 m0, s48, 4096
  s_add_u32 s10, s63, 32256
  buffer_load_dwordx4 v5, s[32:35], s10 offen offset:1024 lds
  v_mfma_f32_16x16x32_bf16 v[232:235], v[28:31], v[52:55], v[232:235]
  s_add_u32 m0, s48, 4096
  s_add_u32 s10, s63, 129536
  buffer_load_dwordx4 v5, s[32:35], s10 offen offset:2048 lds
  v_mfma_f32_16x16x32_bf16 v[236:239], v[28:31], v[56:59], v[236:239]
  s_add_u32 m0, s48, 4096
  s_add_u32 s10, s63, 161280
  buffer_load_dwordx4 v5, s[32:35], s10 offen offset:3072 lds
  s_add_u32 s50, s50, 524288
  s_cmp_ge_u32 s50, 3670016
  s_cselect_b32 s10, 3670016, 0
  s_sub_u32 s50, s50, s10
  s_add_u32 s63, s63, 524288
  s_sub_u32 s63, s63, s10
  v_mfma_f32_16x16x32_bf16 v[240:243], v[28:31], v[60:63], v[240:243]
  v_mfma_f32_16x16x32_bf16 v[244:247], v[28:31], v[64:67], v[244:247]
  v_mfma_f32_16x16x32_bf16 v[248:251], v[28:31], v[68:71], v[248:251]
  v_mfma_f32_16x16x32_bf16 v[252:255], v[28:31], v[72:75], v[252:255]
  s_waitcnt lgkmcnt(0)
  v_mfma_f32_16x16x32_bf16 v[144:147], v[32:35], v[76:79], v[144:147]
  v_mfma_f32_16x16x32_bf16 v[148:151], v[32:35], v[80:83], v[148:151]
  v_mfma_f32_16x16x32_bf16 v[152:155], v[32:35], v[84:87], v[152:155]
  v_mfma_f32_16x16x32_bf16 v[156:159], v[32:35], v[88:91], v[156:159]
  s_add_u32 m0, s14, 32768
  s_add_u32 s10, s58, 196608
  buffer_load_dwordx4 v13, s[24:27], s10 offen offset:0 nt lds
  s_add_u32 s10, s58, 199680
  buffer_load_dwordx4 v13, s[24:27], s10 offen offset:1024 nt lds
  s_add_u32 s10, s58, 202752
  buffer_load_dwordx4 v13, s[24:27], s10 offen offset:2048 nt lds
  s_add_u32 s10, s58, 205824
  buffer_load_dwordx4 v13, s[24:27], s10 offen offset:3072 nt lds
  s_waitcnt lgkmcnt(0) vmcnt(8)
  s_barrier
  v_mfma_f32_16x16x32_bf16 v[160:163], v[32:35], v[92:95], v[160:163]
  v_mfma_f32_16x16x32_bf16 v[164:167], v[32:35], v[96:99], v[164:167]
  ds_read_b128 v[48:51], v108 offset:0
  v_mfma_f32_16x16x32_bf16 v[168:171], v[32:35], v[100:103], v[168:171]
  ds_read_b128 v[52:55], v108 offset:2048
  v_mfma_f32_16x16x32_bf16 v[172:175], v[36:39], v[76:79], v[172:175]
  ds_read_b128 v[56:59], v108 offset:4096
  v_mfma_f32_16x16x32_bf16 v[176:179], v[36:39], v[80:83], v[176:179]
  ds_read_b128 v[60:63], v108 offset:6144
  v_mfma_f32_16x16x32_bf16 v[180:183], v[36:39], v[84:87], v[180:183]
  ds_read_b128 v[64:67], v108 offset:8192
  v_mfma_f32_16x16x32_bf16 v[184:187], v[36:39], v[88:91], v[184:187]
  ds_read_b128 v[68:71], v108 offset:10240
  v_mfma_f32_16x16x32_bf16 v[188:191], v[36:39], v[92:95], v[188:191]
  ds_read_b128 v[72:75], v108 offset:12288
  v_mfma_f32_16x16x32_bf16 v[192:195], v[36:39], v[96:99], v[192:195]
  ds_read_b64_tr_b16 v[16:17], v1 offset:0
  v_mfma_f32_16x16x32_bf16 v[196:199], v[36:39], v[100:103], v[196:199]
  ds_read_b64_tr_b16 v[18:19], v1 offset:1024
  v_mfma_f32_16x16x32_bf16 v[200:203], v[40:43], v[76:79], v[200:203]
  ds_read_b64_tr_b16 v[20:21], v2 offset:0
  v_mfma_f32_16x16x32_bf16 v[204:207], v[40:43], v[80:83], v[204:207]
  ds_read_b64_tr_b16 v[22:23], v2 offset:1024
  v_mfma_f32_16x16x32_bf16 v[208:211], v[40:43], v[84:87], v[208:211]
  ds_read_b64_tr_b16 v[24:25], v3 offset:0
  v_mfma_f32_16x16x32_bf16 v[212:215], v[40:43], v[88:91], v[212:215]
  ds_read_b64_tr_b16 v[26:27], v3 offset:1024
  v_mfma_f32_16x16x32_bf16 v[216:219], v[40:43], v[92:95], v[216:219]
  ds_read_b64_tr_b16 v[28:29], v4 offset:0
  v_mfma_f32_16x16x32_bf16 v[220:223], v[40:43], v[96:99], v[220:223]
  ds_read_b64_tr_b16 v[30:31], v4 offset:1024
  v_mfma_f32_16x16x32_bf16 v[224:227], v[40:43], v[100:103], v[224:227]
  v_mfma_f32_16x16x32_bf16 v[228:231], v[44:47], v[76:79], v[228:231]
  v_mfma_f32_16x16x32_bf16 v[232:235], v[44:47], v[80:83], v[232:235]
  s_add_u32 m0, s14, 49152
  s_add_u32 s10, s59, 0
  buffer_load_dwordx4 v13, s[24:27], s10 offen offset:0 nt lds
  s_add_u32 s10, s59, 3072
  buffer_load_dwordx4 v13, s[24:27], s10 offen offset:1024 nt lds
  s_add_u32 s10, s59, 6144
  buffer_load_dwordx4 v13, s[24:27], s10 offen offset:2048 nt lds
  s_add_u32 s10, s59, 9216
  buffer_load_dwordx4 v13, s[24:27], s10 offen offset:3072 nt lds
  s_waitcnt lgkmcnt(0) vmcnt(4)
  s_barrier
  v_mfma_f32_16x16x32_bf16 v[236:239], v[44:47], v[84:87], v[236:239]
  v_mfma_f32_16x16x32_bf16 v[240:243], v[44:47], v[88:91], v[240:243]
  v_mfma_f32_16x16x32_bf16 v[244:247], v[44:47], v[92:95], v[244:247]
  v_mfma_f32_16x16x32_bf16 v[248:251], v[44:47], v[96:99], v[248:251]
  v_mfma_f32_16x16x32_bf16 v[252:255], v[44:47], v[100:103], v[252:255]
  v_mfma_f32_16x16x32_bf16 v[144:147], v[16:19], v[48:51], v[144:147]
  v_mfma_f32_16x16x32_bf16 v[148:151], v[16:19], v[52:55], v[148:151]
  v_mfma_f32_16x16x32_bf16 v[152:155], v[16:19], v[56:59], v[152:155]
  v_mfma_f32_16x16x32_bf16 v[156:159], v[16:19], v[60:63], v[156:159]
  v_mfma_f32_16x16x32_bf16 v[160:163], v[16:19], v[64:67], v[160:163]
  v_mfma_f32_16x16x32_bf16 v[164:167], v[16:19], v[68:71], v[164:167]
  ds_read_b128 v[76:79], v109 offset:0
  v_mfma_f32_16x16x32_bf16 v[168:171], v[16:19], v[72:75], v[168:171]
  ds_read_b128 v[80:83], v109 offset:2048
  v_mfma_f32_16x16x32_bf16 v[172:175], v[20:23], v[48:51], v[172:175]
  ds_read_b128 v[84:87], v109 offset:4096
  v_mfma_f32_16x16x32_bf16 v[176:179], v[20:23], v[52:55], v[176:179]
  ds_read_b128 v[88:91], v109 offset:6144
  v_mfma_f32_16x16x32_bf16 v[180:183], v[20:23], v[56:59], v[180:183]
  ds_read_b128 v[92:95], v109 offset:8192
  v_mfma_f32_16x16x32_bf16 v[184:187], v[20:23], v[60:63], v[184:187]
  ds_read_b128 v[96:99], v109 offset:10240
  v_mfma_f32_16x16x32_bf16 v[188:191], v[20:23], v[64:67], v[188:191]
  ds_read_b128 v[100:103], v109 offset:12288
  v_mfma_f32_16x16x32_bf16 v[192:195], v[20:23], v[68:71], v[192:195]
  ds_read_b64_tr_b16 v[32:33], v1 offset:4096
  v_mfma_f32_16x16x32_bf16 v[196:199], v[20:23], v[72:75], v[196:199]
  s_add_u32 m0, s14, 65536
  s_add_u32 s10, s59, 65536
  buffer_load_dwordx4 v13, s[24:27], s10 offen offset:0 nt lds
  s_add_u32 s10, s59, 68608
  buffer_load_dwordx4 v13, s[24:27], s10 offen offset:1024 nt lds
  s_add_u32 s10, s59, 71680
  buffer_load_dwordx4 v13, s[24:27], s10 offen offset:2048 nt lds
  s_add_u32 s10, s59, 74752
  buffer_load_dwordx4 v13, s[24:27], s10 offen offset:3072 nt lds
  ds_read_b64_tr_b16 v[34:35], v1 offset:5120
  s_waitcnt lgkmcnt(0) vmcnt(4)
  s_barrier
  v_mfma_f32_16x16x32_bf16 v[200:203], v[24:27], v[48:51], v[200:203]
  ds_read_b64_tr_b16 v[36:37], v2 offset:4096
  v_mfma_f32_16x16x32_bf16 v[204:207], v[24:27], v[52:55], v[204:207]
  ds_read_b64_tr_b16 v[38:39], v2 offset:5120
  v_mfma_f32_16x16x32_bf16 v[208:211], v[24:27], v[56:59], v[208:211]
  ds_read_b64_tr_b16 v[40:41], v3 offset:4096
  v_mfma_f32_16x16x32_bf16 v[212:215], v[24:27], v[60:63], v[212:215]
  ds_read_b64_tr_b16 v[42:43], v3 offset:5120
  v_mfma_f32_16x16x32_bf16 v[216:219], v[24:27], v[64:67], v[216:219]
  ds_read_b64_tr_b16 v[44:45], v4 offset:4096
  v_mfma_f32_16x16x32_bf16 v[220:223], v[24:27], v[68:71], v[220:223]
  ds_read_b64_tr_b16 v[46:47], v4 offset:5120
  v_mfma_f32_16x16x32_bf16 v[224:227], v[24:27], v[72:75], v[224:227]
  v_mfma_f32_16x16x32_bf16 v[228:231], v[28:31], v[48:51], v[228:231]
  v_mfma_f32_16x16x32_bf16 v[232:235], v[28:31], v[52:55], v[232:235]
  v_mfma_f32_16x16x32_bf16 v[236:239], v[28:31], v[56:59], v[236:239]
  v_mfma_f32_16x16x32_bf16 v[240:243], v[28:31], v[60:63], v[240:243]
  v_mfma_f32_16x16x32_bf16 v[244:247], v[28:31], v[64:67], v[244:247]
  v_mfma_f32_16x16x32_bf16 v[248:251], v[28:31], v[68:71], v[248:251]
  v_mfma_f32_16x16x32_bf16 v[252:255], v[28:31], v[72:75], v[252:255]
  s_waitcnt lgkmcnt(0)
  v_mfma_f32_16x16x32_bf16 v[144:147], v[32:35], v[76:79], v[144:147]
  v_mfma_f32_16x16x32_bf16 v[148:151], v[32:35], v[80:83], v[148:151]
  v_mfma_f32_16x16x32_bf16 v[152:155], v[32:35], v[84:87], v[152:155]
  v_mfma_f32_16x16x32_bf16 v[156:159], v[32:35], v[88:91], v[156:159]
  s_add_u32 m0, s14, 0
  s_add_u32 s10, s59, 131072
  buffer_load_dwordx4 v13, s[24:27], s10 offen offset:0 nt lds
  s_add_u32 s10, s59, 134144
  buffer_load_dwordx4 v13, s[24:27], s10 offen offset:1024 nt lds
  s_add_u32 s10, s59, 137216
  buffer_load_dwordx4 v13, s[24:27], s10 offen offset:2048 nt lds
  s_add_u32 s10, s59, 140288
  buffer_load_dwordx4 v13, s[24:27], s10 offen offset:3072 nt lds
  s_waitcnt lgkmcnt(0) vmcnt(4)
  s_barrier
  v_mfma_f32_16x16x32_bf16 v[160:163], v[32:35], v[92:95], v[160:163]
  v_mfma_f32_16x16x32_bf16 v[164:167], v[32:35], v[96:99], v[164:167]
  v_mfma_f32_16x16x32_bf16 v[168:171], v[32:35], v[100:103], v[168:171]
  v_mfma_f32_16x16x32_bf16 v[172:175], v[36:39], v[76:79], v[172:175]
  ds_write_b64 v110, v[112:113] offset:50176
  ds_write_b64 v110, v[112:113] offset:50688
  ds_write_b64 v110, v[112:113] offset:52224
  ds_write_b64 v110, v[112:113] offset:52736
  v_mul_f32 v144, s18, v144
  v_mul_f32 v145, s18, v145
  v_mul_f32 v146, s18, v146
  v_mul_f32 v147, s18, v147
  v_cvt_pk_bf16_f32 v144, v144, v145
  v_cvt_pk_bf16_f32 v145, v146, v147
  ds_write_b64 v110, v[144:145] offset:0
  v_mfma_f32_16x16x32_bf16 v[176:179], v[36:39], v[80:83], v[176:179]
  v_mul_f32 v148, s18, v148
  v_mul_f32 v149, s18, v149
  v_mul_f32 v150, s18, v150
  v_mul_f32 v151, s18, v151
  v_cvt_pk_bf16_f32 v148, v148, v149
  v_cvt_pk_bf16_f32 v149, v150, v151
  ds_write_b64 v110, v[148:149] offset:1024
  v_mfma_f32_16x16x32_bf16 v[180:183], v[36:39], v[84:87], v[180:183]
  v_mul_f32 v152, s18, v152
  v_mul_f32 v153, s18, v153
  v_mul_f32 v154, s18, v154
  v_mul_f32 v155, s18, v155
  v_cvt_pk_bf16_f32 v152, v152, v153
  v_cvt_pk_bf16_f32 v153, v154, v155
  ds_write_b64 v110, v[152:153] offset:16384
  v_mfma_f32_16x16x32_bf16 v[184:187], v[36:39], v[88:91], v[184:187]
  v_mul_f32 v156, s18, v156
  v_mul_f32 v157, s18, v157
  v_mul_f32 v158, s18, v158
  v_mul_f32 v159, s18, v159
  v_cvt_pk_bf16_f32 v156, v156, v157
  v_cvt_pk_bf16_f32 v157, v158, v159
  ds_write_b64 v110, v[156:157] offset:17408
  v_mfma_f32_16x16x32_bf16 v[188:191], v[36:39], v[92:95], v[188:191]
  v_mul_f32 v160, s18, v160
  v_mul_f32 v161, s18, v161
  v_mul_f32 v162, s18, v162
  v_mul_f32 v163, s18, v163
  v_cvt_pk_bf16_f32 v160, v160, v161
  v_cvt_pk_bf16_f32 v161, v162, v163
  ds_write_b64 v110, v[160:161] offset:32768
  v_mfma_f32_16x16x32_bf16 v[192:195], v[36:39], v[96:99], v[192:195]
  v_mul_f32 v164, s18, v164
  v_mul_f32 v165, s18, v165
  v_mul_f32 v166, s18, v166
  v_mul_f32 v167, s18, v167
  v_cvt_pk_bf16_f32 v164, v164, v165
  v_cvt_pk_bf16_f32 v165, v166, v167
  ds_write_b64 v110, v[164:165] offset:33792
  v_mfma_f32_16x16x32_bf16 v[196:199], v[36:39], v[100:103], v[196:199]
  v_mul_f32 v168, s18, v168
  v_mul_f32 v169, s18, v169
  v_mul_f32 v170, s18, v170
  v_mul_f32 v171, s18, v171
  v_cvt_pk_bf16_f32 v168, v168, v169
  v_cvt_pk_bf16_f32 v169, v170, v171
  ds_write_b64 v110, v[168:169] offset:49152
  v_mfma_f32_16x16x32_bf16 v[200:203], v[40:43], v[76:79], v[200:203]
  v_mul_f32 v172, s18, v172
  v_mul_f32 v173, s18, v173
  v_mul_f32 v174, s18, v174
  v_mul_f32 v175, s18, v175
  v_cvt_pk_bf16_f32 v172, v172, v173
  v_cvt_pk_bf16_f32 v173, v174, v175
  ds_write_b64 v110, v[172:173] offset:512
  v_mfma_f32_16x16x32_bf16 v[204:207], v[40:43], v[80:83], v[204:207]
  s_add_u32 m0, s14, 16384
  s_add_u32 s10, s59, 196608
  buffer_load_dwordx4 v13, s[24:27], s10 offen offset:0 nt lds
  s_add_u32 s10, s59, 199680
  buffer_load_dwordx4 v13, s[24:27], s10 offen offset:1024 nt lds
  s_add_u32 s10, s59, 202752
  buffer_load_dwordx4 v13, s[24:27], s10 offen offset:2048 nt lds
  s_add_u32 s10, s59, 205824
  buffer_load_dwordx4 v13, s[24:27], s10 offen offset:3072 nt lds
  v_mul_f32 v176, s18, v176
  v_mul_f32 v177, s18, v177
  v_mul_f32 v178, s18, v178
  v_mul_f32 v179, s18, v179
  v_cvt_pk_bf16_f32 v176, v176, v177
  v_cvt_pk_bf16_f32 v177, v178, v179
  ds_write_b64 v110, v[176:177] offset:1536
  s_waitcnt lgkmcnt(0) vmcnt(4)
  s_barrier
  v_mfma_f32_16x16x32_bf16 v[208:211], v[40:43], v[84:87], v[208:211]
  v_mul_f32 v180, s18, v180
  v_mul_f32 v181, s18, v181
  v_mul_f32 v182, s18, v182
  v_mul_f32 v183, s18, v183
  v_cvt_pk_bf16_f32 v180, v180, v181
  v_cvt_pk_bf16_f32 v181, v182, v183
  ds_write_b64 v110, v[180:181] offset:16896
  v_mfma_f32_16x16x32_bf16 v[212:215], v[40:43], v[88:91], v[212:215]
  v_mul_f32 v184, s18, v184
  v_mul_f32 v185, s18, v185
  v_mul_f32 v186, s18, v186
  v_mul_f32 v187, s18, v187
  v_cvt_pk_bf16_f32 v184, v184, v185
  v_cvt_pk_bf16_f32 v185, v186, v187
  ds_write_b64 v110, v[184:185] offset:17920
  v_mfma_f32_16x16x32_bf16 v[216:219], v[40:43], v[92:95], v[216:219]
  v_mul_f32 v188, s18, v188
  v_mul_f32 v189, s18, v189
  v_mul_f32 v190, s18, v190
  v_mul_f32 v191, s18, v191
  v_cvt_pk_bf16_f32 v188, v188, v189
  v_cvt_pk_bf16_f32 v189, v190, v191
  ds_write_b64 v110, v[188:189] offset:33280
  v_mfma_f32_16x16x32_bf16 v[220:223], v[40:43], v[96:99], v[220:223]
  v_mul_f32 v192, s18, v192
  v_mul_f32 v193, s18, v193
  v_mul_f32 v194, s18, v194
  v_mul_f32 v195, s18, v195
  v_cvt_pk_bf16_f32 v192, v192, v193
  v_cvt_pk_bf16_f32 v193, v194, v195
  ds_write_b64 v110, v[192:193] offset:34304
  v_mfma_f32_16x16x32_bf16 v[224:227], v[40:43], v[100:103], v[224:227]
  v_mul_f32 v196, s18, v196
  v_mul_f32 v197, s18, v197
  v_mul_f32 v198, s18, v198
  v_mul_f32 v199, s18, v199
  v_cvt_pk_bf16_f32 v196, v196, v197
  v_cvt_pk_bf16_f32 v197, v198, v199
  ds_write_b64 v110, v[196:197] offset:49664
  v_mfma_f32_16x16x32_bf16 v[228:231], v[44:47], v[76:79], v[228:231]
  v_mul_f32 v200, s18, v200
  v_mul_f32 v201, s18, v201
  v_mul_f32 v202, s18, v202
  v_mul_f32 v203, s18, v203
  v_cvt_pk_bf16_f32 v200, v200, v201
  v_cvt_pk_bf16_f32 v201, v202, v203
  ds_write_b64 v110, v[200:201] offset:2048
  v_mfma_f32_16x16x32_bf16 v[232:235], v[44:47], v[80:83], v[232:235]
  v_mul_f32 v204, s18, v204
  v_mul_f32 v205, s18, v205
  v_mul_f32 v206, s18, v206
  v_mul_f32 v207, s18, v207
  v_cvt_pk_bf16_f32 v204, v204, v205
  v_cvt_pk_bf16_f32 v205, v206, v207
  ds_write_b64 v110, v[204:205] offset:3072
  v_mfma_f32_16x16x32_bf16 v[236:239], v[44:47], v[84:87], v[236:239]
  s_add_u32 m0, s14, 32768
  s_add_u32 s10, s14, 266240
  buffer_load_dwordx4 v10, s[20:23], s10 offen offset:0 nt lds
  s_add_u32 s10, s14, 265344
  buffer_load_dwordx4 v10, s[20:23], s10 offen offset:1024 nt lds
  s_add_u32 s10, s14, 264448
  buffer_load_dwordx4 v10, s[20:23], s10 offen offset:2048 nt lds
  s_add_u32 s10, s14, 263552
  buffer_load_dwordx4 v10, s[20:23], s10 offen offset:3072 nt lds
  v_mul_f32 v208, s18, v208
  v_mul_f32 v209, s18, v209
  v_mul_f32 v210, s18, v210
  v_mul_f32 v211, s18, v211
  v_cvt_pk_bf16_f32 v208, v208, v209
  v_cvt_pk_bf16_f32 v209, v210, v211
  ds_write_b64 v110, v[208:209] offset:18432
  s_waitcnt lgkmcnt(0) vmcnt(4)
  s_barrier
  v_mfma_f32_16x16x32_bf16 v[240:243], v[44:47], v[88:91], v[240:243]
  v_mul_f32 v212, s18, v212
  v_mul_f32 v213, s18, v213
  v_mul_f32 v214, s18, v214
  v_mul_f32 v215, s18, v215
  v_cvt_pk_bf16_f32 v212, v212, v213
  v_cvt_pk_bf16_f32 v213, v214, v215
  ds_write_b64 v110, v[212:213] offset:19456
  v_mfma_f32_16x16x32_bf16 v[244:247], v[44:47], v[92:95], v[244:247]
  v_mul_f32 v216, s18, v216
  v_mul_f32 v217, s18, v217
  v_mul_f32 v218, s18, v218
  v_mul_f32 v219, s18, v219
  v_cvt_pk_bf16_f32 v216, v216, v217
  v_cvt_pk_bf16_f32 v217, v218, v219
  ds_write_b64 v110, v[216:217] offset:34816
  v_mfma_f32_16x16x32_bf16 v[248:251], v[44:47], v[96:99], v[248:251]
  v_mul_f32 v220, s18, v220
  v_mul_f32 v221, s18, v221
  v_mul_f32 v222, s18, v222
  v_mul_f32 v223, s18, v223
  v_cvt_pk_bf16_f32 v220, v220, v221
  v_cvt_pk_bf16_f32 v221, v222, v223
  ds_write_b64 v110, v[220:221] offset:35840
  v_mfma_f32_16x16x32_bf16 v[252:255], v[44:47], v[100:103], v[252:255]
  s_add_u32 m0, s14, 49152
  s_add_u32 s10, s14, 282624
  buffer_load_dwordx4 v10, s[20:23], s10 offen offset:0 nt lds
  s_add_u32 s10, s14, 281728
  buffer_load_dwordx4 v10, s[20:23], s10 offen offset:1024 nt lds
  s_add_u32 s10, s14, 280832
  buffer_load_dwordx4 v10, s[20:23], s10 offen offset:2048 nt lds
  s_add_u32 s10, s14, 279936
  buffer_load_dwordx4 v10, s[20:23], s10 offen offset:3072 nt lds
  v_mul_f32 v224, s18, v224
  v_mul_f32 v225, s18, v225
  v_mul_f32 v226, s18, v226
  v_mul_f32 v227, s18, v227
  v_cvt_pk_bf16_f32 v224, v224, v225
  v_cvt_pk_bf16_f32 v225, v226, v227
  ds_write_b64 v110, v[224:225] offset:51200
  v_mul_f32 v228, s18, v228
  v_mul_f32 v229, s18, v229
  v_mul_f32 v230, s18, v230
  v_mul_f32 v231, s18, v231
  v_cvt_pk_bf16_f32 v228, v228, v229
  v_cvt_pk_bf16_f32 v229, v230, v231
  ds_write_b64 v110, v[228:229] offset:2560
  v_mul_f32 v232, s18, v232
  v_mul_f32 v233, s18, v233
  v_mul_f32 v234, s18, v234
  v_mul_f32 v235, s18, v235
  v_cvt_pk_bf16_f32 v232, v232, v233
  v_cvt_pk_bf16_f32 v233, v234, v235
  ds_write_b64 v110, v[232:233] offset:3584
  v_mul_f32 v236, s18, v236
  v_mul_f32 v237, s18, v237
  v_mul_f32 v238, s18, v238
  v_mul_f32 v239, s18, v239
  v_cvt_pk_bf16_f32 v236, v236, v237
  v_cvt_pk_bf16_f32 v237, v238, v239
  ds_write_b64 v110, v[236:237] offset:18944
  v_mul_f32 v240, s18, v240
  v_mul_f32 v241, s18, v241
  v_mul_f32 v242, s18, v242
  v_mul_f32 v243, s18, v243
  v_cvt_pk_bf16_f32 v240, v240, v241
  v_cvt_pk_bf16_f32 v241, v242, v243
  ds_write_b64 v110, v[240:241] offset:19968
  v_mul_f32 v244, s18, v244
  v_mul_f32 v245, s18, v245
  v_mul_f32 v246, s18, v246
  v_mul_f32 v247, s18, v247
  v_cvt_pk_bf16_f32 v244, v244, v245
  v_cvt_pk_bf16_f32 v245, v246, v247
  ds_write_b64 v110, v[244:245] offset:35328
  v_mul_f32 v248, s18, v248
  v_mul_f32 v249, s18, v249
  v_mul_f32 v250, s18, v250
  v_mul_f32 v251, s18, v251
  v_cvt_pk_bf16_f32 v248, v248, v249
  v_cvt_pk_bf16_f32 v249, v250, v251
  ds_write_b64 v110, v[248:249] offset:36352
  v_mul_f32 v252, s18, v252
  v_mul_f32 v253, s18, v253
  v_mul_f32 v254, s18, v254
  v_mul_f32 v255, s18, v255
  v_cvt_pk_bf16_f32 v252, v252, v253
  v_cvt_pk_bf16_f32 v253, v254, v255
  ds_write_b64 v110, v[252:253] offset:51712
  s_waitcnt lgkmcnt(0) vmcnt(4)
  s_barrier
  s_add_u32 m0, s14, 65536
  s_add_u32 s10, s14, 299008
  buffer_load_dwordx4 v10, s[20:23], s10 offen offset:0 nt lds
  s_add_u32 s10, s14, 298112
  buffer_load_dwordx4 v10, s[20:23], s10 offen offset:1024 nt lds
  s_add_u32 s10, s14, 297216
  buffer_load_dwordx4 v10, s[20:23], s10 offen offset:2048 nt lds
  s_add_u32 s10, s14, 296320
  buffer_load_dwordx4 v10, s[20:23], s10 offen offset:3072 nt lds
  v_add_u32 v15, 0, v0
  v_mul_u32_u24 v16, 2341, v15
  v_lshrrev_b32 v16, 15, v16
  v_mul_u32_u24 v16, 672, v16
  v_lshl_add_u32 v3, v15, 4, v16
  v_subrev_u32 v3, 0, v3
  v_add_u32 v15, 64, v0
  v_mul_u32_u24 v16, 2341, v15
  v_lshrrev_b32 v16, 15, v16
  v_mul_u32_u24 v16, 672, v16
  v_lshl_add_u32 v4, v15, 4, v16
  v_subrev_u32 v4, 1024, v4
  v_add_u32 v15, 128, v0
  v_mul_u32_u24 v16, 2341, v15
  v_lshrrev_b32 v16, 15, v16
  v_mul_u32_u24 v16, 672, v16
  v_lshl_add_u32 v5, v15, 4, v16
  v_subrev_u32 v5, 2048, v5
  v_add_u32 v15, 192, v0
  v_mul_u32_u24 v16, 2341, v15
  v_lshrrev_b32 v16, 15, v16
  v_mul_u32_u24 v16, 672, v16
  v_lshl_add_u32 v6, v15, 4, v16
  v_subrev_u32 v6, 3072, v6
  v_add_u32 v15, 256, v0
  v_mul_u32_u24 v16, 2341, v15
  v_lshrrev_b32 v16, 15, v16
  v_mul_u32_u24 v16, 672, v16
  v_lshl_add_u32 v7, v15, 4, v16
  v_subrev_u32 v7, 0, v7
  v_add_u32 v15, 320, v0
  v_mul_u32_u24 v16, 2341, v15
  v_lshrrev_b32 v16, 15, v16
  v_mul_u32_u24 v16, 672, v16
  v_lshl_add_u32 v8, v15, 4, v16
  v_subrev_u32 v8, 1024, v8
  v_add_u32 v15, 384, v0
  v_mul_u32_u24 v16, 2341, v15
  v_lshrrev_b32 v16, 15, v16
  v_mul_u32_u24 v16, 672, v16
  v_lshl_add_u32 v9, v15, 4, v16
  v_subrev_u32 v9, 2048, v9
  v_lshrrev_b32 v15, 2, v0
  v_mul_u32_u24 v1, 224, v15
  v_and_b32 v16, 3, v0
  v_lshl_add_u32 v1, v16, 3, v1
  v_add_u32 v1, s51, v1
  v_add_u32 v2, 147456, v12
  s_waitcnt lgkmcnt(0) vmcnt(4)
  s_barrier
  s_add_u32 s10, s46, 6
  s_and_b32 s10, s10, 7
  s_xor_b32 s10, s10, s45
  s_mul_i32 s15, s10, 28672
  s_add_u32 s15, s15, s13
  s_add_u32 s15, s15, 0
  s_add_u32 m0, s51, 0
  s_nop 0
  buffer_load_dwordx4 v3, s[36:39], s15 offen offset:0 lds
  s_add_u32 m0, s51, 0
  s_nop 0
  buffer_load_dwordx4 v4, s[36:39], s15 offen offset:1024 lds
  s_add_u32 m0, s51, 0
  s_nop 0
  buffer_load_dwordx4 v5, s[36:39], s15 offen offset:2048 lds
  s_add_u32 m0, s51, 0
  s_nop 0
  buffer_load_dwordx4 v6, s[36:39], s15 offen offset:3072 lds
  s_add_u32 m0, s51, 4096
  s_nop 0
  buffer_load_dwordx4 v7, s[36:39], s15 offen offset:0 lds
  s_add_u32 m0, s51, 4096
  s_nop 0
  buffer_load_dwordx4 v8, s[36:39], s15 offen offset:1024 lds
  s_add_u32 m0, s51, 4096
  s_nop 0
  buffer_load_dwordx4 v9, s[36:39], s15 offen offset:2048 lds
  s_add_u32 m0, s14, 0
  s_add_u32 s10, s14, 315392
  buffer_load_dwordx4 v10, s[20:23], s10 offen offset:0 nt lds
  s_add_u32 s10, s14, 314496
  buffer_load_dwordx4 v10, s[20:23], s10 offen offset:1024 nt lds
  s_add_u32 s10, s14, 313600
  buffer_load_dwordx4 v10, s[20:23], s10 offen offset:2048 nt lds
  s_add_u32 s10, s14, 312704
  buffer_load_dwordx4 v10, s[20:23], s10 offen offset:3072 nt lds
  s_waitcnt lgkmcnt(0) vmcnt(11)
  s_barrier
  s_waitcnt vmcnt(4)
  ds_read_b64_tr_b16 v[16:17], v1 offset:0
  ds_read_b64_tr_b16 v[18:19], v1 offset:3584
  ds_read_b64_tr_b16 v[20:21], v1 offset:32
  ds_read_b64_tr_b16 v[22:23], v1 offset:3616
  ds_read_b64_tr_b16 v[24:25], v1 offset:64
  ds_read_b64_tr_b16 v[26:27], v1 offset:3648
  ds_read_b64_tr_b16 v[28:29], v1 offset:96
  ds_read_b64_tr_b16 v[30:31], v1 offset:3680
  ds_read_b128 v[32:35], v2 offset:0
  ds_read_b128 v[36:39], v2 offset:1024
  ds_read_b128 v[40:43], v2 offset:2048
  ds_read_b128 v[44:47], v2 offset:3072
  ds_read_b128 v[48:51], v2 offset:4096
  ds_read_b128 v[52:55], v2 offset:5120
  ds_read_b128 v[56:59], v2 offset:6144
  s_waitcnt lgkmcnt(13)
  s_waitcnt lgkmcnt(6)
  v_mfma_f32_16x16x32_bf16 v[60:63], v[16:19], v[32:35], 0
  s_waitcnt lgkmcnt(5)
  v_mfma_f32_16x16x32_bf16 v[64:67], v[16:19], v[36:39], 0
  s_waitcnt lgkmcnt(4)
  v_mfma_f32_16x16x32_bf16 v[68:71], v[16:19], v[40:43], 0
  s_waitcnt lgkmcnt(3)
  v_mfma_f32_16x16x32_bf16 v[72:75], v[16:19], v[44:47], 0
  s_add_u32 s10, s46, 7
  s_and_b32 s10, s10, 7
  s_xor_b32 s10, s10, s45
  s_mul_i32 s15, s10, 28672
  s_add_u32 s15, s15, s13
  s_add_u32 s15, s15, 0
  s_add_u32 m0, s51, 7168
  s_nop 0
  buffer_load_dwordx4 v3, s[36:39], s15 offen offset:0 lds
  s_waitcnt lgkmcnt(2)
  v_mfma_f32_16x16x32_bf16 v[76:79], v[16:19], v[48:51], 0
  s_waitcnt lgkmcnt(1)
  v_mfma_f32_16x16x32_bf16 v[80:83], v[16:19], v[52:55], 0
  s_add_u32 m0, s51, 7168
  s_nop 0
  buffer_load_dwordx4 v4, s[36:39], s15 offen offset:1024 lds
  s_waitcnt lgkmcnt(0)
  v_mfma_f32_16x16x32_bf16 v[84:87], v[16:19], v[56:59], 0
  ds_read_b64_tr_b16 v[16:17], v1 offset:128
  ds_read_b64_tr_b16 v[18:19], v1 offset:3712
  v_mfma_f32_16x16x32_bf16 v[88:91], v[20:23], v[32:35], 0
  s_add_u32 m0, s51, 7168
  s_nop 0
  buffer_load_dwordx4 v5, s[36:39], s15 offen offset:2048 lds
  v_mfma_f32_16x16x32_bf16 v[92:95], v[20:23], v[36:39], 0
  v_mfma_f32_16x16x32_bf16 v[96:99], v[20:23], v[40:43], 0
  s_add_u32 m0, s51, 7168
  s_nop 0
  buffer_load_dwordx4 v6, s[36:39], s15 offen offset:3072 lds
  v_mfma_f32_16x16x32_bf16 v[100:103], v[20:23], v[44:47], 0
  v_mfma_f32_16x16x32_bf16 v[104:107], v[20:23], v[48:51], 0
  s_add_u32 m0, s51, 11264
  s_nop 0
  buffer_load_dwordx4 v7, s[36:39], s15 offen offset:0 lds
  v_mfma_f32_16x16x32_bf16 v[108:111], v[20:23], v[52:55], 0
  v_mfma_f32_16x16x32_bf16 v[112:115], v[20:23], v[56:59], 0
  s_add_u32 m0, s51, 11264
  s_nop 0
  buffer_load_dwordx4 v8, s[36:39], s15 offen offset:1024 lds
  ds_read_b64_tr_b16 v[20:21], v1 offset:160
  ds_read_b64_tr_b16 v[22:23], v1 offset:3744
  v_mfma_f32_16x16x32_bf16 v[116:119], v[24:27], v[32:35], 0
  v_mfma_f32_16x16x32_bf16 v[120:123], v[24:27], v[36:39], 0
  s_add_u32 m0, s51, 11264
  s_nop 0
  buffer_load_dwordx4 v9, s[36:39], s15 offen offset:2048 lds
  v_mfma_f32_16x16x32_bf16 v[124:127], v[24:27], v[40:43], 0
  v_mfma_f32_16x16x32_bf16 v[128:131], v[24:27], v[44:47], 0
  v_mfma_f32_16x16x32_bf16 v[132:135], v[24:27], v[48:51], 0
  v_mfma_f32_16x16x32_bf16 v[136:139], v[24:27], v[52:55], 0
  v_mfma_f32_16x16x32_bf16 v[140:143], v[24:27], v[56:59], 0
  s_add_u32 m0, s14, 16384
  s_add_u32 s10, s14, 331776
  buffer_load_dwordx4 v10, s[20:23], s10 offen offset:0 nt lds
  s_add_u32 s10, s14, 330880
  buffer_load_dwordx4 v10, s[20:23], s10 offen offset:1024 nt lds
  s_add_u32 s10, s14, 329984
  buffer_load_dwordx4 v10, s[20:23], s10 offen offset:2048 nt lds
  s_add_u32 s10, s14, 329088
  buffer_load_dwordx4 v10, s[20:23], s10 offen offset:3072 nt lds
  ds_read_b64_tr_b16 v[24:25], v1 offset:192
  ds_read_b64_tr_b16 v[26:27], v1 offset:3776
  s_waitcnt lgkmcnt(0) vmcnt(11)
  s_barrier
  v_mfma_f32_16x16x32_bf16 v[144:147], v[28:31], v[32:35], 0
  v_mfma_f32_16x16x32_bf16 v[148:151], v[28:31], v[36:39], 0
  v_mfma_f32_16x16x32_bf16 v[152:155], v[28:31], v[40:43], 0
  v_mfma_f32_16x16x32_bf16 v[156:159], v[28:31], v[44:47], 0
  v_mfma_f32_16x16x32_bf16 v[160:163], v[28:31], v[48:51], 0
  v_mfma_f32_16x16x32_bf16 v[164:167], v[28:31], v[52:55], 0
  v_mfma_f32_16x16x32_bf16 v[168:171], v[28:31], v[56:59], 0
  v_mfma_f32_16x16x32_bf16 v[172:175], v[16:19], v[32:35], 0
  s_add_u32 s10, s46, 8
  s_and_b32 s10, s10, 7
  s_xor_b32 s10, s10, s45
  s_mul_i32 s15, s10, 28672
  s_add_u32 s15, s15, s13
  s_add_u32 s15, s15, 0
  s_add_u32 m0, s51, 0
  s_nop 0
  buffer_load_dwordx4 v3, s[36:39], s15 offen offset:0 lds
  v_mfma_f32_16x16x32_bf16 v[176:179], v[16:19], v[36:39], 0
  s_add_u32 m0, s51, 0
  s_nop 0
  buffer_load_dwordx4 v4, s[36:39], s15 offen offset:1024 lds
  v_mfma_f32_16x16x32_bf16 v[180:183], v[16:19], v[40:43], 0
  s_add_u32 m0, s51, 0
  s_nop 0
  buffer_load_dwordx4 v5, s[36:39], s15 offen offset:2048 lds
  v_mfma_f32_16x16x32_bf16 v[184:187], v[16:19], v[44:47], 0
  s_add_u32 m0, s51, 0
  s_nop 0
  buffer_load_dwordx4 v6, s[36:39], s15 offen offset:3072 lds
  v_mfma_f32_16x16x32_bf16 v[188:191], v[16:19], v[48:51], 0
  s_add_u32 m0, s51, 4096
  s_nop 0
  buffer_load_dwordx4 v7, s[36:39], s15 offen offset:0 lds
  v_mfma_f32_16x16x32_bf16 v[192:195], v[16:19], v[52:55], 0
  s_add_u32 m0, s51, 4096
  s_nop 0
  buffer_load_dwordx4 v8, s[36:39], s15 offen offset:1024 lds
  v_mfma_f32_16x16x32_bf16 v[196:199], v[16:19], v[56:59], 0
  s_add_u32 m0, s51, 4096
  s_nop 0
  buffer_load_dwordx4 v9, s[36:39], s15 offen offset:2048 lds
  v_mfma_f32_16x16x32_bf16 v[200:203], v[20:23], v[32:35], 0
  v_mfma_f32_16x16x32_bf16 v[204:207], v[20:23], v[36:39], 0
  v_mfma_f32_16x16x32_bf16 v[208:211], v[20:23], v[40:43], 0
  v_mfma_f32_16x16x32_bf16 v[212:215], v[20:23], v[44:47], 0
  v_mfma_f32_16x16x32_bf16 v[216:219], v[20:23], v[48:51], 0
  v_mfma_f32_16x16x32_bf16 v[220:223], v[20:23], v[52:55], 0
  v_mfma_f32_16x16x32_bf16 v[224:227], v[20:23], v[56:59], 0
  s_add_u32 m0, s14, 32768
  s_add_u32 s10, s14, 348160
  buffer_load_dwordx4 v10, s[20:23], s10 offen offset:0 nt lds
  s_add_u32 s10, s14, 347264
  buffer_load_dwordx4 v10, s[20:23], s10 offen offset:1024 nt lds
  s_add_u32 s10, s14, 346368
  buffer_load_dwordx4 v10, s[20:23], s10 offen offset:2048 nt lds
  s_add_u32 s10, s14, 345472
  buffer_load_dwordx4 v10, s[20:23], s10 offen offset:3072 nt lds
  s_waitcnt lgkmcnt(0) vmcnt(11)
  s_barrier
  v_mfma_f32_16x16x32_bf16 v[228:231], v[24:27], v[32:35], 0
  v_mfma_f32_16x16x32_bf16 v[232:235], v[24:27], v[36:39], 0
  v_mfma_f32_16x16x32_bf16 v[236:239], v[24:27], v[40:43], 0
  v_mfma_f32_16x16x32_bf16 v[240:243], v[24:27], v[44:47], 0
  v_mfma_f32_16x16x32_bf16 v[244:247], v[24:27], v[48:51], 0
  v_mfma_f32_16x16x32_bf16 v[248:251], v[24:27], v[52:55], 0
  v_mfma_f32_16x16x32_bf16 v[252:255], v[24:27], v[56:59], 0
  s_waitcnt vmcnt(15)
  ds_read_b64_tr_b16 v[16:17], v1 offset:7168
  ds_read_b64_tr_b16 v[18:19], v1 offset:10752
  ds_read_b64_tr_b16 v[20:21], v1 offset:7200
  ds_read_b64_tr_b16 v[22:23], v1 offset:10784
  ds_read_b64_tr_b16 v[24:25], v1 offset:7232
  ds_read_b64_tr_b16 v[26:27], v1 offset:10816
  ds_read_b64_tr_b16 v[28:29], v1 offset:7264
  ds_read_b64_tr_b16 v[30:31], v1 offset:10848
  ds_read_b128 v[32:35], v2 offset:8192
  ds_read_b128 v[36:39], v2 offset:9216
  ds_read_b128 v[40:43], v2 offset:10240
  ds_read_b128 v[44:47], v2 offset:11264
  ds_read_b128 v[48:51], v2 offset:12288
  ds_read_b128 v[52:55], v2 offset:13312
  ds_read_b128 v[56:59], v2 offset:14336
  s_waitcnt lgkmcnt(13)
  s_waitcnt lgkmcnt(6)
  v_mfma_f32_16x16x32_bf16 v[60:63], v[16:19], v[32:35], v[60:63]
  s_waitcnt lgkmcnt(5)
  v_mfma_f32_16x16x32_bf16 v[64:67], v[16:19], v[36:39], v[64:67]
  s_waitcnt lgkmcnt(4)
  v_mfma_f32_16x16x32_bf16 v[68:71], v[16:19], v[40:43], v[68:71]
  s_waitcnt lgkmcnt(3)
  v_mfma_f32_16x16x32_bf16 v[72:75], v[16:19], v[44:47], v[72:75]
  s_waitcnt lgkmcnt(2)
  v_mfma_f32_16x16x32_bf16 v[76:79], v[16:19], v[48:51], v[76:79]
  s_waitcnt lgkmcnt(1)
  v_mfma_f32_16x16x32_bf16 v[80:83], v[16:19], v[52:55], v[80:83]
  s_waitcnt lgkmcnt(0)
  v_mfma_f32_16x16x32_bf16 v[84:87], v[16:19], v[56:59], v[84:87]
  ds_read_b64_tr_b16 v[16:17], v1 offset:7296
  ds_read_b64_tr_b16 v[18:19], v1 offset:10880
  v_mfma_f32_16x16x32_bf16 v[88:91], v[20:23], v[32:35], v[88:91]
  v_mfma_f32_16x16x32_bf16 v[92:95], v[20:23], v[36:39], v[92:95]
  v_mfma_f32_16x16x32_bf16 v[96:99], v[20:23], v[40:43], v[96:99]
  v_mfma_f32_16x16x32_bf16 v[100:103], v[20:23], v[44:47], v[100:103]
  v_mfma_f32_16x16x32_bf16 v[104:107], v[20:23], v[48:51], v[104:107]
  v_mfma_f32_16x16x32_bf16 v[108:111], v[20:23], v[52:55], v[108:111]
  s_add_u32 m0, s14, 49152
  s_add_u32 s10, s14, 364544
  buffer_load_dwordx4 v10, s[20:23], s10 offen offset:0 nt lds
  s_add_u32 s10, s14, 363648
  buffer_load_dwordx4 v10, s[20:23], s10 offen offset:1024 nt lds
  s_add_u32 s10, s14, 362752
  buffer_load_dwordx4 v10, s[20:23], s10 offen offset:2048 nt lds
  s_add_u32 s10, s14, 361856
  buffer_load_dwordx4 v10, s[20:23], s10 offen offset:3072 nt lds
  s_waitcnt lgkmcnt(0) vmcnt(4)
  s_barrier
  v_mfma_f32_16x16x32_bf16 v[112:115], v[20:23], v[56:59], v[112:115]
  ds_read_b64_tr_b16 v[20:21], v1 offset:7328
  ds_read_b64_tr_b16 v[22:23], v1 offset:10912
  v_mfma_f32_16x16x32_bf16 v[116:119], v[24:27], v[32:35], v[116:119]
  v_mfma_f32_16x16x32_bf16 v[120:123], v[24:27], v[36:39], v[120:123]
  v_mfma_f32_16x16x32_bf16 v[124:127], v[24:27], v[40:43], v[124:127]
  v_mfma_f32_16x16x32_bf16 v[128:131], v[24:27], v[44:47], v[128:131]
  v_mfma_f32_16x16x32_bf16 v[132:135], v[24:27], v[48:51], v[132:135]
  v_mfma_f32_16x16x32_bf16 v[136:139], v[24:27], v[52:55], v[136:139]
  v_mfma_f32_16x16x32_bf16 v[140:143], v[24:27], v[56:59], v[140:143]
  ds_read_b64_tr_b16 v[24:25], v1 offset:7360
  ds_read_b64_tr_b16 v[26:27], v1 offset:10944
  v_mfma_f32_16x16x32_bf16 v[144:147], v[28:31], v[32:35], v[144:147]
  v_mfma_f32_16x16x32_bf16 v[148:151], v[28:31], v[36:39], v[148:151]
  v_mfma_f32_16x16x32_bf16 v[152:155], v[28:31], v[40:43], v[152:155]
  v_mfma_f32_16x16x32_bf16 v[156:159], v[28:31], v[44:47], v[156:159]
  v_mfma_f32_16x16x32_bf16 v[160:163], v[28:31], v[48:51], v[160:163]
  v_mfma_f32_16x16x32_bf16 v[164:167], v[28:31], v[52:55], v[164:167]
  v_mfma_f32_16x16x32_bf16 v[168:171], v[28:31], v[56:59], v[168:171]
  v_mfma_f32_16x16x32_bf16 v[172:175], v[16:19], v[32:35], v[172:175]
  s_waitcnt lgkmcnt(0)
  s_add_u32 s10, s46, 9
  s_and_b32 s10, s10, 7
  s_xor_b32 s10, s10, s45
  s_mul_i32 s15, s10, 28672
  s_add_u32 s15, s15, s13
  s_add_u32 s15, s15, 0
  s_add_u32 m0, s51, 7168
  s_nop 0
  buffer_load_dwordx4 v3, s[36:39], s15 offen offset:0 lds
  v_mfma_f32_16x16x32_bf16 v[176:179], v[16:19], v[36:39], v[176:179]
  s_add_u32 m0, s51, 7168
  s_nop 0
  buffer_load_dwordx4 v4, s[36:39], s15 offen offset:1024 lds
  v_mfma_f32_16x16x32_bf16 v[180:183], v[16:19], v[40:43], v[180:183]
  s_add_u32 m0, s51, 7168
  s_nop 0
  buffer_load_dwordx4 v5, s[36:39], s15 offen offset:2048 lds
  v_mfma_f32_16x16x32_bf16 v[184:187], v[16:19], v[44:47], v[184:187]
  s_add_u32 m0, s51, 7168
  s_nop 0
  buffer_load_dwordx4 v6, s[36:39], s15 offen offset:3072 lds
  v_mfma_f32_16x16x32_bf16 v[188:191], v[16:19], v[48:51], v[188:191]
  s_add_u32 m0, s51, 11264
  s_nop 0
  buffer_load_dwordx4 v7, s[36:39], s15 offen offset:0 lds
  v_mfma_f32_16x16x32_bf16 v[192:195], v[16:19], v[52:55], v[192:195]
  s_add_u32 m0, s14, 65536
  s_add_u32 s10, s14, 380928
  buffer_load_dwordx4 v10, s[20:23], s10 offen offset:0 nt lds
  s_add_u32 s10, s14, 380032
  buffer_load_dwordx4 v10, s[20:23], s10 offen offset:1024 nt lds
  s_add_u32 s10, s14, 379136
  buffer_load_dwordx4 v10, s[20:23], s10 offen offset:2048 nt lds
  s_add_u32 s10, s14, 378240
  buffer_load_dwordx4 v10, s[20:23], s10 offen offset:3072 nt lds
  s_add_u32 m0, s51, 11264
  s_nop 0
  buffer_load_dwordx4 v8, s[36:39], s15 offen offset:1024 lds
  s_waitcnt lgkmcnt(0) vmcnt(10)
  s_barrier
  v_mfma_f32_16x16x32_bf16 v[196:199], v[16:19], v[56:59], v[196:199]
  s_add_u32 m0, s51, 11264
  s_nop 0
  buffer_load_dwordx4 v9, s[36:39], s15 offen offset:2048 lds
  v_mfma_f32_16x16x32_bf16 v[200:203], v[20:23], v[32:35], v[200:203]
  v_mfma_f32_16x16x32_bf16 v[204:207], v[20:23], v[36:39], v[204:207]
  v_mfma_f32_16x16x32_bf16 v[208:211], v[20:23], v[40:43], v[208:211]
  v_mfma_f32_16x16x32_bf16 v[212:215], v[20:23], v[44:47], v[212:215]
  v_mfma_f32_16x16x32_bf16 v[216:219], v[20:23], v[48:51], v[216:219]
  v_mfma_f32_16x16x32_bf16 v[220:223], v[20:23], v[52:55], v[220:223]
  v_mfma_f32_16x16x32_bf16 v[224:227], v[20:23], v[56:59], v[224:227]
  v_mfma_f32_16x16x32_bf16 v[228:231], v[24:27], v[32:35], v[228:231]
  v_mfma_f32_16x16x32_bf16 v[232:235], v[24:27], v[36:39], v[232:235]
  v_mfma_f32_16x16x32_bf16 v[236:239], v[24:27], v[40:43], v[236:239]
  v_mfma_f32_16x16x32_bf16 v[240:243], v[24:27], v[44:47], v[240:243]
  v_mfma_f32_16x16x32_bf16 v[244:247], v[24:27], v[48:51], v[244:247]
  v_mfma_f32_16x16x32_bf16 v[248:251], v[24:27], v[52:55], v[248:251]
  v_mfma_f32_16x16x32_bf16 v[252:255], v[24:27], v[56:59], v[252:255]
  s_waitcnt vmcnt(19)
  ds_read_b64_tr_b16 v[16:17], v1 offset:0
  ds_read_b64_tr_b16 v[18:19], v1 offset:3584
  ds_read_b64_tr_b16 v[20:21], v1 offset:32
  ds_read_b64_tr_b16 v[22:23], v1 offset:3616
  ds_read_b64_tr_b16 v[24:25], v1 offset:64
  ds_read_b64_tr_b16 v[26:27], v1 offset:3648
  ds_read_b64_tr_b16 v[28:29], v1 offset:96
  ds_read_b64_tr_b16 v[30:31], v1 offset:3680
  ds_read_b128 v[32:35], v2 offset:0
  ds_read_b128 v[36:39], v2 offset:1024
  ds_read_b128 v[40:43], v2 offset:2048
  ds_read_b128 v[44:47], v2 offset:3072
  ds_read_b128 v[48:51], v2 offset:4096
  ds_read_b128 v[52:55], v2 offset:5120
  ds_read_b128 v[56:59], v2 offset:6144
  s_waitcnt lgkmcnt(13)
  s_waitcnt lgkmcnt(6)
  v_mfma_f32_16x16x32_bf16 v[60:63], v[16:19], v[32:35], v[60:63]
  s_waitcnt lgkmcnt(5)
  v_mfma_f32_16x16x32_bf16 v[64:67], v[16:19], v[36:39], v[64:67]
  s_waitcnt lgkmcnt(4)
  v_mfma_f32_16x16x32_bf16 v[68:71], v[16:19], v[40:43], v[68:71]
  s_waitcnt lgkmcnt(3)
  v_mfma_f32_16x16x32_bf16 v[72:75], v[16:19], v[44:47], v[72:75]
  s_waitcnt lgkmcnt(2)
  v_mfma_f32_16x16x32_bf16 v[76:79], v[16:19], v[48:51], v[76:79]
  s_waitcnt lgkmcnt(1)
  v_mfma_f32_16x16x32_bf16 v[80:83], v[16:19], v[52:55], v[80:83]
  s_add_u32 m0, s14, 0
  s_add_u32 s10, s14, 397312
  buffer_load_dwordx4 v10, s[20:23], s10 offen offset:0 nt lds
  s_add_u32 s10, s14, 396416
  buffer_load_dwordx4 v10, s[20:23], s10 offen offset:1024 nt lds
  s_add_u32 s10, s14, 395520
  buffer_load_dwordx4 v10, s[20:23], s10 offen offset:2048 nt lds
  s_add_u32 s10, s14, 394624
  buffer_load_dwordx4 v10, s[20:23], s10 offen offset:3072 nt lds
  s_waitcnt lgkmcnt(0)
  s_waitcnt lgkmcnt(0) vmcnt(6)
  s_barrier
  v_mfma_f32_16x16x32_bf16 v[84:87], v[16:19], v[56:59], v[84:87]
  ds_read_b64_tr_b16 v[16:17], v1 offset:128
  ds_read_b64_tr_b16 v[18:19], v1 offset:3712
  v_mfma_f32_16x16x32_bf16 v[88:91], v[20:23], v[32:35], v[88:91]
  v_mfma_f32_16x16x32_bf16 v[92:95], v[20:23], v[36:39], v[92:95]
  v_mfma_f32_16x16x32_bf16 v[96:99], v[20:23], v[40:43], v[96:99]
  v_mfma_f32_16x16x32_bf16 v[100:103], v[20:23], v[44:47], v[100:103]
  v_mfma_f32_16x16x32_bf16 v[104:107], v[20:23], v[48:51], v[104:107]
  v_mfma_f32_16x16x32_bf16 v[108:111], v[20:23], v[52:55], v[108:111]
  v_mfma_f32_16x16x32_bf16 v[112:115], v[20:23], v[56:59], v[112:115]
  ds_read_b64_tr_b16 v[20:21], v1 offset:160
  ds_read_b64_tr_b16 v[22:23], v1 offset:3744
  v_mfma_f32_16x16x32_bf16 v[116:119], v[24:27], v[32:35], v[116:119]
  v_mfma_f32_16x16x32_bf16 v[120:123], v[24:27], v[36:39], v[120:123]
  v_mfma_f32_16x16x32_bf16 v[124:127], v[24:27], v[40:43], v[124:127]
  v_mfma_f32_16x16x32_bf16 v[128:131], v[24:27], v[44:47], v[128:131]
  v_mfma_f32_16x16x32_bf16 v[132:135], v[24:27], v[48:51], v[132:135]
  v_mfma_f32_16x16x32_bf16 v[136:139], v[24:27], v[52:55], v[136:139]
  v_mfma_f32_16x16x32_bf16 v[140:143], v[24:27], v[56:59], v[140:143]
  ds_read_b64_tr_b16 v[24:25], v1 offset:192
  ds_read_b64_tr_b16 v[26:27], v1 offset:3776
  v_mfma_f32_16x16x32_bf16 v[144:147], v[28:31], v[32:35], v[144:147]
  v_mfma_f32_16x16x32_bf16 v[148:151], v[28:31], v[36:39], v[148:151]
  v_mfma_f32_16x16x32_bf16 v[152:155], v[28:31], v[40:43], v[152:155]
  v_mfma_f32_16x16x32_bf16 v[156:159], v[28:31], v[44:47], v[156:159]
  v_mfma_f32_16x16x32_bf16 v[160:163], v[28:31], v[48:51], v[160:163]
  s_add_u32 m0, s14, 16384
  s_add_u32 s10, s14, 413696
  buffer_load_dwordx4 v10, s[20:23], s10 offen offset:0 nt lds
  s_add_u32 s10, s14, 412800
  buffer_load_dwordx4 v10, s[20:23], s10 offen offset:1024 nt lds
  s_add_u32 s10, s14, 411904
  buffer_load_dwordx4 v10, s[20:23], s10 offen offset:2048 nt lds
  s_add_u32 s10, s14, 411008
  buffer_load_dwordx4 v10, s[20:23], s10 offen offset:3072 nt lds
  s_waitcnt lgkmcnt(0) vmcnt(4)
  s_barrier
  v_mfma_f32_16x16x32_bf16 v[164:167], v[28:31], v[52:55], v[164:167]
  v_mfma_f32_16x16x32_bf16 v[168:171], v[28:31], v[56:59], v[168:171]
  v_mfma_f32_16x16x32_bf16 v[172:175], v[16:19], v[32:35], v[172:175]
  s_add_u32 s10, s46, 10
  s_and_b32 s10, s10, 7
  s_xor_b32 s10, s10, s45
  s_mul_i32 s15, s10, 28672
  s_add_u32 s15, s15, s13
  s_add_u32 s15, s15, 0
  s_add_u32 m0, s51, 0
  s_nop 0
  buffer_load_dwordx4 v3, s[36:39], s15 offen offset:0 lds
  v_mfma_f32_16x16x32_bf16 v[176:179], v[16:19], v[36:39], v[176:179]
  s_add_u32 m0, s51, 0
  s_nop 0
  buffer_load_dwordx4 v4, s[36:39], s15 offen offset:1024 lds
  v_mfma_f32_16x16x32_bf16 v[180:183], v[16:19], v[40:43], v[180:183]
  s_add_u32 m0, s51, 0
  s_nop 0
  buffer_load_dwordx4 v5, s[36:39], s15 offen offset:2048 lds
  v_mfma_f32_16x16x32_bf16 v[184:187], v[16:19], v[44:47], v[184:187]
  s_add_u32 m0, s51, 0
  s_nop 0
  buffer_load_dwordx4 v6, s[36:39], s15 offen offset:3072 lds
  v_mfma_f32_16x16x32_bf16 v[188:191], v[16:19], v[48:51], v[188:191]
  s_add_u32 m0, s51, 4096
  s_nop 0
  buffer_load_dwordx4 v7, s[36:39], s15 offen offset:0 lds
  v_mfma_f32_16x16x32_bf16 v[192:195], v[16:19], v[52:55], v[192:195]
  s_add_u32 m0, s51, 4096
  s_nop 0
  buffer_load_dwordx4 v8, s[36:39], s15 offen offset:1024 lds
  v_mfma_f32_16x16x32_bf16 v[196:199], v[16:19], v[56:59], v[196:199]
  s_add_u32 m0, s51, 4096
  s_nop 0
  buffer_load_dwordx4 v9, s[36:39], s15 offen offset:2048 lds
  v_mfma_f32_16x16x32_bf16 v[200:203], v[20:23], v[32:35], v[200:203]
  v_mfma_f32_16x16x32_bf16 v[204:207], v[20:23], v[36:39], v[204:207]
  v_mfma_f32_16x16x32_bf16 v[208:211], v[20:23], v[40:43], v[208:211]
  v_mfma_f32_16x16x32_bf16 v[212:215], v[20:23], v[44:47], v[212:215]
  v_mfma_f32_16x16x32_bf16 v[216:219], v[20:23], v[48:51], v[216:219]
  v_mfma_f32_16x16x32_bf16 v[220:223], v[20:23], v[52:55], v[220:223]
  v_mfma_f32_16x16x32_bf16 v[224:227], v[20:23], v[56:59], v[224:227]
  v_mfma_f32_16x16x32_bf16 v[228:231], v[24:27], v[32:35], v[228:231]
  v_mfma_f32_16x16x32_bf16 v[232:235], v[24:27], v[36:39], v[232:235]
  v_mfma_f32_16x16x32_bf16 v[236:239], v[24:27], v[40:43], v[236:239]
  v_mfma_f32_16x16x32_bf16 v[240:243], v[24:27], v[44:47], v[240:243]
  v_mfma_f32_16x16x32_bf16 v[244:247], v[24:27], v[48:51], v[244:247]
  s_add_u32 m0, s14, 32768
  s_add_u32 s10, s14, 430080
  buffer_load_dwordx4 v10, s[20:23], s10 offen offset:0 nt lds
  s_add_u32 s10, s14, 429184
  buffer_load_dwordx4 v10, s[20:23], s10 offen offset:1024 nt lds
  s_add_u32 s10, s14, 428288
  buffer_load_dwordx4 v10, s[20:23], s10 offen offset:2048 nt lds
  s_add_u32 s10, s14, 427392
  buffer_load_dwordx4 v10, s[20:23], s10 offen offset:3072 nt lds
  s_waitcnt lgkmcnt(0) vmcnt(11)
  s_barrier
  v_mfma_f32_16x16x32_bf16 v[248:251], v[24:27], v[52:55], v[248:251]
  v_mfma_f32_16x16x32_bf16 v[252:255], v[24:27], v[56:59], v[252:255]
  s_waitcnt vmcnt(19)
  ds_read_b64_tr_b16 v[16:17], v1 offset:7168
  ds_read_b64_tr_b16 v[18:19], v1 offset:10752
  ds_read_b64_tr_b16 v[20:21], v1 offset:7200
  ds_read_b64_tr_b16 v[22:23], v1 offset:10784
  ds_read_b64_tr_b16 v[24:25], v1 offset:7232
  ds_read_b64_tr_b16 v[26:27], v1 offset:10816
  ds_read_b64_tr_b16 v[28:29], v1 offset:7264
  ds_read_b64_tr_b16 v[30:31], v1 offset:10848
  ds_read_b128 v[32:35], v2 offset:8192
  ds_read_b128 v[36:39], v2 offset:9216
  ds_read_b128 v[40:43], v2 offset:10240
  ds_read_b128 v[44:47], v2 offset:11264
  ds_read_b128 v[48:51], v2 offset:12288
  ds_read_b128 v[52:55], v2 offset:13312
  ds_read_b128 v[56:59], v2 offset:14336
  s_waitcnt lgkmcnt(13)
  s_waitcnt lgkmcnt(6)
  v_mfma_f32_16x16x32_bf16 v[60:63], v[16:19], v[32:35], v[60:63]
  s_waitcnt lgkmcnt(5)
  v_mfma_f32_16x16x32_bf16 v[64:67], v[16:19], v[36:39], v[64:67]
  s_waitcnt lgkmcnt(4)
  v_mfma_f32_16x16x32_bf16 v[68:71], v[16:19], v[40:43], v[68:71]
  s_waitcnt lgkmcnt(3)
  v_mfma_f32_16x16x32_bf16 v[72:75], v[16:19], v[44:47], v[72:75]
  s_waitcnt lgkmcnt(2)
  v_mfma_f32_16x16x32_bf16 v[76:79], v[16:19], v[48:51], v[76:79]
  s_waitcnt lgkmcnt(1)
  v_mfma_f32_16x16x32_bf16 v[80:83], v[16:19], v[52:55], v[80:83]
  s_waitcnt lgkmcnt(0)
  v_mfma_f32_16x16x32_bf16 v[84:87], v[16:19], v[56:59], v[84:87]
  ds_read_b64_tr_b16 v[16:17], v1 offset:7296
  ds_read_b64_tr_b16 v[18:19], v1 offset:10880
  v_mfma_f32_16x16x32_bf16 v[88:91], v[20:23], v[32:35], v[88:91]
  v_mfma_f32_16x16x32_bf16 v[92:95], v[20:23], v[36:39], v[92:95]
  v_mfma_f32_16x16x32_bf16 v[96:99], v[20:23], v[40:43], v[96:99]
  v_mfma_f32_16x16x32_bf16 v[100:103], v[20:23], v[44:47], v[100:103]
  v_mfma_f32_16x16x32_bf16 v[104:107], v[20:23], v[48:51], v[104:107]
  v_mfma_f32_16x16x32_bf16 v[108:111], v[20:23], v[52:55], v[108:111]
  v_mfma_f32_16x16x32_bf16 v[112:115], v[20:23], v[56:59], v[112:115]
  ds_read_b64_tr_b16 v[20:21], v1 offset:7328
  ds_read_b64_tr_b16 v[22:23], v1 offset:10912
  v_mfma_f32_16x16x32_bf16 v[116:119], v[24:27], v[32:35], v[116:119]
  v_mfma_f32_16x16x32_bf16 v[120:123], v[24:27], v[36:39], v[120:123]
  v_mfma_f32_16x16x32_bf16 v[124:127], v[24:27], v[40:43], v[124:127]
  v_mfma_f32_16x16x32_bf16 v[128:131], v[24:27], v[44:47], v[128:131]
  v_mfma_f32_16x16x32_bf16 v[132:135], v[24:27], v[48:51], v[132:135]
  s_add_u32 m0, s14, 49152
  s_add_u32 s10, s14, 446464
  buffer_load_dwordx4 v10, s[20:23], s10 offen offset:0 nt lds
  s_add_u32 s10, s14, 445568
  buffer_load_dwordx4 v10, s[20:23], s10 offen offset:1024 nt lds
  s_add_u32 s10, s14, 444672
  buffer_load_dwordx4 v10, s[20:23], s10 offen offset:2048 nt lds
  s_add_u32 s10, s14, 443776
  buffer_load_dwordx4 v10, s[20:23], s10 offen offset:3072 nt lds
  s_waitcnt lgkmcnt(0) vmcnt(4)
  s_barrier
  v_mfma_f32_16x16x32_bf16 v[136:139], v[24:27], v[52:55], v[136:139]
  v_mfma_f32_16x16x32_bf16 v[140:143], v[24:27], v[56:59], v[140:143]
  ds_read_b64_tr_b16 v[24:25], v1 offset:7360
  ds_read_b64_tr_b16 v[26:27], v1 offset:10944
  v_mfma_f32_16x16x32_bf16 v[144:147], v[28:31], v[32:35], v[144:147]
  v_mfma_f32_16x16x32_bf16 v[148:151], v[28:31], v[36:39], v[148:151]
  v_mfma_f32_16x16x32_bf16 v[152:155], v[28:31], v[40:43], v[152:155]
  v_mfma_f32_16x16x32_bf16 v[156:159], v[28:31], v[44:47], v[156:159]
  v_mfma_f32_16x16x32_bf16 v[160:163], v[28:31], v[48:51], v[160:163]
  v_mfma_f32_16x16x32_bf16 v[164:167], v[28:31], v[52:55], v[164:167]
  v_mfma_f32_16x16x32_bf16 v[168:171], v[28:31], v[56:59], v[168:171]
  v_mfma_f32_16x16x32_bf16 v[172:175], v[16:19], v[32:35], v[172:175]
  s_waitcnt lgkmcnt(0)
  s_add_u32 s10, s46, 11
  s_and_b32 s10, s10, 7
  s_xor_b32 s10, s10, s45
  s_mul_i32 s15, s10, 28672
  s_add_u32 s15, s15, s13
  s_add_u32 s15, s15, 0
  s_add_u32 m0, s51, 7168
  s_nop 0
  buffer_load_dwordx4 v3, s[36:39], s15 offen offset:0 lds
  v_mfma_f32_16x16x32_bf16 v[176:179], v[16:19], v[36:39], v[176:179]
  s_add_u32 m0, s51, 7168
  s_nop 0
  buffer_load_dwordx4 v4, s[36:39], s15 offen offset:1024 lds
  v_mfma_f32_16x16x32_bf16 v[180:183], v[16:19], v[40:43], v[180:183]
  s_add_u32 m0, s51, 7168
  s_nop 0
  buffer_load_dwordx4 v5, s[36:39], s15 offen offset:2048 lds
  v_mfma_f32_16x16x32_bf16 v[184:187], v[16:19], v[44:47], v[184:187]
  s_add_u32 m0, s51, 7168
  s_nop 0
  buffer_load_dwordx4 v6, s[36:39], s15 offen offset:3072 lds
  v_mfma_f32_16x16x32_bf16 v[188:191], v[16:19], v[48:51], v[188:191]
  s_add_u32 m0, s51, 11264
  s_nop 0
  buffer_load_dwordx4 v7, s[36:39], s15 offen offset:0 lds
  v_mfma_f32_16x16x32_bf16 v[192:195], v[16:19], v[52:55], v[192:195]
  s_add_u32 m0, s51, 11264
  s_nop 0
  buffer_load_dwordx4 v8, s[36:39], s15 offen offset:1024 lds
  v_mfma_f32_16x16x32_bf16 v[196:199], v[16:19], v[56:59], v[196:199]
  s_add_u32 m0, s51, 11264
  s_nop 0
  buffer_load_dwordx4 v9, s[36:39], s15 offen offset:2048 lds
  v_mfma_f32_16x16x32_bf16 v[200:203], v[20:23], v[32:35], v[200:203]
  v_mfma_f32_16x16x32_bf16 v[204:207], v[20:23], v[36:39], v[204:207]
  v_mfma_f32_16x16x32_bf16 v[208:211], v[20:23], v[40:43], v[208:211]
  v_mfma_f32_16x16x32_bf16 v[212:215], v[20:23], v[44:47], v[212:215]
  s_add_u32 m0, s14, 65536
  s_add_u32 s10, s14, 462848
  buffer_load_dwordx4 v10, s[20:23], s10 offen offset:0 nt lds
  s_add_u32 s10, s14, 461952
  buffer_load_dwordx4 v10, s[20:23], s10 offen offset:1024 nt lds
  s_add_u32 s10, s14, 461056
  buffer_load_dwordx4 v10, s[20:23], s10 offen offset:2048 nt lds
  s_add_u32 s10, s14, 460160
  buffer_load_dwordx4 v10, s[20:23], s10 offen offset:3072 nt lds
  s_waitcnt lgkmcnt(0) vmcnt(11)
  s_barrier
  v_mfma_f32_16x16x32_bf16 v[216:219], v[20:23], v[48:51], v[216:219]
  v_mfma_f32_16x16x32_bf16 v[220:223], v[20:23], v[52:55], v[220:223]
  v_mfma_f32_16x16x32_bf16 v[224:227], v[20:23], v[56:59], v[224:227]
  v_mfma_f32_16x16x32_bf16 v[228:231], v[24:27], v[32:35], v[228:231]
  v_mfma_f32_16x16x32_bf16 v[232:235], v[24:27], v[36:39], v[232:235]
  v_mfma_f32_16x16x32_bf16 v[236:239], v[24:27], v[40:43], v[236:239]
  v_mfma_f32_16x16x32_bf16 v[240:243], v[24:27], v[44:47], v[240:243]
  v_mfma_f32_16x16x32_bf16 v[244:247], v[24:27], v[48:51], v[244:247]
  v_mfma_f32_16x16x32_bf16 v[248:251], v[24:27], v[52:55], v[248:251]
  v_mfma_f32_16x16x32_bf16 v[252:255], v[24:27], v[56:59], v[252:255]
  s_waitcnt vmcnt(19)
  ds_read_b64_tr_b16 v[16:17], v1 offset:0
  ds_read_b64_tr_b16 v[18:19], v1 offset:3584
  ds_read_b64_tr_b16 v[20:21], v1 offset:32
  ds_read_b64_tr_b16 v[22:23], v1 offset:3616
  ds_read_b64_tr_b16 v[24:25], v1 offset:64
  ds_read_b64_tr_b16 v[26:27], v1 offset:3648
  ds_read_b64_tr_b16 v[28:29], v1 offset:96
  ds_read_b64_tr_b16 v[30:31], v1 offset:3680
  ds_read_b128 v[32:35], v2 offset:0
  ds_read_b128 v[36:39], v2 offset:1024
  ds_read_b128 v[40:43], v2 offset:2048
  ds_read_b128 v[44:47], v2 offset:3072
  ds_read_b128 v[48:51], v2 offset:4096
  ds_read_b128 v[52:55], v2 offset:5120
  ds_read_b128 v[56:59], v2 offset:6144
  s_waitcnt lgkmcnt(13)
  s_waitcnt lgkmcnt(6)
  v_mfma_f32_16x16x32_bf16 v[60:63], v[16:19], v[32:35], v[60:63]
  s_waitcnt lgkmcnt(5)
  v_mfma_f32_16x16x32_bf16 v[64:67], v[16:19], v[36:39], v[64:67]
  s_waitcnt lgkmcnt(4)
  v_mfma_f32_16x16x32_bf16 v[68:71], v[16:19], v[40:43], v[68:71]
  s_waitcnt lgkmcnt(3)
  v_mfma_f32_16x16x32_bf16 v[72:75], v[16:19], v[44:47], v[72:75]
  s_waitcnt lgkmcnt(2)
  v_mfma_f32_16x16x32_bf16 v[76:79], v[16:19], v[48:51], v[76:79]
  s_waitcnt lgkmcnt(1)
  v_mfma_f32_16x16x32_bf16 v[80:83], v[16:19], v[52:55], v[80:83]
  s_waitcnt lgkmcnt(0)
  v_mfma_f32_16x16x32_bf16 v[84:87], v[16:19], v[56:59], v[84:87]
  ds_read_b64_tr_b16 v[16:17], v1 offset:128
  ds_read_b64_tr_b16 v[18:19], v1 offset:3712
  v_mfma_f32_16x16x32_bf16 v[88:91], v[20:23], v[32:35], v[88:91]
  v_mfma_f32_16x16x32_bf16 v[92:95], v[20:23], v[36:39], v[92:95]
  v_mfma_f32_16x16x32_bf16 v[96:99], v[20:23], v[40:43], v[96:99]
  v_mfma_f32_16x16x32_bf16 v[100:103], v[20:23], v[44:47], v[100:103]
  s_add_u32 m0, s14, 0
  s_add_u32 s10, s14, 479232
  buffer_load_dwordx4 v10, s[20:23], s10 offen offset:0 nt lds
  s_add_u32 s10, s14, 478336
  buffer_load_dwordx4 v10, s[20:23], s10 offen offset:1024 nt lds
  s_add_u32 s10, s14, 477440
  buffer_load_dwordx4 v10, s[20:23], s10 offen offset:2048 nt lds
  s_add_u32 s10, s14, 476544
  buffer_load_dwordx4 v10, s[20:23], s10 offen offset:3072 nt lds
  s_waitcnt lgkmcnt(0) vmcnt(4)
  s_barrier
  v_mfma_f32_16x16x32_bf16 v[104:107], v[20:23], v[48:51], v[104:107]
  v_mfma_f32_16x16x32_bf16 v[108:111], v[20:23], v[52:55], v[108:111]
  v_mfma_f32_16x16x32_bf16 v[112:115], v[20:23], v[56:59], v[112:115]
  ds_read_b64_tr_b16 v[20:21], v1 offset:160
  ds_read_b64_tr_b16 v[22:23], v1 offset:3744
  v_mfma_f32_16x16x32_bf16 v[116:119], v[24:27], v[32:35], v[116:119]
  v_mfma_f32_16x16x32_bf16 v[120:123], v[24:27], v[36:39], v[120:123]
  v_mfma_f32_16x16x32_bf16 v[124:127], v[24:27], v[40:43], v[124:127]
  v_mfma_f32_16x16x32_bf16 v[128:131], v[24:27], v[44:47], v[128:131]
  v_mfma_f32_16x16x32_bf16 v[132:135], v[24:27], v[48:51], v[132:135]
  v_mfma_f32_16x16x32_bf16 v[136:139], v[24:27], v[52:55], v[136:139]
  v_mfma_f32_16x16x32_bf16 v[140:143], v[24:27], v[56:59], v[140:143]
  ds_read_b64_tr_b16 v[24:25], v1 offset:192
  ds_read_b64_tr_b16 v[26:27], v1 offset:3776
  v_mfma_f32_16x16x32_bf16 v[144:147], v[28:31], v[32:35], v[144:147]
  v_mfma_f32_16x16x32_bf16 v[148:151], v[28:31], v[36:39], v[148:151]
  v_mfma_f32_16x16x32_bf16 v[152:155], v[28:31], v[40:43], v[152:155]
  v_mfma_f32_16x16x32_bf16 v[156:159], v[28:31], v[44:47], v[156:159]
  v_mfma_f32_16x16x32_bf16 v[160:163], v[28:31], v[48:51], v[160:163]
  v_mfma_f32_16x16x32_bf16 v[164:167], v[28:31], v[52:55], v[164:167]
  v_mfma_f32_16x16x32_bf16 v[168:171], v[28:31], v[56:59], v[168:171]
  v_mfma_f32_16x16x32_bf16 v[172:175], v[16:19], v[32:35], v[172:175]
  s_waitcnt lgkmcnt(0)
  s_add_u32 s10, s46, 12
  s_and_b32 s10, s10, 7
  s_xor_b32 s10, s10, s45
  s_mul_i32 s15, s10, 28672
  s_add_u32 s15, s15, s13
  s_add_u32 s15, s15, 0
  s_add_u32 m0, s51, 0
  s_nop 0
  buffer_load_dwordx4 v3, s[36:39], s15 offen offset:0 lds
  v_mfma_f32_16x16x32_bf16 v[176:179], v[16:19], v[36:39], v[176:179]
  s_add_u32 m0, s51, 0
  s_nop 0
  buffer_load_dwordx4 v4, s[36:39], s15 offen offset:1024 lds
  v_mfma_f32_16x16x32_bf16 v[180:183], v[16:19], v[40:43], v[180:183]
  s_add_u32 m0, s14, 16384
  s_add_u32 s10, s14, 495616
  buffer_load_dwordx4 v10, s[20:23], s10 offen offset:0 nt lds
  s_add_u32 s10, s14, 494720
  buffer_load_dwordx4 v10, s[20:23], s10 offen offset:1024 nt lds
  s_add_u32 s10, s14, 493824
  buffer_load_dwordx4 v10, s[20:23], s10 offen offset:2048 nt lds
  s_add_u32 s10, s14, 492928
  buffer_load_dwordx4 v10, s[20:23], s10 offen offset:3072 nt lds
  s_add_u32 m0, s51, 0
  s_nop 0
  buffer_load_dwordx4 v5, s[36:39], s15 offen offset:2048 lds
  s_waitcnt lgkmcnt(0) vmcnt(7)
  s_barrier
  v_mfma_f32_16x16x32_bf16 v[184:187], v[16:19], v[44:47], v[184:187]
  s_add_u32 m0, s51, 0
  s_nop 0
  buffer_load_dwordx4 v6, s[36:39], s15 offen offset:3072 lds
  v_mfma_f32_16x16x32_bf16 v[188:191], v[16:19], v[48:51], v[188:191]
  s_add_u32 m0, s51, 4096
  s_nop 0
  buffer_load_dwordx4 v7, s[36:39], s15 offen offset:0 lds
  v_mfma_f32_16x16x32_bf16 v[192:195], v[16:19], v[52:55], v[192:195]
  s_add_u32 m0, s51, 4096
  s_nop 0
  buffer_load_dwordx4 v8, s[36:39], s15 offen offset:1024 lds
  v_mfma_f32_16x16x32_bf16 v[196:199], v[16:19], v[56:59], v[196:199]
  s_add_u32 m0, s51, 4096
  s_nop 0
  buffer_load_dwordx4 v9, s[36:39], s15 offen offset:2048 lds
  v_mfma_f32_16x16x32_bf16 v[200:203], v[20:23], v[32:35], v[200:203]
  v_mfma_f32_16x16x32_bf16 v[204:207], v[20:23], v[36:39], v[204:207]
  v_mfma_f32_16x16x32_bf16 v[208:211], v[20:23], v[40:43], v[208:211]
  v_mfma_f32_16x16x32_bf16 v[212:215], v[20:23], v[44:47], v[212:215]
  v_mfma_f32_16x16x32_bf16 v[216:219], v[20:23], v[48:51], v[216:219]
  v_mfma_f32_16x16x32_bf16 v[220:223], v[20:23], v[52:55], v[220:223]
  v_mfma_f32_16x16x32_bf16 v[224:227], v[20:23], v[56:59], v[224:227]
  v_mfma_f32_16x16x32_bf16 v[228:231], v[24:27], v[32:35], v[228:231]
  v_mfma_f32_16x16x32_bf16 v[232:235], v[24:27], v[36:39], v[232:235]
  v_mfma_f32_16x16x32_bf16 v[236:239], v[24:27], v[40:43], v[236:239]
  v_mfma_f32_16x16x32_bf16 v[240:243], v[24:27], v[44:47], v[240:243]
  v_mfma_f32_16x16x32_bf16 v[244:247], v[24:27], v[48:51], v[244:247]
  v_mfma_f32_16x16x32_bf16 v[248:251], v[24:27], v[52:55], v[248:251]
  v_mfma_f32_16x16x32_bf16 v[252:255], v[24:27], v[56:59], v[252:255]
  s_waitcnt vmcnt(19)
  ds_read_b64_tr_b16 v[16:17], v1 offset:7168
  ds_read_b64_tr_b16 v[18:19], v1 offset:10752
  ds_read_b64_tr_b16 v[20:21], v1 offset:7200
  ds_read_b64_tr_b16 v[22:23], v1 offset:10784
  ds_read_b64_tr_b16 v[24:25], v1 offset:7232
  ds_read_b64_tr_b16 v[26:27], v1 offset:10816
  ds_read_b64_tr_b16 v[28:29], v1 offset:7264
  ds_read_b64_tr_b16 v[30:31], v1 offset:10848
  ds_read_b128 v[32:35], v2 offset:8192
  ds_read_b128 v[36:39], v2 offset:9216
  ds_read_b128 v[40:43], v2 offset:10240
  ds_read_b128 v[44:47], v2 offset:11264
  ds_read_b128 v[48:51], v2 offset:12288
  ds_read_b128 v[52:55], v2 offset:13312
  ds_read_b128 v[56:59], v2 offset:14336
  s_waitcnt lgkmcnt(13)
  s_waitcnt lgkmcnt(6)
  v_mfma_f32_16x16x32_bf16 v[60:63], v[16:19], v[32:35], v[60:63]
  s_waitcnt lgkmcnt(5)
  v_mfma_f32_16x16x32_bf16 v[64:67], v[16:19], v[36:39], v[64:67]
  s_waitcnt lgkmcnt(4)
  v_mfma_f32_16x16x32_bf16 v[68:71], v[16:19], v[40:43], v[68:71]
  s_add_u32 m0, s14, 32768
  s_add_u32 s10, s14, 512000
  buffer_load_dwordx4 v10, s[20:23], s10 offen offset:0 nt lds
  s_add_u32 s10, s14, 511104
  buffer_load_dwordx4 v10, s[20:23], s10 offen offset:1024 nt lds
  s_add_u32 s10, s14, 510208
  buffer_load_dwordx4 v10, s[20:23], s10 offen offset:2048 nt lds
  s_add_u32 s10, s14, 509312
  buffer_load_dwordx4 v10, s[20:23], s10 offen offset:3072 nt lds
  s_waitcnt lgkmcnt(3)
  s_waitcnt lgkmcnt(0) vmcnt(9)
  s_barrier
  v_mfma_f32_16x16x32_bf16 v[72:75], v[16:19], v[44:47], v[72:75]
  v_mfma_f32_16x16x32_bf16 v[76:79], v[16:19], v[48:51], v[76:79]
  v_mfma_f32_16x16x32_bf16 v[80:83], v[16:19], v[52:55], v[80:83]
  v_mfma_f32_16x16x32_bf16 v[84:87], v[16:19], v[56:59], v[84:87]
  ds_read_b64_tr_b16 v[16:17], v1 offset:7296
  ds_read_b64_tr_b16 v[18:19], v1 offset:10880
  v_mfma_f32_16x16x32_bf16 v[88:91], v[20:23], v[32:35], v[88:91]
  v_mfma_f32_16x16x32_bf16 v[92:95], v[20:23], v[36:39], v[92:95]
  v_mfma_f32_16x16x32_bf16 v[96:99], v[20:23], v[40:43], v[96:99]
  v_mfma_f32_16x16x32_bf16 v[100:103], v[20:23], v[44:47], v[100:103]
  v_mfma_f32_16x16x32_bf16 v[104:107], v[20:23], v[48:51], v[104:107]
  v_mfma_f32_16x16x32_bf16 v[108:111], v[20:23], v[52:55], v[108:111]
  v_mfma_f32_16x16x32_bf16 v[112:115], v[20:23], v[56:59], v[112:115]
  ds_read_b64_tr_b16 v[20:21], v1 offset:7328
  ds_read_b64_tr_b16 v[22:23], v1 offset:10912
  v_mfma_f32_16x16x32_bf16 v[116:119], v[24:27], v[32:35], v[116:119]
  v_mfma_f32_16x16x32_bf16 v[120:123], v[24:27], v[36:39], v[120:123]
  v_mfma_f32_16x16x32_bf16 v[124:127], v[24:27], v[40:43], v[124:127]
  v_mfma_f32_16x16x32_bf16 v[128:131], v[24:27], v[44:47], v[128:131]
  v_mfma_f32_16x16x32_bf16 v[132:135], v[24:27], v[48:51], v[132:135]
  v_mfma_f32_16x16x32_bf16 v[136:139], v[24:27], v[52:55], v[136:139]
  v_mfma_f32_16x16x32_bf16 v[140:143], v[24:27], v[56:59], v[140:143]
  ds_read_b64_tr_b16 v[24:25], v1 offset:7360
  ds_read_b64_tr_b16 v[26:27], v1 offset:10944
  v_mfma_f32_16x16x32_bf16 v[144:147], v[28:31], v[32:35], v[144:147]
  v_mfma_f32_16x16x32_bf16 v[148:151], v[28:31], v[36:39], v[148:151]
  v_mfma_f32_16x16x32_bf16 v[152:155], v[28:31], v[40:43], v[152:155]
  s_add_u32 m0, s14, 49152
  s_add_u32 s10, s56, 262144
  buffer_load_dwordx4 v13, s[24:27], s10 offen offset:0 nt lds
  s_add_u32 s10, s56, 265216
  buffer_load_dwordx4 v13, s[24:27], s10 offen offset:1024 nt lds
  s_add_u32 s10, s56, 268288
  buffer_load_dwordx4 v13, s[24:27], s10 offen offset:2048 nt lds
  s_add_u32 s10, s56, 271360
  buffer_load_dwordx4 v13, s[24:27], s10 offen offset:3072 nt lds
  s_waitcnt lgkmcnt(0) vmcnt(4)
  s_barrier
  v_mfma_f32_16x16x32_bf16 v[156:159], v[28:31], v[44:47], v[156:159]
  v_mfma_f32_16x16x32_bf16 v[160:163], v[28:31], v[48:51], v[160:163]
  v_mfma_f32_16x16x32_bf16 v[164:167], v[28:31], v[52:55], v[164:167]
  v_mfma_f32_16x16x32_bf16 v[168:171], v[28:31], v[56:59], v[168:171]
  v_mfma_f32_16x16x32_bf16 v[172:175], v[16:19], v[32:35], v[172:175]
  s_add_u32 s10, s46, 13
  s_and_b32 s10, s10, 7
  s_xor_b32 s10, s10, s45
  s_mul_i32 s15, s10, 28672
  s_add_u32 s15, s15, s13
  s_add_u32 s15, s15, 0
  s_add_u32 m0, s51, 7168
  s_nop 0
  buffer_load_dwordx4 v3, s[36:39], s15 offen offset:0 lds
  v_mfma_f32_16x16x32_bf16 v[176:179], v[16:19], v[36:39], v[176:179]
  s_add_u32 m0, s51, 7168
  s_nop 0
  buffer_load_dwordx4 v4, s[36:39], s15 offen offset:1024 lds
  v_mfma_f32_16x16x32_bf16 v[180:183], v[16:19], v[40:43], v[180:183]
  s_add_u32 m0, s51, 7168
  s_nop 0
  buffer_load_dwordx4 v5, s[36:39], s15 offen offset:2048 lds
  v_mfma_f32_16x16x32_bf16 v[184:187], v[16:19], v[44:47], v[184:187]
  s_add_u32 m0, s51, 7168
  s_nop 0
  buffer_load_dwordx4 v6, s[36:39], s15 offen offset:3072 lds
  v_mfma_f32_16x16x32_bf16 v[188:191], v[16:19], v[48:51], v[188:191]
  s_add_u32 m0, s51, 11264
  s_nop 0
  buffer_load_dwordx4 v7, s[36:39], s15 offen offset:0 lds
  v_mfma_f32_16x16x32_bf16 v[192:195], v[16:19], v[52:55], v[192:195]
  s_add_u32 m0, s51, 11264
  s_nop 0
  buffer_load_dwordx4 v8, s[36:39], s15 offen offset:1024 lds
  v_mfma_f32_16x16x32_bf16 v[196:199], v[16:19], v[56:59], v[196:199]
  s_add_u32 m0, s51, 11264
  s_nop 0
  buffer_load_dwordx4 v9, s[36:39], s15 offen offset:2048 lds
  v_mfma_f32_16x16x32_bf16 v[200:203], v[20:23], v[32:35], v[200:203]
  v_mfma_f32_16x16x32_bf16 v[204:207], v[20:23], v[36:39], v[204:207]
  v_mfma_f32_16x16x32_bf16 v[208:211], v[20:23], v[40:43], v[208:211]
  v_mfma_f32_16x16x32_bf16 v[212:215], v[20:23], v[44:47], v[212:215]
  v_mfma_f32_16x16x32_bf16 v[216:219], v[20:23], v[48:51], v[216:219]
  v_mfma_f32_16x16x32_bf16 v[220:223], v[20:23], v[52:55], v[220:223]
  v_mfma_f32_16x16x32_bf16 v[224:227], v[20:23], v[56:59], v[224:227]
  v_mfma_f32_16x16x32_bf16 v[228:231], v[24:27], v[32:35], v[228:231]
  v_mfma_f32_16x16x32_bf16 v[232:235], v[24:27], v[36:39], v[232:235]
  s_add_u32 m0, s14, 65536
  s_add_u32 s10, s56, 327680
  buffer_load_dwordx4 v13, s[24:27], s10 offen offset:0 nt lds
  s_add_u32 s10, s56, 330752
  buffer_load_dwordx4 v13, s[24:27], s10 offen offset:1024 nt lds
  s_add_u32 s10, s56, 333824
  buffer_load_dwordx4 v13, s[24:27], s10 offen offset:2048 nt lds
  s_add_u32 s10, s56, 336896
  buffer_load_dwordx4 v13, s[24:27], s10 offen offset:3072 nt lds
  s_waitcnt lgkmcnt(0) vmcnt(11)
  s_barrier
  v_mfma_f32_16x16x32_bf16 v[236:239], v[24:27], v[40:43], v[236:239]
  v_mfma_f32_16x16x32_bf16 v[240:243], v[24:27], v[44:47], v[240:243]
  v_mfma_f32_16x16x32_bf16 v[244:247], v[24:27], v[48:51], v[244:247]
  v_mfma_f32_16x16x32_bf16 v[248:251], v[24:27], v[52:55], v[248:251]
  v_mfma_f32_16x16x32_bf16 v[252:255], v[24:27], v[56:59], v[252:255]
  s_waitcnt vmcnt(19)
  ds_read_b64_tr_b16 v[16:17], v1 offset:0
  ds_read_b64_tr_b16 v[18:19], v1 offset:3584
  ds_read_b64_tr_b16 v[20:21], v1 offset:32
  ds_read_b64_tr_b16 v[22:23], v1 offset:3616
  ds_read_b64_tr_b16 v[24:25], v1 offset:64
  ds_read_b64_tr_b16 v[26:27], v1 offset:3648
  ds_read_b64_tr_b16 v[28:29], v1 offset:96
  ds_read_b64_tr_b16 v[30:31], v1 offset:3680
  ds_read_b128 v[32:35], v2 offset:0
  ds_read_b128 v[36:39], v2 offset:1024
  ds_read_b128 v[40:43], v2 offset:2048
  ds_read_b128 v[44:47], v2 offset:3072
  ds_read_b128 v[48:51], v2 offset:4096
  ds_read_b128 v[52:55], v2 offset:5120
  ds_read_b128 v[56:59], v2 offset:6144
  s_waitcnt lgkmcnt(13)
  s_waitcnt lgkmcnt(6)
  v_mfma_f32_16x16x32_bf16 v[60:63], v[16:19], v[32:35], v[60:63]
  s_waitcnt lgkmcnt(5)
  v_mfma_f32_16x16x32_bf16 v[64:67], v[16:19], v[36:39], v[64:67]
  s_waitcnt lgkmcnt(4)
  v_mfma_f32_16x16x32_bf16 v[68:71], v[16:19], v[40:43], v[68:71]
  s_waitcnt lgkmcnt(3)
  v_mfma_f32_16x16x32_bf16 v[72:75], v[16:19], v[44:47], v[72:75]
  s_waitcnt lgkmcnt(2)
  v_mfma_f32_16x16x32_bf16 v[76:79], v[16:19], v[48:51], v[76:79]
  s_waitcnt lgkmcnt(1)
  v_mfma_f32_16x16x32_bf16 v[80:83], v[16:19], v[52:55], v[80:83]
  s_waitcnt lgkmcnt(0)
  v_mfma_f32_16x16x32_bf16 v[84:87], v[16:19], v[56:59], v[84:87]
  ds_read_b64_tr_b16 v[16:17], v1 offset:128
  ds_read_b64_tr_b16 v[18:19], v1 offset:3712
  v_mfma_f32_16x16x32_bf16 v[88:91], v[20:23], v[32:35], v[88:91]
  v_mfma_f32_16x16x32_bf16 v[92:95], v[20:23], v[36:39], v[92:95]
  v_mfma_f32_16x16x32_bf16 v[96:99], v[20:23], v[40:43], v[96:99]
  v_mfma_f32_16x16x32_bf16 v[100:103], v[20:23], v[44:47], v[100:103]
  v_mfma_f32_16x16x32_bf16 v[104:107], v[20:23], v[48:51], v[104:107]
  v_mfma_f32_16x16x32_bf16 v[108:111], v[20:23], v[52:55], v[108:111]
  v_mfma_f32_16x16x32_bf16 v[112:115], v[20:23], v[56:59], v[112:115]
  ds_read_b64_tr_b16 v[20:21], v1 offset:160
  ds_read_b64_tr_b16 v[22:23], v1 offset:3744
  v_mfma_f32_16x16x32_bf16 v[116:119], v[24:27], v[32:35], v[116:119]
  v_mfma_f32_16x16x32_bf16 v[120:123], v[24:27], v[36:39], v[120:123]
  s_add_u32 m0, s14, 0
  s_add_u32 s10, s56, 393216
  buffer_load_dwordx4 v13, s[24:27], s10 offen offset:0 nt lds
  s_add_u32 s10, s56, 396288
  buffer_load_dwordx4 v13, s[24:27], s10 offen offset:1024 nt lds
  s_add_u32 s10, s56, 399360
  buffer_load_dwordx4 v13, s[24:27], s10 offen offset:2048 nt lds
  s_add_u32 s10, s56, 402432
  buffer_load_dwordx4 v13, s[24:27], s10 offen offset:3072 nt lds
  s_waitcnt lgkmcnt(0) vmcnt(4)
  s_barrier
  v_mfma_f32_16x16x32_bf16 v[124:127], v[24:27], v[40:43], v[124:127]
  v_mfma_f32_16x16x32_bf16 v[128:131], v[24:27], v[44:47], v[128:131]
  v_mfma_f32_16x16x32_bf16 v[132:135], v[24:27], v[48:51], v[132:135]
  v_mfma_f32_16x16x32_bf16 v[136:139], v[24:27], v[52:55], v[136:139]
  v_mfma_f32_16x16x32_bf16 v[140:143], v[24:27], v[56:59], v[140:143]
  ds_read_b64_tr_b16 v[24:25], v1 offset:192
  ds_read_b64_tr_b16 v[26:27], v1 offset:3776
  v_mfma_f32_16x16x32_bf16 v[144:147], v[28:31], v[32:35], v[144:147]
  v_mfma_f32_16x16x32_bf16 v[148:151], v[28:31], v[36:39], v[148:151]
  v_mfma_f32_16x16x32_bf16 v[152:155], v[28:31], v[40:43], v[152:155]
  v_mfma_f32_16x16x32_bf16 v[156:159], v[28:31], v[44:47], v[156:159]
  v_mfma_f32_16x16x32_bf16 v[160:163], v[28:31], v[48:51], v[160:163]
  v_mfma_f32_16x16x32_bf16 v[164:167], v[28:31], v[52:55], v[164:167]
  v_mfma_f32_16x16x32_bf16 v[168:171], v[28:31], v[56:59], v[168:171]
  v_mfma_f32_16x16x32_bf16 v[172:175], v[16:19], v[32:35], v[172:175]
  s_waitcnt lgkmcnt(0)
  s_add_u32 s10, s46, 8
  s_and_b32 s10, s10, 7
  s_xor_b32 s10, s10, s45
  s_mul_i32 s15, s10, 28672
  s_add_u32 s15, s15, s13
  s_add_u32 s15, s15, 229376
  s_add_u32 m0, s51, 0
  s_nop 0
  buffer_load_dwordx4 v3, s[36:39], s15 offen offset:0 lds
  v_mfma_f32_16x16x32_bf16 v[176:179], v[16:19], v[36:39], v[176:179]
  s_add_u32 m0, s51, 0
  s_nop 0
  buffer_load_dwordx4 v4, s[36:39], s15 offen offset:1024 lds
  v_mfma_f32_16x16x32_bf16 v[180:183], v[16:19], v[40:43], v[180:183]
  s_add_u32 m0, s51, 0
  s_nop 0
  buffer_load_dwordx4 v5, s[36:39], s15 offen offset:2048 lds
  v_mfma_f32_16x16x32_bf16 v[184:187], v[16:19], v[44:47], v[184:187]
  s_add_u32 m0, s51, 0
  s_nop 0
  buffer_load_dwordx4 v6, s[36:39], s15 offen offset:3072 lds
  v_mfma_f32_16x16x32_bf16 v[188:191], v[16:19], v[48:51], v[188:191]
  s_add_u32 m0, s51, 4096
  s_nop 0
  buffer_load_dwordx4 v7, s[36:39], s15 offen offset:0 lds
  v_mfma_f32_16x16x32_bf16 v[192:195], v[16:19], v[52:55], v[192:195]
  s_add_u32 m0, s51, 4096
  s_nop 0
  buffer_load_dwordx4 v8, s[36:39], s15 offen offset:1024 lds
  v_mfma_f32_16x16x32_bf16 v[196:199], v[16:19], v[56:59], v[196:199]
  s_add_u32 m0, s51, 4096
  s_nop 0
  buffer_load_dwordx4 v9, s[36:39], s15 offen offset:2048 lds
  v_mfma_f32_16x16x32_bf16 v[200:203], v[20:23], v[32:35], v[200:203]
  v_mfma_f32_16x16x32_bf16 v[204:207], v[20:23], v[36:39], v[204:207]
  s_add_u32 m0, s14, 16384
  s_add_u32 s10, s56, 458752
  buffer_load_dwordx4 v13, s[24:27], s10 offen offset:0 nt lds
  s_add_u32 s10, s56, 461824
  buffer_load_dwordx4 v13, s[24:27], s10 offen offset:1024 nt lds
  s_add_u32 s10, s56, 464896
  buffer_load_dwordx4 v13, s[24:27], s10 offen offset:2048 nt lds
  s_add_u32 s10, s56, 467968
  buffer_load_dwordx4 v13, s[24:27], s10 offen offset:3072 nt lds
  s_waitcnt lgkmcnt(0) vmcnt(11)
  s_barrier
  v_mfma_f32_16x16x32_bf16 v[208:211], v[20:23], v[40:43], v[208:211]
  v_mfma_f32_16x16x32_bf16 v[212:215], v[20:23], v[44:47], v[212:215]
  v_mfma_f32_16x16x32_bf16 v[216:219], v[20:23], v[48:51], v[216:219]
  v_mfma_f32_16x16x32_bf16 v[220:223], v[20:23], v[52:55], v[220:223]
  v_mfma_f32_16x16x32_bf16 v[224:227], v[20:23], v[56:59], v[224:227]
  v_mfma_f32_16x16x32_bf16 v[228:231], v[24:27], v[32:35], v[228:231]
  v_mfma_f32_16x16x32_bf16 v[232:235], v[24:27], v[36:39], v[232:235]
  v_mfma_f32_16x16x32_bf16 v[236:239], v[24:27], v[40:43], v[236:239]
  v_mfma_f32_16x16x32_bf16 v[240:243], v[24:27], v[44:47], v[240:243]
  v_mfma_f32_16x16x32_bf16 v[244:247], v[24:27], v[48:51], v[244:247]
  v_mfma_f32_16x16x32_bf16 v[248:251], v[24:27], v[52:55], v[248:251]
  v_mfma_f32_16x16x32_bf16 v[252:255], v[24:27], v[56:59], v[252:255]
  s_waitcnt vmcnt(19)
  ds_read_b64_tr_b16 v[16:17], v1 offset:7168
  ds_read_b64_tr_b16 v[18:19], v1 offset:10752
  ds_read_b64_tr_b16 v[20:21], v1 offset:7200
  ds_read_b64_tr_b16 v[22:23], v1 offset:10784
  ds_read_b64_tr_b16 v[24:25], v1 offset:7232
  ds_read_b64_tr_b16 v[26:27], v1 offset:10816
  ds_read_b64_tr_b16 v[28:29], v1 offset:7264
  ds_read_b64_tr_b16 v[30:31], v1 offset:10848
  ds_read_b128 v[32:35], v2 offset:8192
  ds_read_b128 v[36:39], v2 offset:9216
  ds_read_b128 v[40:43], v2 offset:10240
  ds_read_b128 v[44:47], v2 offset:11264
  ds_read_b128 v[48:51], v2 offset:12288
  ds_read_b128 v[52:55], v2 offset:13312
  ds_read_b128 v[56:59], v2 offset:14336
  s_waitcnt lgkmcnt(13)
  s_waitcnt lgkmcnt(6)
  v_mfma_f32_16x16x32_bf16 v[60:63], v[16:19], v[32:35], v[60:63]
  s_waitcnt lgkmcnt(5)
  v_mfma_f32_16x16x32_bf16 v[64:67], v[16:19], v[36:39], v[64:67]
  s_waitcnt lgkmcnt(4)
  v_mfma_f32_16x16x32_bf16 v[68:71], v[16:19], v[40:43], v[68:71]
  s_waitcnt lgkmcnt(3)
  v_mfma_f32_16x16x32_bf16 v[72:75], v[16:19], v[44:47], v[72:75]
  s_waitcnt lgkmcnt(2)
  v_mfma_f32_16x16x32_bf16 v[76:79], v[16:19], v[48:51], v[76:79]
  s_waitcnt lgkmcnt(1)
  v_mfma_f32_16x16x32_bf16 v[80:83], v[16:19], v[52:55], v[80:83]
  s_waitcnt lgkmcnt(0)
  v_mfma_f32_16x16x32_bf16 v[84:87], v[16:19], v[56:59], v[84:87]
  ds_read_b64_tr_b16 v[16:17], v1 offset:7296
  ds_read_b64_tr_b16 v[18:19], v1 offset:10880
  v_mfma_f32_16x16x32_bf16 v[88:91], v[20:23], v[32:35], v[88:91]
  s_add_u32 m0, s14, 32768
  s_add_u32 s10, s57, 262144
  buffer_load_dwordx4 v13, s[24:27], s10 offen offset:0 nt lds
  s_add_u32 s10, s57, 265216
  buffer_load_dwordx4 v13, s[24:27], s10 offen offset:1024 nt lds
  s_add_u32 s10, s57, 268288
  buffer_load_dwordx4 v13, s[24:27], s10 offen offset:2048 nt lds
  s_add_u32 s10, s57, 271360
  buffer_load_dwordx4 v13, s[24:27], s10 offen offset:3072 nt lds
  s_waitcnt lgkmcnt(0) vmcnt(4)
  s_barrier
  v_mfma_f32_16x16x32_bf16 v[92:95], v[20:23], v[36:39], v[92:95]
  v_mfma_f32_16x16x32_bf16 v[96:99], v[20:23], v[40:43], v[96:99]
  v_mfma_f32_16x16x32_bf16 v[100:103], v[20:23], v[44:47], v[100:103]
  v_mfma_f32_16x16x32_bf16 v[104:107], v[20:23], v[48:51], v[104:107]
  v_mfma_f32_16x16x32_bf16 v[108:111], v[20:23], v[52:55], v[108:111]
  v_mfma_f32_16x16x32_bf16 v[112:115], v[20:23], v[56:59], v[112:115]
  ds_read_b64_tr_b16 v[20:21], v1 offset:7328
  ds_read_b64_tr_b16 v[22:23], v1 offset:10912
  v_mfma_f32_16x16x32_bf16 v[116:119], v[24:27], v[32:35], v[116:119]
  v_mfma_f32_16x16x32_bf16 v[120:123], v[24:27], v[36:39], v[120:123]
  v_mfma_f32_16x16x32_bf16 v[124:127], v[24:27], v[40:43], v[124:127]
  v_mfma_f32_16x16x32_bf16 v[128:131], v[24:27], v[44:47], v[128:131]
  v_mfma_f32_16x16x32_bf16 v[132:135], v[24:27], v[48:51], v[132:135]
  v_mfma_f32_16x16x32_bf16 v[136:139], v[24:27], v[52:55], v[136:139]
  v_mfma_f32_16x16x32_bf16 v[140:143], v[24:27], v[56:59], v[140:143]
  ds_read_b64_tr_b16 v[24:25], v1 offset:7360
  ds_read_b64_tr_b16 v[26:27], v1 offset:10944
  v_mfma_f32_16x16x32_bf16 v[144:147], v[28:31], v[32:35], v[144:147]
  v_mfma_f32_16x16x32_bf16 v[148:151], v[28:31], v[36:39], v[148:151]
  v_mfma_f32_16x16x32_bf16 v[152:155], v[28:31], v[40:43], v[152:155]
  v_mfma_f32_16x16x32_bf16 v[156:159], v[28:31], v[44:47], v[156:159]
  v_mfma_f32_16x16x32_bf16 v[160:163], v[28:31], v[48:51], v[160:163]
  v_mfma_f32_16x16x32_bf16 v[164:167], v[28:31], v[52:55], v[164:167]
  v_mfma_f32_16x16x32_bf16 v[168:171], v[28:31], v[56:59], v[168:171]
  v_mfma_f32_16x16x32_bf16 v[172:175], v[16:19], v[32:35], v[172:175]
  s_add_u32 m0, s14, 49152
  s_add_u32 s10, s57, 327680
  buffer_load_dwordx4 v13, s[24:27], s10 offen offset:0 nt lds
  s_add_u32 s10, s57, 330752
  buffer_load_dwordx4 v13, s[24:27], s10 offen offset:1024 nt lds
  s_add_u32 s10, s57, 333824
  buffer_load_dwordx4 v13, s[24:27], s10 offen offset:2048 nt lds
  s_add_u32 s10, s57, 336896
  buffer_load_dwordx4 v13, s[24:27], s10 offen offset:3072 nt lds
  s_waitcnt lgkmcnt(0)
  s_add_u32 s10, s46, 9
  s_and_b32 s10, s10, 7
  s_xor_b32 s10, s10, s45
  s_mul_i32 s15, s10, 28672
  s_add_u32 s15, s15, s13
  s_add_u32 s15, s15, 229376
  s_add_u32 m0, s51, 7168
  s_nop 0
  buffer_load_dwordx4 v3, s[36:39], s15 offen offset:0 lds
  s_waitcnt lgkmcnt(0) vmcnt(5)
  s_barrier
  v_mfma_f32_16x16x32_bf16 v[176:179], v[16:19], v[36:39], v[176:179]
  s_add_u32 m0, s51, 7168
  s_nop 0
  buffer_load_dwordx4 v4, s[36:39], s15 offen offset:1024 lds
  v_mfma_f32_16x16x32_bf16 v[180:183], v[16:19], v[40:43], v[180:183]
  s_add_u32 m0, s51, 7168
  s_nop 0
  buffer_load_dwordx4 v5, s[36:39], s15 offen offset:2048 lds
  v_mfma_f32_16x16x32_bf16 v[184:187], v[16:19], v[44:47], v[184:187]
  s_add_u32 m0, s51, 7168
  s_nop 0
  buffer_load_dwordx4 v6, s[36:39], s15 offen offset:3072 lds
  v_mfma_f32_16x16x32_bf16 v[188:191], v[16:19], v[48:51], v[188:191]
  s_add_u32 m0, s51, 11264
  s_nop 0
  buffer_load_dwordx4 v7, s[36:39], s15 offen offset:0 lds
  v_mfma_f32_16x16x32_bf16 v[192:195], v[16:19], v[52:55], v[192:195]
  s_add_u32 m0, s51, 11264
  s_nop 0
  buffer_load_dwordx4 v8, s[36:39], s15 offen offset:1024 lds
  v_mfma_f32_16x16x32_bf16 v[196:199], v[16:19], v[56:59], v[196:199]
  s_add_u32 m0, s51, 11264
  s_nop 0
  buffer_load_dwordx4 v9, s[36:39], s15 offen offset:2048 lds
  v_mfma_f32_16x16x32_bf16 v[200:203], v[20:23], v[32:35], v[200:203]
  v_mfma_f32_16x16x32_bf16 v[204:207], v[20:23], v[36:39], v[204:207]
  v_mfma_f32_16x16x32_bf16 v[208:211], v[20:23], v[40:43], v[208:211]
  v_mfma_f32_16x16x32_bf16 v[212:215], v[20:23], v[44:47], v[212:215]
  v_mfma_f32_16x16x32_bf16 v[216:219], v[20:23], v[48:51], v[216:219]
  v_mfma_f32_16x16x32_bf16 v[220:223], v[20:23], v[52:55], v[220:223]
  v_mfma_f32_16x16x32_bf16 v[224:227], v[20:23], v[56:59], v[224:227]
  v_mfma_f32_16x16x32_bf16 v[228:231], v[24:27], v[32:35], v[228:231]
  v_mfma_f32_16x16x32_bf16 v[232:235], v[24:27], v[36:39], v[232:235]
  v_mfma_f32_16x16x32_bf16 v[236:239], v[24:27], v[40:43], v[236:239]
  v_mfma_f32_16x16x32_bf16 v[240:243], v[24:27], v[44:47], v[240:243]
  v_mfma_f32_16x16x32_bf16 v[244:247], v[24:27], v[48:51], v[244:247]
  v_mfma_f32_16x16x32_bf16 v[248:251], v[24:27], v[52:55], v[248:251]
  v_mfma_f32_16x16x32_bf16 v[252:255], v[24:27], v[56:59], v[252:255]
  s_add_u32 m0, s14, 65536
  s_add_u32 s10, s57, 393216
  buffer_load_dwordx4 v13, s[24:27], s10 offen offset:0 nt lds
  s_add_u32 s10, s57, 396288
  buffer_load_dwordx4 v13, s[24:27], s10 offen offset:1024 nt lds
  s_add_u32 s10, s57, 399360
  buffer_load_dwordx4 v13, s[24:27], s10 offen offset:2048 nt lds
  s_add_u32 s10, s57, 402432
  buffer_load_dwordx4 v13, s[24:27], s10 offen offset:3072 nt lds
  s_waitcnt lgkmcnt(0) vmcnt(11)
  s_barrier
  s_waitcnt vmcnt(23)
  ds_read_b64_tr_b16 v[16:17], v1 offset:0
  ds_read_b64_tr_b16 v[18:19], v1 offset:3584
  ds_read_b64_tr_b16 v[20:21], v1 offset:32
  ds_read_b64_tr_b16 v[22:23], v1 offset:3616
  ds_read_b64_tr_b16 v[24:25], v1 offset:64
  ds_read_b64_tr_b16 v[26:27], v1 offset:3648
  ds_read_b64_tr_b16 v[28:29], v1 offset:96
  ds_read_b64_tr_b16 v[30:31], v1 offset:3680
  ds_read_b128 v[32:35], v2 offset:0
  ds_read_b128 v[36:39], v2 offset:1024
  ds_read_b128 v[40:43], v2 offset:2048
  ds_read_b128 v[44:47], v2 offset:3072
  ds_read_b128 v[48:51], v2 offset:4096
  ds_read_b128 v[52:55], v2 offset:5120
  ds_read_b128 v[56:59], v2 offset:6144
  s_waitcnt lgkmcnt(13)
  s_waitcnt lgkmcnt(6)
  v_mfma_f32_16x16x32_bf16 v[60:63], v[16:19], v[32:35], v[60:63]
  s_waitcnt lgkmcnt(5)
  v_mfma_f32_16x16x32_bf16 v[64:67], v[16:19], v[36:39], v[64:67]
  s_waitcnt lgkmcnt(4)
  v_mfma_f32_16x16x32_bf16 v[68:71], v[16:19], v[40:43], v[68:71]
  s_waitcnt lgkmcnt(3)
  v_mfma_f32_16x16x32_bf16 v[72:75], v[16:19], v[44:47], v[72:75]
  s_waitcnt lgkmcnt(2)
  v_mfma_f32_16x16x32_bf16 v[76:79], v[16:19], v[48:51], v[76:79]
  s_waitcnt lgkmcnt(1)
  v_mfma_f32_16x16x32_bf16 v[80:83], v[16:19], v[52:55], v[80:83]
  s_waitcnt lgkmcnt(0)
  v_mfma_f32_16x16x32_bf16 v[84:87], v[16:19], v[56:59], v[84:87]
  ds_read_b64_tr_b16 v[16:17], v1 offset:128
  ds_read_b64_tr_b16 v[18:19], v1 offset:3712
  v_mfma_f32_16x16x32_bf16 v[88:91], v[20:23], v[32:35], v[88:91]
  v_mfma_f32_16x16x32_bf16 v[92:95], v[20:23], v[36:39], v[92:95]
  v_mfma_f32_16x16x32_bf16 v[96:99], v[20:23], v[40:43], v[96:99]
  v_mfma_f32_16x16x32_bf16 v[100:103], v[20:23], v[44:47], v[100:103]
  v_mfma_f32_16x16x32_bf16 v[104:107], v[20:23], v[48:51], v[104:107]
  s_add_u32 m0, s14, 0
  s_add_u32 s10, s57, 458752
  buffer_load_dwordx4 v13, s[24:27], s10 offen offset:0 nt lds
  s_add_u32 s10, s57, 461824
  buffer_load_dwordx4 v13, s[24:27], s10 offen offset:1024 nt lds
  s_add_u32 s10, s57, 464896
  buffer_load_dwordx4 v13, s[24:27], s10 offen offset:2048 nt lds
  s_add_u32 s10, s57, 467968
  buffer_load_dwordx4 v13, s[24:27], s10 offen offset:3072 nt lds
  v_mfma_f32_16x16x32_bf16 v[108:111], v[20:23], v[52:55], v[108:111]
  v_mfma_f32_16x16x32_bf16 v[112:115], v[20:23], v[56:59], v[112:115]
  ds_read_b64_tr_b16 v[20:21], v1 offset:160
  ds_read_b64_tr_b16 v[22:23], v1 offset:3744
  v_mfma_f32_16x16x32_bf16 v[116:119], v[24:27], v[32:35], v[116:119]
  v_mfma_f32_16x16x32_bf16 v[120:123], v[24:27], v[36:39], v[120:123]
  v_mfma_f32_16x16x32_bf16 v[124:127], v[24:27], v[40:43], v[124:127]
  v_mfma_f32_16x16x32_bf16 v[128:131], v[24:27], v[44:47], v[128:131]
  v_mfma_f32_16x16x32_bf16 v[132:135], v[24:27], v[48:51], v[132:135]
  v_mfma_f32_16x16x32_bf16 v[136:139], v[24:27], v[52:55], v[136:139]
  s_waitcnt lgkmcnt(0) vmcnt(4)
  s_barrier
  v_mfma_f32_16x16x32_bf16 v[140:143], v[24:27], v[56:59], v[140:143]
  ds_read_b64_tr_b16 v[24:25], v1 offset:192
  ds_read_b64_tr_b16 v[26:27], v1 offset:3776
  v_mfma_f32_16x16x32_bf16 v[144:147], v[28:31], v[32:35], v[144:147]
  v_mfma_f32_16x16x32_bf16 v[148:151], v[28:31], v[36:39], v[148:151]
  v_mfma_f32_16x16x32_bf16 v[152:155], v[28:31], v[40:43], v[152:155]
  v_mfma_f32_16x16x32_bf16 v[156:159], v[28:31], v[44:47], v[156:159]
  v_mfma_f32_16x16x32_bf16 v[160:163], v[28:31], v[48:51], v[160:163]
  v_mfma_f32_16x16x32_bf16 v[164:167], v[28:31], v[52:55], v[164:167]
  v_mfma_f32_16x16x32_bf16 v[168:171], v[28:31], v[56:59], v[168:171]
  v_mfma_f32_16x16x32_bf16 v[172:175], v[16:19], v[32:35], v[172:175]
  s_waitcnt lgkmcnt(0)
  s_add_u32 s10, s46, 10
  s_and_b32 s10, s10, 7
  s_xor_b32 s10, s10, s45
  s_mul_i32 s15, s10, 28672
  s_add_u32 s15, s15, s13
  s_add_u32 s15, s15, 229376
  s_add_u32 m0, s51, 0
  s_nop 0
  buffer_load_dwordx4 v3, s[36:39], s15 offen offset:0 lds
  v_mfma_f32_16x16x32_bf16 v[176:179], v[16:19], v[36:39], v[176:179]
  s_add_u32 m0, s51, 0
  s_nop 0
  buffer_load_dwordx4 v4, s[36:39], s15 offen offset:1024 lds
  v_mfma_f32_16x16x32_bf16 v[180:183], v[16:19], v[40:43], v[180:183]
  s_add_u32 m0, s51, 0
  s_nop 0
  buffer_load_dwordx4 v5, s[36:39], s15 offen offset:2048 lds
  v_mfma_f32_16x16x32_bf16 v[184:187], v[16:19], v[44:47], v[184:187]
  s_add_u32 m0, s51, 0
  s_nop 0
  buffer_load_dwordx4 v6, s[36:39], s15 offen offset:3072 lds
  v_mfma_f32_16x16x32_bf16 v[188:191], v[16:19], v[48:51], v[188:191]
  s_add_u32 m0, s51, 4096
  s_nop 0
  buffer_load_dwordx4 v7, s[36:39], s15 offen offset:0 lds
  v_mfma_f32_16x16x32_bf16 v[192:195], v[16:19], v[52:55], v[192:195]
  s_add_u32 m0, s51, 4096
  s_nop 0
  buffer_load_dwordx4 v8, s[36:39], s15 offen offset:1024 lds
  v_mfma_f32_16x16x32_bf16 v[196:199], v[16:19], v[56:59], v[196:199]
  s_add_u32 m0, s51, 4096
  s_nop 0
  buffer_load_dwordx4 v9, s[36:39], s15 offen offset:2048 lds
  v_mfma_f32_16x16x32_bf16 v[200:203], v[20:23], v[32:35], v[200:203]
  s_add_u32 m0, s14, 16384
  s_add_u32 s10, s58, 262144
  buffer_load_dwordx4 v13, s[24:27], s10 offen offset:0 nt lds
  s_add_u32 s10, s58, 265216
  buffer_load_dwordx4 v13, s[24:27], s10 offen offset:1024 nt lds
  s_add_u32 s10, s58, 268288
  buffer_load_dwordx4 v13, s[24:27], s10 offen offset:2048 nt lds
  s_add_u32 s10, s58, 271360
  buffer_load_dwordx4 v13, s[24:27], s10 offen offset:3072 nt lds
  v_mfma_f32_16x16x32_bf16 v[204:207], v[20:23], v[36:39], v[204:207]
  v_mfma_f32_16x16x32_bf16 v[208:211], v[20:23], v[40:43], v[208:211]
  v_mfma_f32_16x16x32_bf16 v[212:215], v[20:23], v[44:47], v[212:215]
  v_mfma_f32_16x16x32_bf16 v[216:219], v[20:23], v[48:51], v[216:219]
  v_mfma_f32_16x16x32_bf16 v[220:223], v[20:23], v[52:55], v[220:223]
  v_mfma_f32_16x16x32_bf16 v[224:227], v[20:23], v[56:59], v[224:227]
  v_mfma_f32_16x16x32_bf16 v[228:231], v[24:27], v[32:35], v[228:231]
  v_mfma_f32_16x16x32_bf16 v[232:235], v[24:27], v[36:39], v[232:235]
  v_mfma_f32_16x16x32_bf16 v[236:239], v[24:27], v[40:43], v[236:239]
  v_mfma_f32_16x16x32_bf16 v[240:243], v[24:27], v[44:47], v[240:243]
  v_mfma_f32_16x16x32_bf16 v[244:247], v[24:27], v[48:51], v[244:247]
  s_waitcnt lgkmcnt(0) vmcnt(11)
  s_barrier
  v_mfma_f32_16x16x32_bf16 v[248:251], v[24:27], v[52:55], v[248:251]
  v_mfma_f32_16x16x32_bf16 v[252:255], v[24:27], v[56:59], v[252:255]
  s_waitcnt vmcnt(19)
  ds_read_b64_tr_b16 v[16:17], v1 offset:7168
  ds_read_b64_tr_b16 v[18:19], v1 offset:10752
  ds_read_b64_tr_b16 v[20:21], v1 offset:7200
  ds_read_b64_tr_b16 v[22:23], v1 offset:10784
  ds_read_b64_tr_b16 v[24:25], v1 offset:7232
  ds_read_b64_tr_b16 v[26:27], v1 offset:10816
  ds_read_b64_tr_b16 v[28:29], v1 offset:7264
  ds_read_b64_tr_b16 v[30:31], v1 offset:10848
  ds_read_b128 v[32:35], v2 offset:8192
  ds_read_b128 v[36:39], v2 offset:9216
  ds_read_b128 v[40:43], v2 offset:10240
  ds_read_b128 v[44:47], v2 offset:11264
  ds_read_b128 v[48:51], v2 offset:12288
  ds_read_b128 v[52:55], v2 offset:13312
  ds_read_b128 v[56:59], v2 offset:14336
  s_waitcnt lgkmcnt(13)
  s_waitcnt lgkmcnt(6)
  v_mfma_f32_16x16x32_bf16 v[60:63], v[16:19], v[32:35], v[60:63]
  s_waitcnt lgkmcnt(5)
  v_mfma_f32_16x16x32_bf16 v[64:67], v[16:19], v[36:39], v[64:67]
  s_waitcnt lgkmcnt(4)
  v_mfma_f32_16x16x32_bf16 v[68:71], v[16:19], v[40:43], v[68:71]
  s_waitcnt lgkmcnt(3)
  v_mfma_f32_16x16x32_bf16 v[72:75], v[16:19], v[44:47], v[72:75]
  s_waitcnt lgkmcnt(2)
  v_mfma_f32_16x16x32_bf16 v[76:79], v[16:19], v[48:51], v[76:79]
  s_waitcnt lgkmcnt(1)
  v_mfma_f32_16x16x32_bf16 v[80:83], v[16:19], v[52:55], v[80:83]
  s_waitcnt lgkmcnt(0)
  v_mfma_f32_16x16x32_bf16 v[84:87], v[16:19], v[56:59], v[84:87]
  ds_read_b64_tr_b16 v[16:17], v1 offset:7296
  ds_read_b64_tr_b16 v[18:19], v1 offset:10880
  v_mfma_f32_16x16x32_bf16 v[88:91], v[20:23], v[32:35], v[88:91]
  v_mfma_f32_16x16x32_bf16 v[92:95], v[20:23], v[36:39], v[92:95]
  v_mfma_f32_16x16x32_bf16 v[96:99], v[20:23], v[40:43], v[96:99]
  v_mfma_f32_16x16x32_bf16 v[100:103], v[20:23], v[44:47], v[100:103]
  v_mfma_f32_16x16x32_bf16 v[104:107], v[20:23], v[48:51], v[104:107]
  v_mfma_f32_16x16x32_bf16 v[108:111], v[20:23], v[52:55], v[108:111]
  s_add_u32 m0, s14, 32768
  s_add_u32 s10, s58, 327680
  buffer_load_dwordx4 v13, s[24:27], s10 offen offset:0 nt lds
  s_add_u32 s10, s58, 330752
  buffer_load_dwordx4 v13, s[24:27], s10 offen offset:1024 nt lds
  s_add_u32 s10, s58, 333824
  buffer_load_dwordx4 v13, s[24:27], s10 offen offset:2048 nt lds
  s_add_u32 s10, s58, 336896
  buffer_load_dwordx4 v13, s[24:27], s10 offen offset:3072 nt lds
  v_mfma_f32_16x16x32_bf16 v[112:115], v[20:23], v[56:59], v[112:115]
  ds_read_b64_tr_b16 v[20:21], v1 offset:7328
  ds_read_b64_tr_b16 v[22:23], v1 offset:10912
  v_mfma_f32_16x16x32_bf16 v[116:119], v[24:27], v[32:35], v[116:119]
  v_mfma_f32_16x16x32_bf16 v[120:123], v[24:27], v[36:39], v[120:123]
  v_mfma_f32_16x16x32_bf16 v[124:127], v[24:27], v[40:43], v[124:127]
  v_mfma_f32_16x16x32_bf16 v[128:131], v[24:27], v[44:47], v[128:131]
  v_mfma_f32_16x16x32_bf16 v[132:135], v[24:27], v[48:51], v[132:135]
  v_mfma_f32_16x16x32_bf16 v[136:139], v[24:27], v[52:55], v[136:139]
  v_mfma_f32_16x16x32_bf16 v[140:143], v[24:27], v[56:59], v[140:143]
  ds_read_b64_tr_b16 v[24:25], v1 offset:7360
  ds_read_b64_tr_b16 v[26:27], v1 offset:10944
  v_mfma_f32_16x16x32_bf16 v[144:147], v[28:31], v[32:35], v[144:147]
  v_mfma_f32_16x16x32_bf16 v[148:151], v[28:31], v[36:39], v[148:151]
  s_waitcnt lgkmcnt(0) vmcnt(4)
  s_barrier
  v_mfma_f32_16x16x32_bf16 v[152:155], v[28:31], v[40:43], v[152:155]
  v_mfma_f32_16x16x32_bf16 v[156:159], v[28:31], v[44:47], v[156:159]
  v_mfma_f32_16x16x32_bf16 v[160:163], v[28:31], v[48:51], v[160:163]
  v_mfma_f32_16x16x32_bf16 v[164:167], v[28:31], v[52:55], v[164:167]
  v_mfma_f32_16x16x32_bf16 v[168:171], v[28:31], v[56:59], v[168:171]
  v_mfma_f32_16x16x32_bf16 v[172:175], v[16:19], v[32:35], v[172:175]
  s_add_u32 s10, s46, 11
  s_and_b32 s10, s10, 7
  s_xor_b32 s10, s10, s45
  s_mul_i32 s15, s10, 28672
  s_add_u32 s15, s15, s13
  s_add_u32 s15, s15, 229376
  s_add_u32 m0, s51, 7168
  s_nop 0
  buffer_load_dwordx4 v3, s[36:39], s15 offen offset:0 lds
  v_mfma_f32_16x16x32_bf16 v[176:179], v[16:19], v[36:39], v[176:179]
  s_add_u32 m0, s51, 7168
  s_nop 0
  buffer_load_dwordx4 v4, s[36:39], s15 offen offset:1024 lds
  v_mfma_f32_16x16x32_bf16 v[180:183], v[16:19], v[40:43], v[180:183]
  s_add_u32 m0, s51, 7168
  s_nop 0
  buffer_load_dwordx4 v5, s[36:39], s15 offen offset:2048 lds
  v_mfma_f32_16x16x32_bf16 v[184:187], v[16:19], v[44:47], v[184:187]
  s_add_u32 m0, s51, 7168
  s_nop 0
  buffer_load_dwordx4 v6, s[36:39], s15 offen offset:3072 lds
  v_mfma_f32_16x16x32_bf16 v[188:191], v[16:19], v[48:51], v[188:191]
  s_add_u32 m0, s51, 11264
  s_nop 0
  buffer_load_dwordx4 v7, s[36:39], s15 offen offset:0 lds
  v_mfma_f32_16x16x32_bf16 v[192:195], v[16:19], v[52:55], v[192:195]
  s_add_u32 m0, s51, 11264
  s_nop 0
  buffer_load_dwordx4 v8, s[36:39], s15 offen offset:1024 lds
  v_mfma_f32_16x16x32_bf16 v[196:199], v[16:19], v[56:59], v[196:199]
  s_add_u32 m0, s51, 11264
  s_nop 0
  buffer_load_dwordx4 v9, s[36:39], s15 offen offset:2048 lds
  v_mfma_f32_16x16x32_bf16 v[200:203], v[20:23], v[32:35], v[200:203]
  v_mfma_f32_16x16x32_bf16 v[204:207], v[20:23], v[36:39], v[204:207]
  v_mfma_f32_16x16x32_bf16 v[208:211], v[20:23], v[40:43], v[208:211]
  s_add_u32 m0, s14, 49152
  s_add_u32 s10, s58, 393216
  buffer_load_dwordx4 v13, s[24:27], s10 offen offset:0 nt lds
  s_add_u32 s10, s58, 396288
  buffer_load_dwordx4 v13, s[24:27], s10 offen offset:1024 nt lds
  s_add_u32 s10, s58, 399360
  buffer_load_dwordx4 v13, s[24:27], s10 offen offset:2048 nt lds
  s_add_u32 s10, s58, 402432
  buffer_load_dwordx4 v13, s[24:27], s10 offen offset:3072 nt lds
  v_mfma_f32_16x16x32_bf16 v[212:215], v[20:23], v[44:47], v[212:215]
  v_mfma_f32_16x16x32_bf16 v[216:219], v[20:23], v[48:51], v[216:219]
  v_mfma_f32_16x16x32_bf16 v[220:223], v[20:23], v[52:55], v[220:223]
  v_mfma_f32_16x16x32_bf16 v[224:227], v[20:23], v[56:59], v[224:227]
  v_mfma_f32_16x16x32_bf16 v[228:231], v[24:27], v[32:35], v[228:231]
  v_mfma_f32_16x16x32_bf16 v[232:235], v[24:27], v[36:39], v[232:235]
  v_mfma_f32_16x16x32_bf16 v[236:239], v[24:27], v[40:43], v[236:239]
  v_mfma_f32_16x16x32_bf16 v[240:243], v[24:27], v[44:47], v[240:243]
  v_mfma_f32_16x16x32_bf16 v[244:247], v[24:27], v[48:51], v[244:247]
  v_mfma_f32_16x16x32_bf16 v[248:251], v[24:27], v[52:55], v[248:251]
  v_mfma_f32_16x16x32_bf16 v[252:255], v[24:27], v[56:59], v[252:255]
  s_waitcnt lgkmcnt(0) vmcnt(11)
  s_barrier
  s_waitcnt vmcnt(19)
  ds_read_b64_tr_b16 v[16:17], v1 offset:0
  ds_read_b64_tr_b16 v[18:19], v1 offset:3584
  ds_read_b64_tr_b16 v[20:21], v1 offset:32
  ds_read_b64_tr_b16 v[22:23], v1 offset:3616
  ds_read_b64_tr_b16 v[24:25], v1 offset:64
  ds_read_b64_tr_b16 v[26:27], v1 offset:3648
  ds_read_b64_tr_b16 v[28:29], v1 offset:96
  ds_read_b64_tr_b16 v[30:31], v1 offset:3680
  ds_read_b128 v[32:35], v2 offset:0
  ds_read_b128 v[36:39], v2 offset:1024
  ds_read_b128 v[40:43], v2 offset:2048
  ds_read_b128 v[44:47], v2 offset:3072
  ds_read_b128 v[48:51], v2 offset:4096
  ds_read_b128 v[52:55], v2 offset:5120
  ds_read_b128 v[56:59], v2 offset:6144
  s_waitcnt lgkmcnt(13)
  s_waitcnt lgkmcnt(6)
  v_mfma_f32_16x16x32_bf16 v[60:63], v[16:19], v[32:35], v[60:63]
  s_waitcnt lgkmcnt(5)
  v_mfma_f32_16x16x32_bf16 v[64:67], v[16:19], v[36:39], v[64:67]
  s_waitcnt lgkmcnt(4)
  v_mfma_f32_16x16x32_bf16 v[68:71], v[16:19], v[40:43], v[68:71]
  s_waitcnt lgkmcnt(3)
  v_mfma_f32_16x16x32_bf16 v[72:75], v[16:19], v[44:47], v[72:75]
  s_waitcnt lgkmcnt(2)
  v_mfma_f32_16x16x32_bf16 v[76:79], v[16:19], v[48:51], v[76:79]
  s_waitcnt lgkmcnt(1)
  v_mfma_f32_16x16x32_bf16 v[80:83], v[16:19], v[52:55], v[80:83]
  s_waitcnt lgkmcnt(0)
  v_mfma_f32_16x16x32_bf16 v[84:87], v[16:19], v[56:59], v[84:87]
  ds_read_b64_tr_b16 v[16:17], v1 offset:128
  ds_read_b64_tr_b16 v[18:19], v1 offset:3712
  v_mfma_f32_16x16x32_bf16 v[88:91], v[20:23], v[32:35], v[88:91]
  v_mfma_f32_16x16x32_bf16 v[92:95], v[20:23], v[36:39], v[92:95]
  v_mfma_f32_16x16x32_bf16 v[96:99], v[20:23], v[40:43], v[96:99]
  v_mfma_f32_16x16x32_bf16 v[100:103], v[20:23], v[44:47], v[100:103]
  v_mfma_f32_16x16x32_bf16 v[104:107], v[20:23], v[48:51], v[104:107]
  s_add_u32 m0, s14, 65536
  s_add_u32 s10, s58, 458752
  buffer_load_dwordx4 v13, s[24:27], s10 offen offset:0 nt lds
  s_add_u32 s10, s58, 461824
  buffer_load_dwordx4 v13, s[24:27], s10 offen offset:1024 nt lds
  s_add_u32 s10, s58, 464896
  buffer_load_dwordx4 v13, s[24:27], s10 offen offset:2048 nt lds
  s_add_u32 s10, s58, 467968
  buffer_load_dwordx4 v13, s[24:27], s10 offen offset:3072 nt lds
  v_mfma_f32_16x16x32_bf16 v[108:111], v[20:23], v[52:55], v[108:111]
  v_mfma_f32_16x16x32_bf16 v[112:115], v[20:23], v[56:59], v[112:115]
  ds_read_b64_tr_b16 v[20:21], v1 offset:160
  ds_read_b64_tr_b16 v[22:23], v1 offset:3744
  v_mfma_f32_16x16x32_bf16 v[116:119], v[24:27], v[32:35], v[116:119]
  v_mfma_f32_16x16x32_bf16 v[120:123], v[24:27], v[36:39], v[120:123]
  v_mfma_f32_16x16x32_bf16 v[124:127], v[24:27], v[40:43], v[124:127]
  v_mfma_f32_16x16x32_bf16 v[128:131], v[24:27], v[44:47], v[128:131]
  v_mfma_f32_16x16x32_bf16 v[132:135], v[24:27], v[48:51], v[132:135]
  v_mfma_f32_16x16x32_bf16 v[136:139], v[24:27], v[52:55], v[136:139]
  s_waitcnt lgkmcnt(0) vmcnt(4)
  s_barrier
  v_mfma_f32_16x16x32_bf16 v[140:143], v[24:27], v[56:59], v[140:143]
  ds_read_b64_tr_b16 v[24:25], v1 offset:192
  ds_read_b64_tr_b16 v[26:27], v1 offset:3776
  v_mfma_f32_16x16x32_bf16 v[144:147], v[28:31], v[32:35], v[144:147]
  v_mfma_f32_16x16x32_bf16 v[148:151], v[28:31], v[36:39], v[148:151]
  v_mfma_f32_16x16x32_bf16 v[152:155], v[28:31], v[40:43], v[152:155]
  v_mfma_f32_16x16x32_bf16 v[156:159], v[28:31], v[44:47], v[156:159]
  v_mfma_f32_16x16x32_bf16 v[160:163], v[28:31], v[48:51], v[160:163]
  v_mfma_f32_16x16x32_bf16 v[164:167], v[28:31], v[52:55], v[164:167]
  v_mfma_f32_16x16x32_bf16 v[168:171], v[28:31], v[56:59], v[168:171]
  v_mfma_f32_16x16x32_bf16 v[172:175], v[16:19], v[32:35], v[172:175]
  s_waitcnt lgkmcnt(0)
  s_add_u32 s10, s46, 12
  s_and_b32 s10, s10, 7
  s_xor_b32 s10, s10, s45
  s_mul_i32 s15, s10, 28672
  s_add_u32 s15, s15, s13
  s_add_u32 s15, s15, 229376
  s_add_u32 m0, s51, 0
  s_nop 0
  buffer_load_dwordx4 v3, s[36:39], s15 offen offset:0 lds
  v_mfma_f32_16x16x32_bf16 v[176:179], v[16:19], v[36:39], v[176:179]
  s_add_u32 m0, s51, 0
  s_nop 0
  buffer_load_dwordx4 v4, s[36:39], s15 offen offset:1024 lds
  v_mfma_f32_16x16x32_bf16 v[180:183], v[16:19], v[40:43], v[180:183]
  s_add_u32 m0, s51, 0
  s_nop 0
  buffer_load_dwordx4 v5, s[36:39], s15 offen offset:2048 lds
  v_mfma_f32_16x16x32_bf16 v[184:187], v[16:19], v[44:47], v[184:187]
  s_add_u32 m0, s51, 0
  s_nop 0
  buffer_load_dwordx4 v6, s[36:39], s15 offen offset:3072 lds
  v_mfma_f32_16x16x32_bf16 v[188:191], v[16:19], v[48:51], v[188:191]
  s_add_u32 m0, s51, 4096
  s_nop 0
  buffer_load_dwordx4 v7, s[36:39], s15 offen offset:0 lds
  v_mfma_f32_16x16x32_bf16 v[192:195], v[16:19], v[52:55], v[192:195]
  s_add_u32 m0, s51, 4096
  s_nop 0
  buffer_load_dwordx4 v8, s[36:39], s15 offen offset:1024 lds
  v_mfma_f32_16x16x32_bf16 v[196:199], v[16:19], v[56:59], v[196:199]
  s_add_u32 m0, s51, 4096
  s_nop 0
  buffer_load_dwordx4 v9, s[36:39], s15 offen offset:2048 lds
  v_mfma_f32_16x16x32_bf16 v[200:203], v[20:23], v[32:35], v[200:203]
  s_add_u32 m0, s14, 0
  s_add_u32 s10, s59, 262144
  buffer_load_dwordx4 v13, s[24:27], s10 offen offset:0 nt lds
  s_add_u32 s10, s59, 265216
  buffer_load_dwordx4 v13, s[24:27], s10 offen offset:1024 nt lds
  s_add_u32 s10, s59, 268288
  buffer_load_dwordx4 v13, s[24:27], s10 offen offset:2048 nt lds
  s_add_u32 s10, s59, 271360
  buffer_load_dwordx4 v13, s[24:27], s10 offen offset:3072 nt lds
  v_mfma_f32_16x16x32_bf16 v[204:207], v[20:23], v[36:39], v[204:207]
  v_mfma_f32_16x16x32_bf16 v[208:211], v[20:23], v[40:43], v[208:211]
  v_mfma_f32_16x16x32_bf16 v[212:215], v[20:23], v[44:47], v[212:215]
  v_mfma_f32_16x16x32_bf16 v[216:219], v[20:23], v[48:51], v[216:219]
  v_mfma_f32_16x16x32_bf16 v[220:223], v[20:23], v[52:55], v[220:223]
  v_mfma_f32_16x16x32_bf16 v[224:227], v[20:23], v[56:59], v[224:227]
  v_mfma_f32_16x16x32_bf16 v[228:231], v[24:27], v[32:35], v[228:231]
  v_mfma_f32_16x16x32_bf16 v[232:235], v[24:27], v[36:39], v[232:235]
  v_mfma_f32_16x16x32_bf16 v[236:239], v[24:27], v[40:43], v[236:239]
  v_mfma_f32_16x16x32_bf16 v[240:243], v[24:27], v[44:47], v[240:243]
  v_mfma_f32_16x16x32_bf16 v[244:247], v[24:27], v[48:51], v[244:247]
  s_waitcnt lgkmcnt(0) vmcnt(11)
  s_barrier
  v_mfma_f32_16x16x32_bf16 v[248:251], v[24:27], v[52:55], v[248:251]
  v_mfma_f32_16x16x32_bf16 v[252:255], v[24:27], v[56:59], v[252:255]
  s_waitcnt vmcnt(19)
  ds_read_b64_tr_b16 v[16:17], v1 offset:7168
  ds_read_b64_tr_b16 v[18:19], v1 offset:10752
  ds_read_b64_tr_b16 v[20:21], v1 offset:7200
  ds_read_b64_tr_b16 v[22:23], v1 offset:10784
  ds_read_b64_tr_b16 v[24:25], v1 offset:7232
  ds_read_b64_tr_b16 v[26:27], v1 offset:10816
  ds_read_b64_tr_b16 v[28:29], v1 offset:7264
  ds_read_b64_tr_b16 v[30:31], v1 offset:10848
  ds_read_b128 v[32:35], v2 offset:8192
  ds_read_b128 v[36:39], v2 offset:9216
  ds_read_b128 v[40:43], v2 offset:10240
  ds_read_b128 v[44:47], v2 offset:11264
  ds_read_b128 v[48:51], v2 offset:12288
  ds_read_b128 v[52:55], v2 offset:13312
  ds_read_b128 v[56:59], v2 offset:14336
  s_waitcnt lgkmcnt(13)
  s_waitcnt lgkmcnt(6)
  v_mfma_f32_16x16x32_bf16 v[60:63], v[16:19], v[32:35], v[60:63]
  s_waitcnt lgkmcnt(5)
  v_mfma_f32_16x16x32_bf16 v[64:67], v[16:19], v[36:39], v[64:67]
  s_waitcnt lgkmcnt(4)
  v_mfma_f32_16x16x32_bf16 v[68:71], v[16:19], v[40:43], v[68:71]
  s_waitcnt lgkmcnt(3)
  v_mfma_f32_16x16x32_bf16 v[72:75], v[16:19], v[44:47], v[72:75]
  s_waitcnt lgkmcnt(2)
  v_mfma_f32_16x16x32_bf16 v[76:79], v[16:19], v[48:51], v[76:79]
  s_waitcnt lgkmcnt(1)
  v_mfma_f32_16x16x32_bf16 v[80:83], v[16:19], v[52:55], v[80:83]
  s_waitcnt lgkmcnt(0)
  v_mfma_f32_16x16x32_bf16 v[84:87], v[16:19], v[56:59], v[84:87]
  ds_read_b64_tr_b16 v[16:17], v1 offset:7296
  ds_read_b64_tr_b16 v[18:19], v1 offset:10880
  v_mfma_f32_16x16x32_bf16 v[88:91], v[20:23], v[32:35], v[88:91]
  v_mfma_f32_16x16x32_bf16 v[92:95], v[20:23], v[36:39], v[92:95]
  v_mfma_f32_16x16x32_bf16 v[96:99], v[20:23], v[40:43], v[96:99]
  v_mfma_f32_16x16x32_bf16 v[100:103], v[20:23], v[44:47], v[100:103]
  v_mfma_f32_16x16x32_bf16 v[104:107], v[20:23], v[48:51], v[104:107]
  v_mfma_f32_16x16x32_bf16 v[108:111], v[20:23], v[52:55], v[108:111]
  s_add_u32 m0, s14, 16384
  s_add_u32 s10, s59, 327680
  buffer_load_dwordx4 v13, s[24:27], s10 offen offset:0 nt lds
  s_add_u32 s10, s59, 330752
  buffer_load_dwordx4 v13, s[24:27], s10 offen offset:1024 nt lds
  s_add_u32 s10, s59, 333824
  buffer_load_dwordx4 v13, s[24:27], s10 offen offset:2048 nt lds
  s_add_u32 s10, s59, 336896
  buffer_load_dwordx4 v13, s[24:27], s10 offen offset:3072 nt lds
  v_mfma_f32_16x16x32_bf16 v[112:115], v[20:23], v[56:59], v[112:115]
  ds_read_b64_tr_b16 v[20:21], v1 offset:7328
  ds_read_b64_tr_b16 v[22:23], v1 offset:10912
  v_mfma_f32_16x16x32_bf16 v[116:119], v[24:27], v[32:35], v[116:119]
  v_mfma_f32_16x16x32_bf16 v[120:123], v[24:27], v[36:39], v[120:123]
  v_mfma_f32_16x16x32_bf16 v[124:127], v[24:27], v[40:43], v[124:127]
  v_mfma_f32_16x16x32_bf16 v[128:131], v[24:27], v[44:47], v[128:131]
  v_mfma_f32_16x16x32_bf16 v[132:135], v[24:27], v[48:51], v[132:135]
  v_mfma_f32_16x16x32_bf16 v[136:139], v[24:27], v[52:55], v[136:139]
  v_mfma_f32_16x16x32_bf16 v[140:143], v[24:27], v[56:59], v[140:143]
  ds_read_b64_tr_b16 v[24:25], v1 offset:7360
  ds_read_b64_tr_b16 v[26:27], v1 offset:10944
  v_mfma_f32_16x16x32_bf16 v[144:147], v[28:31], v[32:35], v[144:147]
  v_mfma_f32_16x16x32_bf16 v[148:151], v[28:31], v[36:39], v[148:151]
  s_waitcnt lgkmcnt(0) vmcnt(4)
  s_barrier
  v_mfma_f32_16x16x32_bf16 v[152:155], v[28:31], v[40:43], v[152:155]
  v_mfma_f32_16x16x32_bf16 v[156:159], v[28:31], v[44:47], v[156:159]
  v_mfma_f32_16x16x32_bf16 v[160:163], v[28:31], v[48:51], v[160:163]
  v_mfma_f32_16x16x32_bf16 v[164:167], v[28:31], v[52:55], v[164:167]
  v_mfma_f32_16x16x32_bf16 v[168:171], v[28:31], v[56:59], v[168:171]
  v_mfma_f32_16x16x32_bf16 v[172:175], v[16:19], v[32:35], v[172:175]
  s_add_u32 s10, s46, 13
  s_and_b32 s10, s10, 7
  s_xor_b32 s10, s10, s45
  s_mul_i32 s15, s10, 28672
  s_add_u32 s15, s15, s13
  s_add_u32 s15, s15, 229376
  s_add_u32 m0, s51, 7168
  s_nop 0
  buffer_load_dwordx4 v3, s[36:39], s15 offen offset:0 lds
  v_mfma_f32_16x16x32_bf16 v[176:179], v[16:19], v[36:39], v[176:179]
  s_add_u32 m0, s51, 7168
  s_nop 0
  buffer_load_dwordx4 v4, s[36:39], s15 offen offset:1024 lds
  v_mfma_f32_16x16x32_bf16 v[180:183], v[16:19], v[40:43], v[180:183]
  s_add_u32 m0, s51, 7168
  s_nop 0
  buffer_load_dwordx4 v5, s[36:39], s15 offen offset:2048 lds
  v_mfma_f32_16x16x32_bf16 v[184:187], v[16:19], v[44:47], v[184:187]
  s_add_u32 m0, s51, 7168
  s_nop 0
  buffer_load_dwordx4 v6, s[36:39], s15 offen offset:3072 lds
  v_mfma_f32_16x16x32_bf16 v[188:191], v[16:19], v[48:51], v[188:191]
  s_add_u32 m0, s51, 11264
  s_nop 0
  buffer_load_dwordx4 v7, s[36:39], s15 offen offset:0 lds
  v_mfma_f32_16x16x32_bf16 v[192:195], v[16:19], v[52:55], v[192:195]
  s_add_u32 m0, s51, 11264
  s_nop 0
  buffer_load_dwordx4 v8, s[36:39], s15 offen offset:1024 lds
  v_mfma_f32_16x16x32_bf16 v[196:199], v[16:19], v[56:59], v[196:199]
  s_add_u32 m0, s51, 11264
  s_nop 0
  buffer_load_dwordx4 v9, s[36:39], s15 offen offset:2048 lds
  v_mfma_f32_16x16x32_bf16 v[200:203], v[20:23], v[32:35], v[200:203]
  v_mfma_f32_16x16x32_bf16 v[204:207], v[20:23], v[36:39], v[204:207]
  v_mfma_f32_16x16x32_bf16 v[208:211], v[20:23], v[40:43], v[208:211]
  s_add_u32 m0, s14, 32768
  s_add_u32 s10, s59, 393216
  buffer_load_dwordx4 v13, s[24:27], s10 offen offset:0 nt lds
  s_add_u32 s10, s59, 396288
  buffer_load_dwordx4 v13, s[24:27], s10 offen offset:1024 nt lds
  s_add_u32 s10, s59, 399360
  buffer_load_dwordx4 v13, s[24:27], s10 offen offset:2048 nt lds
  s_add_u32 s10, s59, 402432
  buffer_load_dwordx4 v13, s[24:27], s10 offen offset:3072 nt lds
  v_mfma_f32_16x16x32_bf16 v[212:215], v[20:23], v[44:47], v[212:215]
  v_mfma_f32_16x16x32_bf16 v[216:219], v[20:23], v[48:51], v[216:219]
  v_mfma_f32_16x16x32_bf16 v[220:223], v[20:23], v[52:55], v[220:223]
  v_mfma_f32_16x16x32_bf16 v[224:227], v[20:23], v[56:59], v[224:227]
  v_mfma_f32_16x16x32_bf16 v[228:231], v[24:27], v[32:35], v[228:231]
  v_mfma_f32_16x16x32_bf16 v[232:235], v[24:27], v[36:39], v[232:235]
  v_mfma_f32_16x16x32_bf16 v[236:239], v[24:27], v[40:43], v[236:239]
  v_mfma_f32_16x16x32_bf16 v[240:243], v[24:27], v[44:47], v[240:243]
  v_mfma_f32_16x16x32_bf16 v[244:247], v[24:27], v[48:51], v[244:247]
  v_mfma_f32_16x16x32_bf16 v[248:251], v[24:27], v[52:55], v[248:251]
  v_mfma_f32_16x16x32_bf16 v[252:255], v[24:27], v[56:59], v[252:255]
  s_waitcnt lgkmcnt(0) vmcnt(11)
  s_barrier
  s_waitcnt vmcnt(19)
  ds_read_b64_tr_b16 v[16:17], v1 offset:0
  ds_read_b64_tr_b16 v[18:19], v1 offset:3584
  ds_read_b64_tr_b16 v[20:21], v1 offset:32
  ds_read_b64_tr_b16 v[22:23], v1 offset:3616
  ds_read_b64_tr_b16 v[24:25], v1 offset:64
  ds_read_b64_tr_b16 v[26:27], v1 offset:3648
  ds_read_b64_tr_b16 v[28:29], v1 offset:96
  ds_read_b64_tr_b16 v[30:31], v1 offset:3680
  ds_read_b128 v[32:35], v2 offset:0
  ds_read_b128 v[36:39], v2 offset:1024
  ds_read_b128 v[40:43], v2 offset:2048
  ds_read_b128 v[44:47], v2 offset:3072
  ds_read_b128 v[48:51], v2 offset:4096
  ds_read_b128 v[52:55], v2 offset:5120
  ds_read_b128 v[56:59], v2 offset:6144
  s_waitcnt lgkmcnt(13)
  s_waitcnt lgkmcnt(6)
  v_mfma_f32_16x16x32_bf16 v[60:63], v[16:19], v[32:35], v[60:63]
  s_waitcnt lgkmcnt(5)
  v_mfma_f32_16x16x32_bf16 v[64:67], v[16:19], v[36:39], v[64:67]
  s_waitcnt lgkmcnt(4)
  v_mfma_f32_16x16x32_bf16 v[68:71], v[16:19], v[40:43], v[68:71]
  s_waitcnt lgkmcnt(3)
  v_mfma_f32_16x16x32_bf16 v[72:75], v[16:19], v[44:47], v[72:75]
  s_waitcnt lgkmcnt(2)
  v_mfma_f32_16x16x32_bf16 v[76:79], v[16:19], v[48:51], v[76:79]
  s_waitcnt lgkmcnt(1)
  v_mfma_f32_16x16x32_bf16 v[80:83], v[16:19], v[52:55], v[80:83]
  s_waitcnt lgkmcnt(0)
  v_mfma_f32_16x16x32_bf16 v[84:87], v[16:19], v[56:59], v[84:87]
  ds_read_b64_tr_b16 v[16:17], v1 offset:128
  ds_read_b64_tr_b16 v[18:19], v1 offset:3712
  v_mfma_f32_16x16x32_bf16 v[88:91], v[20:23], v[32:35], v[88:91]
  v_mfma_f32_16x16x32_bf16 v[92:95], v[20:23], v[36:39], v[92:95]
  v_mfma_f32_16x16x32_bf16 v[96:99], v[20:23], v[40:43], v[96:99]
  v_mfma_f32_16x16x32_bf16 v[100:103], v[20:23], v[44:47], v[100:103]
  v_mfma_f32_16x16x32_bf16 v[104:107], v[20:23], v[48:51], v[104:107]
  s_add_u32 m0, s14, 49152
  s_add_u32 s10, s59, 458752
  buffer_load_dwordx4 v13, s[24:27], s10 offen offset:0 nt lds
  s_add_u32 s10, s59, 461824
  buffer_load_dwordx4 v13, s[24:27], s10 offen offset:1024 nt lds
  s_add_u32 s10, s59, 464896
  buffer_load_dwordx4 v13, s[24:27], s10 offen offset:2048 nt lds
  s_add_u32 s10, s59, 467968
  buffer_load_dwordx4 v13, s[24:27], s10 offen offset:3072 nt lds
  v_mfma_f32_16x16x32_bf16 v[108:111], v[20:23], v[52:55], v[108:111]
  v_mfma_f32_16x16x32_bf16 v[112:115], v[20:23], v[56:59], v[112:115]
  ds_read_b64_tr_b16 v[20:21], v1 offset:160
  ds_read_b64_tr_b16 v[22:23], v1 offset:3744
  v_mfma_f32_16x16x32_bf16 v[116:119], v[24:27], v[32:35], v[116:119]
  v_mfma_f32_16x16x32_bf16 v[120:123], v[24:27], v[36:39], v[120:123]
  v_mfma_f32_16x16x32_bf16 v[124:127], v[24:27], v[40:43], v[124:127]
  v_mfma_f32_16x16x32_bf16 v[128:131], v[24:27], v[44:47], v[128:131]
  v_mfma_f32_16x16x32_bf16 v[132:135], v[24:27], v[48:51], v[132:135]
  v_mfma_f32_16x16x32_bf16 v[136:139], v[24:27], v[52:55], v[136:139]
  s_waitcnt lgkmcnt(0) vmcnt(4)
  s_barrier
  v_mfma_f32_16x16x32_bf16 v[140:143], v[24:27], v[56:59], v[140:143]
  ds_read_b64_tr_b16 v[24:25], v1 offset:192
  ds_read_b64_tr_b16 v[26:27], v1 offset:3776
  v_mfma_f32_16x16x32_bf16 v[144:147], v[28:31], v[32:35], v[144:147]
  v_mfma_f32_16x16x32_bf16 v[148:151], v[28:31], v[36:39], v[148:151]
  v_mfma_f32_16x16x32_bf16 v[152:155], v[28:31], v[40:43], v[152:155]
  v_mfma_f32_16x16x32_bf16 v[156:159], v[28:31], v[44:47], v[156:159]
  v_mfma_f32_16x16x32_bf16 v[160:163], v[28:31], v[48:51], v[160:163]
  v_mfma_f32_16x16x32_bf16 v[164:167], v[28:31], v[52:55], v[164:167]
  v_mfma_f32_16x16x32_bf16 v[168:171], v[28:31], v[56:59], v[168:171]
  v_mfma_f32_16x16x32_bf16 v[172:175], v[16:19], v[32:35], v[172:175]
  s_waitcnt lgkmcnt(0)
  s_add_u32 s10, s46, 14
  s_and_b32 s10, s10, 7
  s_xor_b32 s10, s10, s45
  s_mul_i32 s15, s10, 28672
  s_add_u32 s15, s15, s13
  s_add_u32 s15, s15, 229376
  s_add_u32 m0, s51, 0
  s_nop 0
  buffer_load_dwordx4 v3, s[36:39], s15 offen offset:0 lds
  v_mfma_f32_16x16x32_bf16 v[176:179], v[16:19], v[36:39], v[176:179]
  s_add_u32 m0, s51, 0
  s_nop 0
  buffer_load_dwordx4 v4, s[36:39], s15 offen offset:1024 lds
  v_mfma_f32_16x16x32_bf16 v[180:183], v[16:19], v[40:43], v[180:183]
  s_add_u32 m0, s51, 0
  s_nop 0
  buffer_load_dwordx4 v5, s[36:39], s15 offen offset:2048 lds
  v_mfma_f32_16x16x32_bf16 v[184:187], v[16:19], v[44:47], v[184:187]
  s_add_u32 m0, s51, 0
  s_nop 0
  buffer_load_dwordx4 v6, s[36:39], s15 offen offset:3072 lds
  v_mfma_f32_16x16x32_bf16 v[188:191], v[16:19], v[48:51], v[188:191]
  s_add_u32 m0, s51, 4096
  s_nop 0
  buffer_load_dwordx4 v7, s[36:39], s15 offen offset:0 lds
  v_mfma_f32_16x16x32_bf16 v[192:195], v[16:19], v[52:55], v[192:195]
  s_add_u32 m0, s51, 4096
  s_nop 0
  buffer_load_dwordx4 v8, s[36:39], s15 offen offset:1024 lds
  v_mfma_f32_16x16x32_bf16 v[196:199], v[16:19], v[56:59], v[196:199]
  s_add_u32 m0, s51, 4096
  s_nop 0
  buffer_load_dwordx4 v9, s[36:39], s15 offen offset:2048 lds
  v_mfma_f32_16x16x32_bf16 v[200:203], v[20:23], v[32:35], v[200:203]
  v_mfma_f32_16x16x32_bf16 v[204:207], v[20:23], v[36:39], v[204:207]
  v_mfma_f32_16x16x32_bf16 v[208:211], v[20:23], v[40:43], v[208:211]
  v_mfma_f32_16x16x32_bf16 v[212:215], v[20:23], v[44:47], v[212:215]
  v_mfma_f32_16x16x32_bf16 v[216:219], v[20:23], v[48:51], v[216:219]
  v_mfma_f32_16x16x32_bf16 v[220:223], v[20:23], v[52:55], v[220:223]
  v_mfma_f32_16x16x32_bf16 v[224:227], v[20:23], v[56:59], v[224:227]
  v_mfma_f32_16x16x32_bf16 v[228:231], v[24:27], v[32:35], v[228:231]
  v_mfma_f32_16x16x32_bf16 v[232:235], v[24:27], v[36:39], v[232:235]
  v_mfma_f32_16x16x32_bf16 v[236:239], v[24:27], v[40:43], v[236:239]
  v_mfma_f32_16x16x32_bf16 v[240:243], v[24:27], v[44:47], v[240:243]
  v_mfma_f32_16x16x32_bf16 v[244:247], v[24:27], v[48:51], v[244:247]
  s_waitcnt lgkmcnt(0) vmcnt(7)
  s_barrier
  v_mfma_f32_16x16x32_bf16 v[248:251], v[24:27], v[52:55], v[248:251]
  v_mfma_f32_16x16x32_bf16 v[252:255], v[24:27], v[56:59], v[252:255]
  s_waitcnt vmcnt(15)
  ds_read_b64_tr_b16 v[16:17], v1 offset:7168
  ds_read_b64_tr_b16 v[18:19], v1 offset:10752
  ds_read_b64_tr_b16 v[20:21], v1 offset:7200
  ds_read_b64_tr_b16 v[22:23], v1 offset:10784
  ds_read_b64_tr_b16 v[24:25], v1 offset:7232
  ds_read_b64_tr_b16 v[26:27], v1 offset:10816
  ds_read_b64_tr_b16 v[28:29], v1 offset:7264
  ds_read_b64_tr_b16 v[30:31], v1 offset:10848
  ds_read_b128 v[32:35], v2 offset:8192
  ds_read_b128 v[36:39], v2 offset:9216
  ds_read_b128 v[40:43], v2 offset:10240
  ds_read_b128 v[44:47], v2 offset:11264
  ds_read_b128 v[48:51], v2 offset:12288
  ds_read_b128 v[52:55], v2 offset:13312
  ds_read_b128 v[56:59], v2 offset:14336
  s_waitcnt lgkmcnt(13)
  s_waitcnt lgkmcnt(6)
  v_mfma_f32_16x16x32_bf16 v[60:63], v[16:19], v[32:35], v[60:63]
  s_waitcnt lgkmcnt(5)
  v_mfma_f32_16x16x32_bf16 v[64:67], v[16:19], v[36:39], v[64:67]
  s_waitcnt lgkmcnt(4)
  v_mfma_f32_16x16x32_bf16 v[68:71], v[16:19], v[40:43], v[68:71]
  s_waitcnt lgkmcnt(3)
  v_mfma_f32_16x16x32_bf16 v[72:75], v[16:19], v[44:47], v[72:75]
  s_waitcnt lgkmcnt(2)
  v_mfma_f32_16x16x32_bf16 v[76:79], v[16:19], v[48:51], v[76:79]
  s_waitcnt lgkmcnt(1)
  v_mfma_f32_16x16x32_bf16 v[80:83], v[16:19], v[52:55], v[80:83]
  s_waitcnt lgkmcnt(0)
  v_mfma_f32_16x16x32_bf16 v[84:87], v[16:19], v[56:59], v[84:87]
  ds_read_b64_tr_b16 v[16:17], v1 offset:7296
  ds_read_b64_tr_b16 v[18:19], v1 offset:10880
  v_mfma_f32_16x16x32_bf16 v[88:91], v[20:23], v[32:35], v[88:91]
  v_mfma_f32_16x16x32_bf16 v[92:95], v[20:23], v[36:39], v[92:95]
  v_mfma_f32_16x16x32_bf16 v[96:99], v[20:23], v[40:43], v[96:99]
  v_mfma_f32_16x16x32_bf16 v[100:103], v[20:23], v[44:47], v[100:103]
  v_mfma_f32_16x16x32_bf16 v[104:107], v[20:23], v[48:51], v[104:107]
  v_mfma_f32_16x16x32_bf16 v[108:111], v[20:23], v[52:55], v[108:111]
  v_mfma_f32_16x16x32_bf16 v[112:115], v[20:23], v[56:59], v[112:115]
  ds_read_b64_tr_b16 v[20:21], v1 offset:7328
  ds_read_b64_tr_b16 v[22:23], v1 offset:10912
  v_mfma_f32_16x16x32_bf16 v[116:119], v[24:27], v[32:35], v[116:119]
  v_mfma_f32_16x16x32_bf16 v[120:123], v[24:27], v[36:39], v[120:123]
  v_mfma_f32_16x16x32_bf16 v[124:127], v[24:27], v[40:43], v[124:127]
  v_mfma_f32_16x16x32_bf16 v[128:131], v[24:27], v[44:47], v[128:131]
  v_mfma_f32_16x16x32_bf16 v[132:135], v[24:27], v[48:51], v[132:135]
  v_mfma_f32_16x16x32_bf16 v[136:139], v[24:27], v[52:55], v[136:139]
  v_mfma_f32_16x16x32_bf16 v[140:143], v[24:27], v[56:59], v[140:143]
  ds_read_b64_tr_b16 v[24:25], v1 offset:7360
  ds_read_b64_tr_b16 v[26:27], v1 offset:10944
  v_mfma_f32_16x16x32_bf16 v[144:147], v[28:31], v[32:35], v[144:147]
  v_mfma_f32_16x16x32_bf16 v[148:151], v[28:31], v[36:39], v[148:151]
  s_waitcnt lgkmcnt(0)
  s_barrier
  v_mfma_f32_16x16x32_bf16 v[152:155], v[28:31], v[40:43], v[152:155]
  v_mfma_f32_16x16x32_bf16 v[156:159], v[28:31], v[44:47], v[156:159]
  v_mfma_f32_16x16x32_bf16 v[160:163], v[28:31], v[48:51], v[160:163]
  v_mfma_f32_16x16x32_bf16 v[164:167], v[28:31], v[52:55], v[164:167]
  v_mfma_f32_16x16x32_bf16 v[168:171], v[28:31], v[56:59], v[168:171]
  v_mfma_f32_16x16x32_bf16 v[172:175], v[16:19], v[32:35], v[172:175]
  s_add_u32 s10, s46, 15
  s_and_b32 s10, s10, 7
  s_xor_b32 s10, s10, s45
  s_mul_i32 s15, s10, 28672
  s_add_u32 s15, s15, s13
  s_add_u32 s15, s15, 229376
  s_add_u32 m0, s51, 7168
  s_nop 0
  buffer_load_dwordx4 v3, s[36:39], s15 offen offset:0 lds
  v_mfma_f32_16x16x32_bf16 v[176:179], v[16:19], v[36:39], v[176:179]
  s_add_u32 m0, s51, 7168
  s_nop 0
  buffer_load_dwordx4 v4, s[36:39], s15 offen offset:1024 lds
  v_mfma_f32_16x16x32_bf16 v[180:183], v[16:19], v[40:43], v[180:183]
  s_add_u32 m0, s51, 7168
  s_nop 0
  buffer_load_dwordx4 v5, s[36:39], s15 offen offset:2048 lds
  v_mfma_f32_16x16x32_bf16 v[184:187], v[16:19], v[44:47], v[184:187]
  s_add_u32 m0, s51, 7168
  s_nop 0
  buffer_load_dwordx4 v6, s[36:39], s15 offen offset:3072 lds
  v_mfma_f32_16x16x32_bf16 v[188:191], v[16:19], v[48:51], v[188:191]
  s_add_u32 m0, s51, 11264
  s_nop 0
  buffer_load_dwordx4 v7, s[36:39], s15 offen offset:0 lds
  v_mfma_f32_16x16x32_bf16 v[192:195], v[16:19], v[52:55], v[192:195]
  s_add_u32 m0, s51, 11264
  s_nop 0
  buffer_load_dwordx4 v8, s[36:39], s15 offen offset:1024 lds
  v_mfma_f32_16x16x32_bf16 v[196:199], v[16:19], v[56:59], v[196:199]
  s_add_u32 m0, s51, 11264
  s_nop 0
  buffer_load_dwordx4 v9, s[36:39], s15 offen offset:2048 lds
  v_mfma_f32_16x16x32_bf16 v[200:203], v[20:23], v[32:35], v[200:203]
  v_mfma_f32_16x16x32_bf16 v[204:207], v[20:23], v[36:39], v[204:207]
  v_mfma_f32_16x16x32_bf16 v[208:211], v[20:23], v[40:43], v[208:211]
  v_mfma_f32_16x16x32_bf16 v[212:215], v[20:23], v[44:47], v[212:215]
  v_mfma_f32_16x16x32_bf16 v[216:219], v[20:23], v[48:51], v[216:219]
  v_mfma_f32_16x16x32_bf16 v[220:223], v[20:23], v[52:55], v[220:223]
  v_mfma_f32_16x16x32_bf16 v[224:227], v[20:23], v[56:59], v[224:227]
  v_mfma_f32_16x16x32_bf16 v[228:231], v[24:27], v[32:35], v[228:231]
  v_mfma_f32_16x16x32_bf16 v[232:235], v[24:27], v[36:39], v[232:235]
  v_mfma_f32_16x16x32_bf16 v[236:239], v[24:27], v[40:43], v[236:239]
  v_mfma_f32_16x16x32_bf16 v[240:243], v[24:27], v[44:47], v[240:243]
  v_mfma_f32_16x16x32_bf16 v[244:247], v[24:27], v[48:51], v[244:247]
  v_mfma_f32_16x16x32_bf16 v[248:251], v[24:27], v[52:55], v[248:251]
  v_mfma_f32_16x16x32_bf16 v[252:255], v[24:27], v[56:59], v[252:255]
  s_waitcnt lgkmcnt(0)
  s_load_dwordx4 s[64:67], s[0:1], 80
  s_load_dwordx2 s[40:41], s[0:1], 96
  s_mul_i32 s17, s7, 200704
  s_mul_i32 s16, s5, 896
  s_add_u32 s17, s17, s16
  s_lshl_b32 s10, s5, 4
  s_add_u32 s10, s10, s7
  s_mul_i32 s11, s10, 831744
  s_lshl_b32 s16, s10, 11
  s_add_u32 s16, s16, 33554432
  s_mov_b32 s42, 831744
  s_mov_b32 s43, 0x20000
  s_movk_i32 s26, 2048
  s_mov_b32 s27, 0x20000
  s_mov_b32 s30, 3211264
  s_mov_b32 s31, 0x20000
  s_waitcnt lgkmcnt(0)
  s_add_u32 s24, s40, s16
  s_addc_u32 s25, s41, 0
  s_add_u32 s40, s40, s11
  s_addc_u32 s41, s41, 0
  s_mov_b32 s28, s64
  s_mov_b32 s29, s65
  s_waitcnt vmcnt(0)
  s_mul_i32 s18, s4, 3712
  s_add_u32 s10, s18, 16384
  v_add_u32 v3, s10, v12
  v_lshlrev_b32 v4, 3, v0
  v_add_u32 v5, s10, v4
  s_mul_i32 s19, s6, 14848
  s_add_u32 s18, s18, s19
  s_add_u32 s18, s18, 128
  ds_read_b64_tr_b16 v[16:17], v1 offset:0
  ds_read_b64_tr_b16 v[18:19], v1 offset:3584
  ds_read_b64_tr_b16 v[20:21], v1 offset:32
  ds_read_b64_tr_b16 v[22:23], v1 offset:3616
  ds_read_b64_tr_b16 v[24:25], v1 offset:64
  ds_read_b64_tr_b16 v[26:27], v1 offset:3648
  ds_read_b64_tr_b16 v[28:29], v1 offset:96
  ds_read_b64_tr_b16 v[30:31], v1 offset:3680
  s_barrier
  ds_read_b128 v[32:35], v2 offset:0
  ds_read_b128 v[36:39], v2 offset:1024
  ds_read_b128 v[40:43], v2 offset:2048
  ds_read_b128 v[56:59], v2 offset:3072
  s_waitcnt lgkmcnt(10)
  s_waitcnt lgkmcnt(3)
  v_mfma_f32_16x16x32_bf16 v[60:63], v[16:19], v[32:35], v[60:63]
  s_waitcnt lgkmcnt(2)
  v_mfma_f32_16x16x32_bf16 v[64:67], v[16:19], v[36:39], v[64:67]
  s_waitcnt lgkmcnt(1)
  v_mfma_f32_16x16x32_bf16 v[68:71], v[16:19], v[40:43], v[68:71]
  ds_read_b64_tr_b16 v[16:17], v1 offset:128
  ds_read_b64_tr_b16 v[18:19], v1 offset:3712
  v_mfma_f32_16x16x32_bf16 v[88:91], v[20:23], v[32:35], v[88:91]
  v_mfma_f32_16x16x32_bf16 v[92:95], v[20:23], v[36:39], v[92:95]
  v_mfma_f32_16x16x32_bf16 v[96:99], v[20:23], v[40:43], v[96:99]
  ds_read_b64_tr_b16 v[20:21], v1 offset:160
  ds_read_b64_tr_b16 v[22:23], v1 offset:3744
  v_mfma_f32_16x16x32_bf16 v[116:119], v[24:27], v[32:35], v[116:119]
  v_mfma_f32_16x16x32_bf16 v[120:123], v[24:27], v[36:39], v[120:123]
  v_mfma_f32_16x16x32_bf16 v[124:127], v[24:27], v[40:43], v[124:127]
  ds_read_b64_tr_b16 v[24:25], v1 offset:192
  ds_read_b64_tr_b16 v[26:27], v1 offset:3776
  v_mfma_f32_16x16x32_bf16 v[144:147], v[28:31], v[32:35], v[144:147]
  v_mfma_f32_16x16x32_bf16 v[148:151], v[28:31], v[36:39], v[148:151]
  v_mfma_f32_16x16x32_bf16 v[152:155], v[28:31], v[40:43], v[152:155]
  ds_read_b64_tr_b16 v[28:29], v1 offset:7168
  ds_read_b64_tr_b16 v[30:31], v1 offset:10752
  s_waitcnt lgkmcnt(6)
  v_mfma_f32_16x16x32_bf16 v[172:175], v[16:19], v[32:35], v[172:175]
  v_mfma_f32_16x16x32_bf16 v[176:179], v[16:19], v[36:39], v[176:179]
  v_mfma_f32_16x16x32_bf16 v[180:183], v[16:19], v[40:43], v[180:183]
  ds_read_b64_tr_b16 v[16:17], v1 offset:7200
  ds_read_b64_tr_b16 v[18:19], v1 offset:10784
  s_barrier
  ds_read_b128 v[44:47], v2 offset:8192
  ds_read_b128 v[48:51], v2 offset:9216
  ds_read_b128 v[52:55], v2 offset:10240
  s_waitcnt lgkmcnt(9)
  v_mfma_f32_16x16x32_bf16 v[200:203], v[20:23], v[32:35], v[200:203]
  v_mfma_f32_16x16x32_bf16 v[204:207], v[20:23], v[36:39], v[204:207]
  v_mfma_f32_16x16x32_bf16 v[208:211], v[20:23], v[40:43], v[208:211]
  ds_read_b64_tr_b16 v[20:21], v1 offset:7232
  ds_read_b64_tr_b16 v[22:23], v1 offset:10816
  s_waitcnt lgkmcnt(9)
  v_mfma_f32_16x16x32_bf16 v[228:231], v[24:27], v[32:35], v[228:231]
  v_mfma_f32_16x16x32_bf16 v[232:235], v[24:27], v[36:39], v[232:235]
  v_mfma_f32_16x16x32_bf16 v[236:239], v[24:27], v[40:43], v[236:239]
  ds_read_b64_tr_b16 v[24:25], v1 offset:7264
  ds_read_b64_tr_b16 v[26:27], v1 offset:10848
  ds_read_b128 v[32:35], v2 offset:4096
  ds_read_b128 v[36:39], v2 offset:5120
  ds_read_b128 v[40:43], v2 offset:6144
  s_waitcnt lgkmcnt(12)
  s_waitcnt lgkmcnt(9)
  v_mfma_f32_16x16x32_bf16 v[60:63], v[28:31], v[44:47], v[60:63]
  s_waitcnt lgkmcnt(8)
  v_mfma_f32_16x16x32_bf16 v[64:67], v[28:31], v[48:51], v[64:67]
  s_waitcnt lgkmcnt(7)
  v_mfma_f32_16x16x32_bf16 v[68:71], v[28:31], v[52:55], v[68:71]
  ds_read_b64_tr_b16 v[28:29], v1 offset:7296
  ds_read_b64_tr_b16 v[30:31], v1 offset:10880
  v_mfma_f32_16x16x32_bf16 v[88:91], v[16:19], v[44:47], v[88:91]
  v_mfma_f32_16x16x32_bf16 v[92:95], v[16:19], v[48:51], v[92:95]
  v_mfma_f32_16x16x32_bf16 v[96:99], v[16:19], v[52:55], v[96:99]
  ds_read_b64_tr_b16 v[16:17], v1 offset:7328
  ds_read_b64_tr_b16 v[18:19], v1 offset:10912
  s_waitcnt lgkmcnt(9)
  v_mfma_f32_16x16x32_bf16 v[116:119], v[20:23], v[44:47], v[116:119]
  v_cvt_pk_bf16_f32 v60, v60, v61
  v_cvt_pk_bf16_f32 v61, v62, v63
  v_cvt_pk_bf16_f32 v62, v88, v89
  v_cvt_pk_bf16_f32 v63, v90, v91
  s_add_u32 s10, s18, 0
  s_cmp_eq_u32 s6, 0
  s_cbranch_scc1 L_eo00
  buffer_store_dwordx4 v[60:63], v12, s[40:43], s10 offen offset:0 sc1
L_eb00:
  ds_read_b128 v[88:91], v2 offset:11264
  v_mfma_f32_16x16x32_bf16 v[120:123], v[20:23], v[48:51], v[120:123]
  v_mfma_f32_16x16x32_bf16 v[124:127], v[20:23], v[52:55], v[124:127]
  ds_read_b64_tr_b16 v[20:21], v1 offset:7360
  ds_read_b64_tr_b16 v[22:23], v1 offset:10944
  s_waitcnt lgkmcnt(10)
  v_mfma_f32_16x16x32_bf16 v[144:147], v[24:27], v[44:47], v[144:147]
  v_cvt_pk_bf16_f32 v64, v64, v65
  v_cvt_pk_bf16_f32 v65, v66, v67
  v_cvt_pk_bf16_f32 v66, v92, v93
  v_cvt_pk_bf16_f32 v67, v94, v95
  s_add_u32 s10, s18, 118784
  s_cmp_eq_u32 s6, 1
  s_cbranch_scc1 L_eo01
  buffer_store_dwordx4 v[64:67], v12, s[40:43], s10 offen offset:0 sc1
L_eb01:
  ds_read_b128 v[92:95], v2 offset:12288
  v_mfma_f32_16x16x32_bf16 v[148:151], v[24:27], v[48:51], v[148:151]
  v_mfma_f32_16x16x32_bf16 v[152:155], v[24:27], v[52:55], v[152:155]
  ds_read_b64_tr_b16 v[24:25], v1 offset:0
  ds_read_b64_tr_b16 v[26:27], v1 offset:3584
  s_waitcnt lgkmcnt(8)
  v_mfma_f32_16x16x32_bf16 v[172:175], v[28:31], v[44:47], v[172:175]
  v_cvt_pk_bf16_f32 v68, v68, v69
  v_cvt_pk_bf16_f32 v69, v70, v71
  v_cvt_pk_bf16_f32 v70, v96, v97
  v_cvt_pk_bf16_f32 v71, v98, v99
  s_add_u32 s10, s18, 237568
  s_cmp_eq_u32 s6, 2
  s_cbranch_scc1 L_eo02
  buffer_store_dwordx4 v[68:71], v12, s[40:43], s10 offen offset:0 sc1
L_eb02:
  ds_read_b128 v[96:99], v2 offset:13312
  v_mfma_f32_16x16x32_bf16 v[176:179], v[28:31], v[48:51], v[176:179]
  v_mfma_f32_16x16x32_bf16 v[180:183], v[28:31], v[52:55], v[180:183]
  ds_read_b64_tr_b16 v[28:29], v1 offset:7168
  ds_read_b64_tr_b16 v[30:31], v1 offset:10752
  s_waitcnt lgkmcnt(9)
  v_mfma_f32_16x16x32_bf16 v[200:203], v[16:19], v[44:47], v[200:203]
  v_cvt_pk_bf16_f32 v116, v116, v117
  v_cvt_pk_bf16_f32 v117, v118, v119
  v_cvt_pk_bf16_f32 v118, v144, v145
  v_cvt_pk_bf16_f32 v119, v146, v147
  s_add_u32 s10, s18, 0
  s_cmp_eq_u32 s6, 0
  s_cbranch_scc1 L_eo10
  buffer_store_dwordx4 v[116:119], v12, s[40:43], s10 offen offset:1024 sc1
L_eb10:
  ds_read_b128 v[144:147], v2 offset:14336
  v_mfma_f32_16x16x32_bf16 v[204:207], v[16:19], v[48:51], v[204:207]
  v_mfma_f32_16x16x32_bf16 v[208:211], v[16:19], v[52:55], v[208:211]
  ds_read_b64_tr_b16 v[16:17], v1 offset:32
  ds_read_b64_tr_b16 v[18:19], v1 offset:3616
  s_waitcnt lgkmcnt(9)
  v_mfma_f32_16x16x32_bf16 v[228:231], v[20:23], v[44:47], v[228:231]
  v_cvt_pk_bf16_f32 v120, v120, v121
  v_cvt_pk_bf16_f32 v121, v122, v123
  v_cvt_pk_bf16_f32 v122, v148, v149
  v_cvt_pk_bf16_f32 v123, v150, v151
  s_add_u32 s10, s18, 118784
  s_cmp_eq_u32 s6, 1
  s_cbranch_scc1 L_eo11
  buffer_store_dwordx4 v[120:123], v12, s[40:43], s10 offen offset:1024 sc1
L_eb11:
  v_mfma_f32_16x16x32_bf16 v[232:235], v[20:23], v[48:51], v[232:235]
  v_mfma_f32_16x16x32_bf16 v[236:239], v[20:23], v[52:55], v[236:239]
  ds_read_b64_tr_b16 v[20:21], v1 offset:7200
  ds_read_b64_tr_b16 v[22:23], v1 offset:10784
  s_waitcnt lgkmcnt(8)
  v_mfma_f32_16x16x32_bf16 v[72:75], v[24:27], v[56:59], v[72:75]
  v_cvt_pk_bf16_f32 v124, v124, v125
  v_cvt_pk_bf16_f32 v125, v126, v127
  v_cvt_pk_bf16_f32 v126, v152, v153
  v_cvt_pk_bf16_f32 v127, v154, v155
  s_add_u32 s10, s18, 237568
  s_cmp_eq_u32 s6, 2
  s_cbranch_scc1 L_eo12
  buffer_store_dwordx4 v[124:127], v12, s[40:43], s10 offen offset:1024 sc1
L_eb12:
  v_mfma_f32_16x16x32_bf16 v[76:79], v[24:27], v[32:35], v[76:79]
  v_mfma_f32_16x16x32_bf16 v[80:83], v[24:27], v[36:39], v[80:83]
  v_mfma_f32_16x16x32_bf16 v[84:87], v[24:27], v[40:43], v[84:87]
  v_cvt_pk_bf16_f32 v172, v172, v173
  v_cvt_pk_bf16_f32 v173, v174, v175
  v_cvt_pk_bf16_f32 v174, v200, v201
  v_cvt_pk_bf16_f32 v175, v202, v203
  s_add_u32 s10, s18, 0
  s_cmp_eq_u32 s6, 0
  s_cbranch_scc1 L_eo20
  buffer_store_dwordx4 v[172:175], v12, s[40:43], s10 offen offset:2048 sc1
L_eb20:
  ds_read_b64_tr_b16 v[24:25], v1 offset:64
  ds_read_b64_tr_b16 v[26:27], v1 offset:3648
  s_waitcnt lgkmcnt(7)
  v_mfma_f32_16x16x32_bf16 v[72:75], v[28:31], v[88:91], v[72:75]
  v_mfma_f32_16x16x32_bf16 v[76:79], v[28:31], v[92:95], v[76:79]
  v_mfma_f32_16x16x32_bf16 v[80:83], v[28:31], v[96:99], v[80:83]
  v_cvt_pk_bf16_f32 v176, v176, v177
  v_cvt_pk_bf16_f32 v177, v178, v179
  v_cvt_pk_bf16_f32 v178, v204, v205
  v_cvt_pk_bf16_f32 v179, v206, v207
  s_add_u32 s10, s18, 118784
  s_cmp_eq_u32 s6, 1
  s_cbranch_scc1 L_eo21
  buffer_store_dwordx4 v[176:179], v12, s[40:43], s10 offen offset:2048 sc1
L_eb21:
  s_waitcnt lgkmcnt(6)
  v_mfma_f32_16x16x32_bf16 v[84:87], v[28:31], v[144:147], v[84:87]
  ds_read_b64_tr_b16 v[28:29], v1 offset:7232
  ds_read_b64_tr_b16 v[30:31], v1 offset:10816
  s_waitcnt lgkmcnt(6)
  v_mfma_f32_16x16x32_bf16 v[100:103], v[16:19], v[56:59], v[100:103]
  v_mfma_f32_16x16x32_bf16 v[104:107], v[16:19], v[32:35], v[104:107]
  v_cvt_pk_bf16_f32 v180, v180, v181
  v_cvt_pk_bf16_f32 v181, v182, v183
  v_cvt_pk_bf16_f32 v182, v208, v209
  v_cvt_pk_bf16_f32 v183, v210, v211
  s_add_u32 s10, s18, 237568
  s_cmp_eq_u32 s6, 2
  s_cbranch_scc1 L_eo22
  buffer_store_dwordx4 v[180:183], v12, s[40:43], s10 offen offset:2048 sc1
L_eb22:
  v_mfma_f32_16x16x32_bf16 v[108:111], v[16:19], v[36:39], v[108:111]
  v_mfma_f32_16x16x32_bf16 v[112:115], v[16:19], v[40:43], v[112:115]
  ds_read_b64_tr_b16 v[16:17], v1 offset:96
  ds_read_b64_tr_b16 v[18:19], v1 offset:3680
  s_waitcnt lgkmcnt(6)
  v_mfma_f32_16x16x32_bf16 v[100:103], v[20:23], v[88:91], v[100:103]
  v_cvt_pk_bf16_f32 v228, v228, v229
  v_cvt_pk_bf16_f32 v229, v230, v231
  s_add_u32 s10, s18, 0
  s_cmp_eq_u32 s6, 0
  s_cbranch_scc1 L_eo30
  buffer_store_dwordx2 v[228:229], v4, s[40:43], s10 offen offset:3072 sc1
L_eb30:
  v_mfma_f32_16x16x32_bf16 v[104:107], v[20:23], v[92:95], v[104:107]
  v_mfma_f32_16x16x32_bf16 v[108:111], v[20:23], v[96:99], v[108:111]
  v_mfma_f32_16x16x32_bf16 v[112:115], v[20:23], v[144:147], v[112:115]
  v_cvt_pk_bf16_f32 v232, v232, v233
  v_cvt_pk_bf16_f32 v233, v234, v235
  s_add_u32 s10, s18, 118784
  s_cmp_eq_u32 s6, 1
  s_cbranch_scc1 L_eo31
  buffer_store_dwordx2 v[232:233], v4, s[40:43], s10 offen offset:3072 sc1
L_eb31:
  ds_read_b64_tr_b16 v[20:21], v1 offset:7264
  ds_read_b64_tr_b16 v[22:23], v1 offset:10848
  s_waitcnt lgkmcnt(6)
  v_mfma_f32_16x16x32_bf16 v[128:131], v[24:27], v[56:59], v[128:131]
  v_mfma_f32_16x16x32_bf16 v[132:135], v[24:27], v[32:35], v[132:135]
  v_mfma_f32_16x16x32_bf16 v[136:139], v[24:27], v[36:39], v[136:139]
  v_cvt_pk_bf16_f32 v236, v236, v237
  v_cvt_pk_bf16_f32 v237, v238, v239
  s_add_u32 s10, s18, 237568
  s_cmp_eq_u32 s6, 2
  s_cbranch_scc1 L_eo32
  buffer_store_dwordx2 v[236:237], v4, s[40:43], s10 offen offset:3072 sc1
L_eb32:
  v_mfma_f32_16x16x32_bf16 v[140:143], v[24:27], v[40:43], v[140:143]
  ds_read_b64_tr_b16 v[24:25], v1 offset:128
  ds_read_b64_tr_b16 v[26:27], v1 offset:3712
  s_waitcnt lgkmcnt(6)
  v_mfma_f32_16x16x32_bf16 v[128:131], v[28:31], v[88:91], v[128:131]
  v_mfma_f32_16x16x32_bf16 v[132:135], v[28:31], v[92:95], v[132:135]
  v_cvt_pk_bf16_f32 v72, v72, v73
  v_cvt_pk_bf16_f32 v73, v74, v75
  v_cvt_pk_bf16_f32 v74, v100, v101
  v_cvt_pk_bf16_f32 v75, v102, v103
  s_add_u32 s10, s18, 356352
  s_cmp_eq_u32 s6, 3
  s_cbranch_scc1 L_eo03
  buffer_store_dwordx4 v[72:75], v12, s[40:43], s10 offen offset:0 sc1
L_eb03:
  v_mfma_f32_16x16x32_bf16 v[136:139], v[28:31], v[96:99], v[136:139]
  v_mfma_f32_16x16x32_bf16 v[140:143], v[28:31], v[144:147], v[140:143]
  ds_read_b64_tr_b16 v[28:29], v1 offset:7296
  ds_read_b64_tr_b16 v[30:31], v1 offset:10880
  s_waitcnt lgkmcnt(6)
  v_mfma_f32_16x16x32_bf16 v[156:159], v[16:19], v[56:59], v[156:159]
  v_cvt_pk_bf16_f32 v76, v76, v77
  v_cvt_pk_bf16_f32 v77, v78, v79
  v_cvt_pk_bf16_f32 v78, v104, v105
  v_cvt_pk_bf16_f32 v79, v106, v107
  s_add_u32 s10, s18, 475136
  s_cmp_eq_u32 s6, 4
  s_cbranch_scc1 L_eo04
  buffer_store_dwordx4 v[76:79], v12, s[40:43], s10 offen offset:0 sc1
L_eb04:
  v_mfma_f32_16x16x32_bf16 v[160:163], v[16:19], v[32:35], v[160:163]
  v_mfma_f32_16x16x32_bf16 v[164:167], v[16:19], v[36:39], v[164:167]
  v_mfma_f32_16x16x32_bf16 v[168:171], v[16:19], v[40:43], v[168:171]
  v_cvt_pk_bf16_f32 v80, v80, v81
  v_cvt_pk_bf16_f32 v81, v82, v83
  v_cvt_pk_bf16_f32 v82, v108, v109
  v_cvt_pk_bf16_f32 v83, v110, v111
  s_add_u32 s10, s18, 593920
  s_cmp_eq_u32 s6, 5
  s_cbranch_scc1 L_eo05
  buffer_store_dwordx4 v[80:83], v12, s[40:43], s10 offen offset:0 sc1
L_eb05:
  ds_read_b64_tr_b16 v[16:17], v1 offset:160
  ds_read_b64_tr_b16 v[18:19], v1 offset:3744
  s_waitcnt lgkmcnt(6)
  v_mfma_f32_16x16x32_bf16 v[156:159], v[20:23], v[88:91], v[156:159]
  v_mfma_f32_16x16x32_bf16 v[160:163], v[20:23], v[92:95], v[160:163]
  v_mfma_f32_16x16x32_bf16 v[164:167], v[20:23], v[96:99], v[164:167]
  v_cvt_pk_bf16_f32 v84, v84, v85
  v_cvt_pk_bf16_f32 v85, v86, v87
  v_cvt_pk_bf16_f32 v86, v112, v113
  v_cvt_pk_bf16_f32 v87, v114, v115
  s_add_u32 s10, s18, 712704
  s_cmp_eq_u32 s6, 6
  s_cbranch_scc1 L_eo06
  buffer_store_dwordx4 v[84:87], v12, s[40:43], s10 offen offset:0 sc1
L_eb06:
  v_mfma_f32_16x16x32_bf16 v[168:171], v[20:23], v[144:147], v[168:171]
  ds_read_b64_tr_b16 v[20:21], v1 offset:7328
  ds_read_b64_tr_b16 v[22:23], v1 offset:10912
  s_waitcnt lgkmcnt(6)
  v_mfma_f32_16x16x32_bf16 v[184:187], v[24:27], v[56:59], v[184:187]
  v_mfma_f32_16x16x32_bf16 v[188:191], v[24:27], v[32:35], v[188:191]
  v_cvt_pk_bf16_f32 v128, v128, v129
  v_cvt_pk_bf16_f32 v129, v130, v131
  v_cvt_pk_bf16_f32 v130, v156, v157
  v_cvt_pk_bf16_f32 v131, v158, v159
  s_add_u32 s10, s18, 356352
  s_cmp_eq_u32 s6, 3
  s_cbranch_scc1 L_eo13
  buffer_store_dwordx4 v[128:131], v12, s[40:43], s10 offen offset:1024 sc1
L_eb13:
  v_mfma_f32_16x16x32_bf16 v[192:195], v[24:27], v[36:39], v[192:195]
  v_mfma_f32_16x16x32_bf16 v[196:199], v[24:27], v[40:43], v[196:199]
  ds_read_b64_tr_b16 v[24:25], v1 offset:192
  ds_read_b64_tr_b16 v[26:27], v1 offset:3776
  s_waitcnt lgkmcnt(6)
  v_mfma_f32_16x16x32_bf16 v[184:187], v[28:31], v[88:91], v[184:187]
  v_cvt_pk_bf16_f32 v132, v132, v133
  v_cvt_pk_bf16_f32 v133, v134, v135
  v_cvt_pk_bf16_f32 v134, v160, v161
  v_cvt_pk_bf16_f32 v135, v162, v163
  s_add_u32 s10, s18, 475136
  s_cmp_eq_u32 s6, 4
  s_cbranch_scc1 L_eo14
  buffer_store_dwordx4 v[132:135], v12, s[40:43], s10 offen offset:1024 sc1
L_eb14:
  v_mfma_f32_16x16x32_bf16 v[188:191], v[28:31], v[92:95], v[188:191]
  v_mfma_f32_16x16x32_bf16 v[192:195], v[28:31], v[96:99], v[192:195]
  v_mfma_f32_16x16x32_bf16 v[196:199], v[28:31], v[144:147], v[196:199]
  v_cvt_pk_bf16_f32 v136, v136, v137
  v_cvt_pk_bf16_f32 v137, v138, v139
  v_cvt_pk_bf16_f32 v138, v164, v165
  v_cvt_pk_bf16_f32 v139, v166, v167
  s_add_u32 s10, s18, 593920
  s_cmp_eq_u32 s6, 5
  s_cbranch_scc1 L_eo15
  buffer_store_dwordx4 v[136:139], v12, s[40:43], s10 offen offset:1024 sc1
L_eb15:
  ds_read_b64_tr_b16 v[28:29], v1 offset:7360
  ds_read_b64_tr_b16 v[30:31], v1 offset:10944
  s_waitcnt lgkmcnt(6)
  v_mfma_f32_16x16x32_bf16 v[212:215], v[16:19], v[56:59], v[212:215]
  v_mfma_f32_16x16x32_bf16 v[216:219], v[16:19], v[32:35], v[216:219]
  v_mfma_f32_16x16x32_bf16 v[220:223], v[16:19], v[36:39], v[220:223]
  v_cvt_pk_bf16_f32 v140, v140, v141
  v_cvt_pk_bf16_f32 v141, v142, v143
  v_cvt_pk_bf16_f32 v142, v168, v169
  v_cvt_pk_bf16_f32 v143, v170, v171
  s_add_u32 s10, s18, 712704
  s_cmp_eq_u32 s6, 6
  s_cbranch_scc1 L_eo16
  buffer_store_dwordx4 v[140:143], v12, s[40:43], s10 offen offset:1024 sc1
L_eb16:
  v_mfma_f32_16x16x32_bf16 v[224:227], v[16:19], v[40:43], v[224:227]
  s_waitcnt lgkmcnt(4)
  v_mfma_f32_16x16x32_bf16 v[212:215], v[20:23], v[88:91], v[212:215]
  v_mfma_f32_16x16x32_bf16 v[216:219], v[20:23], v[92:95], v[216:219]
  v_mfma_f32_16x16x32_bf16 v[220:223], v[20:23], v[96:99], v[220:223]
  v_mfma_f32_16x16x32_bf16 v[224:227], v[20:23], v[144:147], v[224:227]
  v_cvt_pk_bf16_f32 v184, v184, v185
  v_cvt_pk_bf16_f32 v185, v186, v187
  s_nop 2
  v_cvt_pk_bf16_f32 v186, v212, v213
  v_cvt_pk_bf16_f32 v187, v214, v215
  s_add_u32 s10, s18, 356352
  s_cmp_eq_u32 s6, 3
  s_cbranch_scc1 L_eo23
  buffer_store_dwordx4 v[184:187], v12, s[40:43], s10 offen offset:2048 sc1
L_eb23:
  s_waitcnt lgkmcnt(2)
  v_mfma_f32_16x16x32_bf16 v[240:243], v[24:27], v[56:59], v[240:243]
  v_mfma_f32_16x16x32_bf16 v[244:247], v[24:27], v[32:35], v[244:247]
  v_mfma_f32_16x16x32_bf16 v[248:251], v[24:27], v[36:39], v[248:251]
  v_cvt_pk_bf16_f32 v188, v188, v189
  v_cvt_pk_bf16_f32 v189, v190, v191
  v_cvt_pk_bf16_f32 v190, v216, v217
  v_cvt_pk_bf16_f32 v191, v218, v219
  s_add_u32 s10, s18, 475136
  s_cmp_eq_u32 s6, 4
  s_cbranch_scc1 L_eo24
  buffer_store_dwordx4 v[188:191], v12, s[40:43], s10 offen offset:2048 sc1
L_eb24:
  v_mfma_f32_16x16x32_bf16 v[252:255], v[24:27], v[40:43], v[252:255]
  s_waitcnt lgkmcnt(0)
  v_mfma_f32_16x16x32_bf16 v[240:243], v[28:31], v[88:91], v[240:243]
  v_mfma_f32_16x16x32_bf16 v[244:247], v[28:31], v[92:95], v[244:247]
  v_cvt_pk_bf16_f32 v192, v192, v193
  v_cvt_pk_bf16_f32 v193, v194, v195
  v_cvt_pk_bf16_f32 v194, v220, v221
  v_cvt_pk_bf16_f32 v195, v222, v223
  s_add_u32 s10, s18, 593920
  s_cmp_eq_u32 s6, 5
  s_cbranch_scc1 L_eo25
  buffer_store_dwordx4 v[192:195], v12, s[40:43], s10 offen offset:2048 sc1
L_eb25:
  v_mfma_f32_16x16x32_bf16 v[248:251], v[28:31], v[96:99], v[248:251]
  v_mfma_f32_16x16x32_bf16 v[252:255], v[28:31], v[144:147], v[252:255]
  v_cvt_pk_bf16_f32 v196, v196, v197
  v_cvt_pk_bf16_f32 v197, v198, v199
  v_cvt_pk_bf16_f32 v198, v224, v225
  v_cvt_pk_bf16_f32 v199, v226, v227
  s_add_u32 s10, s18, 712704
  s_cmp_eq_u32 s6, 6
  s_cbranch_scc1 L_eo26
  buffer_store_dwordx4 v[196:199], v12, s[40:43], s10 offen offset:2048 sc1
L_eb26:
  v_cvt_pk_bf16_f32 v240, v240, v241
  v_cvt_pk_bf16_f32 v241, v242, v243
  s_add_u32 s10, s18, 356352
  s_cmp_eq_u32 s6, 3
  s_cbranch_scc1 L_eo33
  buffer_store_dwordx2 v[240:241], v4, s[40:43], s10 offen offset:3072 sc1
L_eb33:
  v_cvt_pk_bf16_f32 v244, v244, v245
  v_cvt_pk_bf16_f32 v245, v246, v247
  s_add_u32 s10, s18, 475136
  s_cmp_eq_u32 s6, 4
  s_cbranch_scc1 L_eo34
  buffer_store_dwordx2 v[244:245], v4, s[40:43], s10 offen offset:3072 sc1
L_eb34:
  v_cvt_pk_bf16_f32 v248, v248, v249
  v_cvt_pk_bf16_f32 v249, v250, v251
  s_add_u32 s10, s18, 593920
  s_cmp_eq_u32 s6, 5
  s_cbranch_scc1 L_eo35
  buffer_store_dwordx2 v[248:249], v4, s[40:43], s10 offen offset:3072 sc1
L_eb35:
  v_cvt_pk_bf16_f32 v252, v252, v253
  v_cvt_pk_bf16_f32 v253, v254, v255
  s_add_u32 s10, s18, 712704
  s_cmp_eq_u32 s6, 6
  s_cbranch_scc1 L_eo36
  buffer_store_dwordx2 v[252:253], v4, s[40:43], s10 offen offset:3072 sc1
L_eb36:
  v_lshlrev_b32 v6, 8, v0
  v_mov_b32 v7, 1
  s_lshl_b32 s10, s6, 2
  s_add_u32 s10, s10, s4
  s_lshl_b32 s10, s10, 2
  s_mov_b64 exec, 0x7f
  s_waitcnt vmcnt(0)
  buffer_store_dword v7, v6, s[24:27], s10 offen sc1
  s_mov_b64 exec, -1
  s_branch L_tail
L_eo00:
  ds_write_b128 v3, v[60:63] offset:0
  s_branch L_eb00
L_eo01:
  ds_write_b128 v3, v[64:67] offset:0
  s_branch L_eb01
L_eo02:
  ds_write_b128 v3, v[68:71] offset:0
  s_branch L_eb02
L_eo10:
  ds_write_b128 v3, v[116:119] offset:1024
  s_branch L_eb10
L_eo11:
  ds_write_b128 v3, v[120:123] offset:1024
  s_branch L_eb11
L_eo12:
  ds_write_b128 v3, v[124:127] offset:1024
  s_branch L_eb12
L_eo20:
  ds_write_b128 v3, v[172:175] offset:2048
  s_branch L_eb20
L_eo21:
  ds_write_b128 v3, v[176:179] offset:2048
  s_branch L_eb21
L_eo22:
  ds_write_b128 v3, v[180:183] offset:2048
  s_branch L_eb22
L_eo30:
  ds_write_b64 v5, v[228:229] offset:3072
  s_branch L_eb30
L_eo31:
  ds_write_b64 v5, v[232:233] offset:3072
  s_branch L_eb31
L_eo32:
  ds_write_b64 v5, v[236:237] offset:3072
  s_branch L_eb32
L_eo03:
  ds_write_b128 v3, v[72:75] offset:0
  s_branch L_eb03
L_eo04:
  ds_write_b128 v3, v[76:79] offset:0
  s_branch L_eb04
L_eo05:
  ds_write_b128 v3, v[80:83] offset:0
  s_branch L_eb05
L_eo06:
  ds_write_b128 v3, v[84:87] offset:0
  s_branch L_eb06
L_eo13:
  ds_write_b128 v3, v[128:131] offset:1024
  s_branch L_eb13
L_eo14:
  ds_write_b128 v3, v[132:135] offset:1024
  s_branch L_eb14
L_eo15:
  ds_write_b128 v3, v[136:139] offset:1024
  s_branch L_eb15
L_eo16:
  ds_write_b128 v3, v[140:143] offset:1024
  s_branch L_eb16
L_eo23:
  ds_write_b128 v3, v[184:187] offset:2048
  s_branch L_eb23
L_eo24:
  ds_write_b128 v3, v[188:191] offset:2048
  s_branch L_eb24
L_eo25:
  ds_write_b128 v3, v[192:195] offset:2048
  s_branch L_eb25
L_eo26:
  ds_write_b128 v3, v[196:199] offset:2048
  s_branch L_eb26
L_eo33:
  ds_write_b64 v5, v[240:241] offset:3072
  s_branch L_eb33
L_eo34:
  ds_write_b64 v5, v[244:245] offset:3072
  s_branch L_eb34
L_eo35:
  ds_write_b64 v5, v[248:249] offset:3072
  s_branch L_eb35
L_eo36:
  ds_write_b64 v5, v[252:253] offset:3072
  s_branch L_eb36
L_codeend:
.section .rodata,"a"
.p2align 6
.amdhsa_kernel concat_heads__mha_block_cached__gqa_block_cached__near_ridge_kernel
  .amdhsa_next_free_vgpr 256
  .amdhsa_next_free_sgpr 102
  .amdhsa_accum_offset 256
  .amdhsa_group_segment_fixed_size 0
  .amdhsa_kernarg_size 104
  .amdhsa_user_sgpr_count 2
  .amdhsa_user_sgpr_kernarg_segment_ptr 1
  .amdhsa_system_sgpr_workgroup_id_x 1
.end_amdhsa_kernel
.text
```
